```python
import torch

def _softmax(x, axis=-1):
    return torch.softmax(x, dim=axis)
def _gelu(x):
    return torch.nn.functional.gelu(x, approximate="tanh")
def _silu(x):
    return torch.nn.functional.silu(x)
def _sigmoid(x):
    return torch.sigmoid(x)
def _layernorm(x, axis=-1, eps=1e-5):
    m = x.mean(dim=axis, keepdim=True)
    v = x.var(dim=axis, keepdim=True, unbiased=False)
    return (x - m) / torch.sqrt(v + eps)
def _scatter_add(tgt, idx, src, axis=0):
    return tgt.clone().index_add_(axis, idx, src)
def _segment_sum(src, seg, n):
    out = torch.zeros((n,) + src.shape[1:], dtype=src.dtype)
    return out.index_add_(0, seg, src)
def _pad(x, pw):
    flat = tuple(v for pair in reversed(pw) for v in pair)
    return torch.nn.functional.pad(x, flat)

kernel_name = 'sequential_preLN__ssm_conv_s4__geglu_ffn__prompt'

def setup_inputs():

    _w = (lambda a: (lambda t: t.to(torch.bfloat16) if t.is_floating_point() else t)(torch.as_tensor(a)))
    def _A_setup():
        B, L, D, N = 1, 2048, 640, 192
        A_re = -(lambda _x: torch.exp(torch.as_tensor(_x)))((lambda *s: torch.randn(*s, dtype=torch.bfloat16) * 6.4)(D, N))
        A_im = torch.pi * (lambda *s: torch.randn(*s, dtype=torch.bfloat16) * 0.05)(D, N)
        B_re = (lambda *s: torch.randn(*s, dtype=torch.bfloat16) * 0.05)(D, N)
        B_im = (lambda *s: torch.randn(*s, dtype=torch.bfloat16) * 0.05)(D, N)
        C_re = (lambda *s: torch.randn(*s, dtype=torch.bfloat16) * 0.05)(D, N)
        C_im = (lambda *s: torch.randn(*s, dtype=torch.bfloat16) * 0.05)(D, N)
        log_dt = (lambda *s: torch.randn(*s, dtype=torch.bfloat16) * 0.05)(D) * 0.5 - 4.0
        Dskip = (lambda *s: torch.randn(*s, dtype=torch.bfloat16) * 0.05)(D)
        return {
            "u": _w((lambda *s: torch.randn(*s, dtype=torch.bfloat16) * 0.05)(B, L, D)),
            "A_re": _w(A_re),
            "A_im": _w(A_im),
            "B_re": _w(B_re),
            "B_im": _w(B_im),
            "C_re": _w(C_re),
            "C_im": _w(C_im),
            "log_dt": _w(log_dt),
            "Dskip": _w(Dskip),
        }
    _A_in = _A_setup()

    def _B_setup():
        B, S, D, F = 1, 2048, 640, 1536
        return {
            "x": _w((lambda *s: torch.randn(*s, dtype=torch.bfloat16) * 0.05)(B, S, D)),
            "w_gate": _w((lambda *s: torch.randn(*s, dtype=torch.bfloat16) * 0.05)(D, F)),
            "w_up": _w((lambda *s: torch.randn(*s, dtype=torch.bfloat16) * 0.05)(D, F)),
            "w_down": _w((lambda *s: torch.randn(*s, dtype=torch.bfloat16) * 0.05)(F, D)),
        }
    _B_in = _B_setup()

    return {
        "A_u": _A_in["u"],
        "A_A_re": _A_in["A_re"],
        "A_A_im": _A_in["A_im"],
        "A_B_re": _A_in["B_re"],
        "A_B_im": _A_in["B_im"],
        "A_C_re": _A_in["C_re"],
        "A_C_im": _A_in["C_im"],
        "A_log_dt": _A_in["log_dt"],
        "A_Dskip": _A_in["Dskip"],
        "B_x": _B_in["x"],
        "B_w_gate": _B_in["w_gate"],
        "B_w_up": _B_in["w_up"],
        "B_w_down": _B_in["w_down"],
    }

def reference(A_u, A_A_re, A_A_im, A_B_re, A_B_im, A_C_re, A_C_im, A_log_dt, A_Dskip, B_x, B_w_gate, B_w_up, B_w_down):
    def _A_ref(u, A_re, A_im, B_re, B_im, C_re, C_im, log_dt, Dskip):
        Bsz, L, D = u.shape
        dt = torch.exp(log_dt)[:, None]
        A = A_re + 1j * A_im
        Bc = B_re + 1j * B_im
        Cc = C_re + 1j * C_im
        logdA = dt * A
        dB = dt * Bc
        l = (lambda x, dt: x.to(dt))(torch.arange(L), A_re.dtype)
        P = torch.exp(logdA[:, :, None] * l[None, None, :])
        K = torch.einsum("dn,dnl,dn->dl", Cc, P, dB).real
        L2 = 2 * L
        Kp = _pad(K, ((0, 0), (0, L)))
        up = (lambda x, *d: x.permute(*d))(u, 0, 2, 1)
        up = _pad(up, ((0, 0), (0, 0), (0, L)))
        Kf = (lambda x, axes=(-2,-1): torch.fft.rfft2(x.float(), dim=axes))(Kp[:, None, :], axes=(-2, -1))
        Uf = (lambda x, axes=(-2,-1): torch.fft.rfft2(x.float(), dim=axes))(up[:, :, None, :], axes=(-2, -1))
        Yf = Uf * Kf[None, :, :, :]
        y = (lambda x, s, axes=(-2,-1): torch.fft.irfft2(x, s=s, dim=axes).to(torch.bfloat16))(Yf, (1, L2), axes=(-2, -1))[:, :, 0, :L]
        y = (lambda x, *d: x.permute(*d))(y, 0, 2, 1) + u * Dskip[None, None, :]
        return y

    def _B_ref(x, w_gate, w_up, w_down):
        return (_gelu(x @ w_gate) * (x @ w_up)) @ w_down

    x = A_u
    h = x + _A_ref(_layernorm(x, axis=-1), A_A_re, A_A_im, A_B_re, A_B_im, A_C_re, A_C_im, A_log_dt, A_Dskip)
    h2 = h + _B_ref(_layernorm(h, axis=-1), B_w_gate, B_w_up, B_w_down)
    return h2
```

```asm
; @launch grid=(256,1,1) block=(256,1,1) lds=163840
.amdgcn_target "amdgcn-amd-amdhsa--gfx950"
.text
.globl sequential_preLN__ssm_conv_s4__geglu_ffn__prompt_kernel
.p2align 8
.type sequential_preLN__ssm_conv_s4__geglu_ffn__prompt_kernel,@function
sequential_preLN__ssm_conv_s4__geglu_ffn__prompt_kernel:
    s_cmpk_ge_u32 s2, 256
    s_cbranch_scc1 L_end
    s_load_dwordx16 s[16:31], s[0:1], 0
    s_load_dwordx16 s[32:47], s[0:1], 64
    s_getpc_b64 s[80:81]
L_pc:
    v_lshrrev_b32 v8, 2, v0
    s_bfe_u32 s4, s2, 0x30003
    v_lshl_add_u32 v8, v8, 3, s4
    v_lshlrev_b32 v8, 7, v8
    v_min_u32 v8, L_code_end-L_pc-4, v8
    global_load_dword v254, v8, s[80:81]
    v_lshrrev_b32 v1, 6, v0
    v_and_b32 v0, 63, v0
    v_readfirstlane_b32 s3, v1
    s_cmpk_ge_u32 s2, 224
    s_cbranch_scc1 L_h_nostat
    s_cmpk_ge_u32 s2, 160
    s_cbranch_scc1 L_helper
    s_and_b32 s4, s2, 7
    s_mul_i32 s4, s4, 20
    s_lshr_b32 s5, s2, 3
    s_add_u32 s15, s4, s5
    s_lshl2_add_u32 s4, s15, s3
    s_lshl_b32 s5, s4, 1
    v_mov_b32 v4, s5
    s_mulk_i32 s4, 384
    v_lshl_add_u32 v2, v0, 2, s4
    v_lshl_add_u32 v3, v0, 1, s4
    s_waitcnt lgkmcnt(0)
    global_load_ushort v72, v4, s[30:31]
    global_load_dword v60, v2, s[18:19]
    global_load_ushort v66, v3, s[18:19] offset:256
    global_load_dword v61, v2, s[20:21]
    global_load_ushort v67, v3, s[20:21] offset:256
    global_load_dword v62, v2, s[22:23]
    global_load_ushort v68, v3, s[22:23] offset:256
    global_load_dword v63, v2, s[24:25]
    global_load_ushort v69, v3, s[24:25] offset:256
    global_load_dword v64, v2, s[26:27]
    global_load_ushort v70, v3, s[26:27] offset:256
    global_load_dword v65, v2, s[28:29]
    global_load_ushort v71, v3, s[28:29] offset:256
    global_load_ushort v74, v4, s[32:33]
    s_mul_i32 s5, s3, 10240
    s_lshl_b32 s6, s15, 3
    s_add_u32 s5, s5, s6
    s_add_u32 s5, s5, 2560
    v_mul_u32_u24 v5, 40960, v0
    v_add_u32 v54, s5, v5
    v_add_u32 v55, 5120, v54
    s_branch L_conv
.p2align 12
L_warm_f:
    s_mov_b64 exec, 0
    s_cmp_eq_u32 s3, 0
    s_cbranch_scc1 L_pg_f0
L_rt_f0:
    s_cmp_eq_u32 s3, 1
    s_cbranch_scc1 L_pg_f1
L_rt_f1:
    s_cmp_eq_u32 s3, 2
    s_cbranch_scc1 L_pg_f2
L_rt_f2:
    s_cmp_eq_u32 s3, 3
    s_cbranch_scc1 L_ffn
L_rt_ffn:
    s_mov_b64 exec, -1
    s_setpc_b64 s[74:75]
L_conv:
    s_and_b32 s4, s2, 7
    s_mul_i32 s4, s4, 160
    s_bfe_u32 s5, s2, 0x10006
    s_mul_i32 s5, s5, 156
    s_add_u32 s4, s4, s5
    s_bfe_u32 s5, s2, 0x30003
    s_lshl3_add_u32 s5, s3, s5
    s_mul_i32 s5, s5, 1280
    s_add_u32 s4, s4, s5
    v_add_u32 v58, s4, v5
    global_load_dword v255, v58, s[16:17]
    s_mov_b32 s50, 15859712
    s_mov_b32 s51, 0x20000
    s_mov_b32 s54, 2621440
    s_mov_b32 s55, 0x20000
    s_movk_i32 s62, 256
    s_mov_b32 s63, 0x20000
    s_cmp_eq_u32 s3, 0
    s_cselect_b32 s79, 1, 0
    v_lshlrev_b32 v240, 4, v0
    s_waitcnt lgkmcnt(0)
    s_mov_b64 s[48:49], s[46:47]
    s_mov_b64 s[52:53], s[42:43]
    s_mov_b64 s[60:61], s[44:45]
    s_lshl_b32 s4, s3, 10
    s_add_u32 s4, s4, 0
    v_add_u32 v52, s4, v240
    v_and_b32 v2, 15, v0
    v_lshrrev_b32 v3, 4, v0
    v_mul_u32_u24 v4, 800, v2
    v_lshl_add_u32 v4, v3, 4, v4
    s_mul_i32 s4, s3, 16640
    s_add_u32 s4, s4, 0
    v_add_u32 v214, s4, v4
    s_mul_i32 s4, s3, 12800
    s_add_u32 s4, s4, 66560
    v_add_u32 v215, s4, v4
    s_mul_i32 s4, s3, 7168
    s_add_u32 s4, s4, 135168
    v_add_u32 v216, s4, v4
    s_add_u32 s4, s4, 512
    v_lshl_add_u32 v213, v0, 2, s4
    s_mul_i32 s4, s3, 16640
    v_add_u32 v221, s4, v240
    v_and_b32 v5, 3, v0
    v_bfe_u32 v6, v0, 2, 2
    v_mul_u32_u24 v6, 4160, v6
    v_lshl_add_u32 v6, v5, 4, v6
    v_add_u32 v224, s4, v6
    s_lshl_b32 s4, s3, 10
    s_add_u32 s4, s4, 107520
    v_add_u32 v225, s4, v240
    s_mul_i32 s5, s3, 2816
    s_add_u32 s5, s5, 123904
    v_lshlrev_b32 v4, 6, v2
    v_lshl_add_u32 v4, v3, 4, v4
    v_add_u32 v217, s5, v4
    v_lshlrev_b32 v4, 5, v2
    v_lshl_add_u32 v4, v3, 4, v4
    v_lshlrev_b32 v5, 8, v3
    v_lshl_add_u32 v6, v2, 4, v5
    v_cmp_gt_u32 vcc, 32, v0
    s_nop 1
    v_cndmask_b32 v4, v6, v4, vcc
    v_add_u32 v218, s5, v4
    v_lshl_add_u32 v5, v2, 3, v5
    v_min_u32 v5, 520, v5
    v_add_u32 v219, s5, v5
    v_sub_u32 v4, 63, v0
    v_lshl_add_u32 v222, v4, 2, s5
    v_lshl_add_u32 v223, v4, 3, s5
    v_lshlrev_b32 v5, 5, v4
    v_lshlrev_b32 v6, 4, v4
    v_add_u32 v6, 512, v6
    v_cndmask_b32 v5, v5, v6, vcc
    v_add_u32 v220, s5, v5
    v_lshlrev_b32 v3, 2, v3
    v_sub_u32 v2, v2, v3
    s_mov_b32 s100, 0x55555555
    s_mov_b32 s101, 0x55555555
    s_mov_b32 s82, 0x3fb8aa3b
    s_mov_b32 s83, 0x3e22f983
    s_mov_b32 s84, 0x41b8aa3b
    s_mov_b32 s85, 0x4022f983
    s_mov_b32 s86, 0x43b8aa3b
    s_mov_b32 s87, 0x4222f983
    s_mul_i32 s4, s3, 16640
    s_mul_i32 s5, s3, 12800
    s_add_u32 s5, s5, 17408
    v_add_u32 v226, 4294966784, v213
    v_add_u32 v227, 288, v213
    v_add_u32 v228, 1088, v213
    v_add_u32 v229, 1888, v213
    v_add_u32 v230, 2688, v213
    v_add_u32 v231, 3488, v213
    v_add_u32 v232, 4288, v213
    v_add_u32 v233, 5088, v213
    v_add_u32 v234, 5888, v213
    v_mov_b32 v204, 0
    v_cmp_eq_u32 s[6:7], 0, v2
    v_mov_b32 v205, 0
    v_cmp_eq_u32 s[8:9], 1, v2
    v_mov_b32 v206, 0
    v_cmp_eq_u32 s[10:11], 2, v2
    v_mov_b32 v207, 0
    v_cmp_eq_u32 s[12:13], 3, v2
    s_mov_b64 exec, 0
    s_cmp_eq_u32 s3, 0
    s_cbranch_scc1 L_pg_c0
L_rt_c0:
    s_cmp_eq_u32 s3, 1
    s_cbranch_scc1 L_pg_c1
L_rt_c1:
    s_cmp_eq_u32 s3, 2
    s_cbranch_scc1 L_pg_c2
L_rt_c2:
    s_cmp_eq_u32 s3, 3
    s_cbranch_scc1 L_pg_c3
L_rt_c3:
    s_mov_b64 exec, -1
    s_call_b64 s[74:75], L_warm_f
    global_load_dwordx2 v[8:9], v54, s[16:17] offset:-2560
    s_waitcnt vmcnt(15)
    v_lshlrev_b32 v72, 16, v72
    v_mul_f32 v72, 0x3fb8aa3b, v72
    v_exp_f32 v72, v72
    s_nop 0
    v_cvt_pk_bf16_f32 v72, v72, v72
    v_and_b32 v72, 0xffff0000, v72
    s_waitcnt vmcnt(14)
    v_lshlrev_b32 v118, 16, v60
    v_and_b32 v120, 0xffff0000, v60
    s_waitcnt vmcnt(13)
    v_lshlrev_b32 v122, 16, v66
    s_waitcnt vmcnt(12)
    v_lshlrev_b32 v119, 16, v61
    v_and_b32 v121, 0xffff0000, v61
    s_waitcnt vmcnt(11)
    v_lshlrev_b32 v123, 16, v67
    global_load_dwordx2 v[10:11], v54, s[16:17] offset:-1280
    v_pk_mul_f32 v[118:119], v[118:119], v[72:73] op_sel:[0,0] op_sel_hi:[1,0]
    v_pk_mul_f32 v[120:121], v[120:121], v[72:73] op_sel:[0,0] op_sel_hi:[1,0]
    v_pk_mul_f32 v[122:123], v[122:123], v[72:73] op_sel:[0,0] op_sel_hi:[1,0]
    v_pk_mul_f32 v[124:125], v[118:119], s[82:83]
    v_pk_mul_f32 v[126:127], v[120:121], s[82:83]
    v_pk_mul_f32 v[128:129], v[122:123], s[82:83]
    v_pk_mul_f32 v[130:131], v[118:119], s[84:85]
    v_pk_mul_f32 v[132:133], v[120:121], s[84:85]
    v_pk_mul_f32 v[134:135], v[122:123], s[84:85]
    v_pk_mul_f32 v[136:137], v[118:119], s[86:87]
    v_pk_mul_f32 v[138:139], v[120:121], s[86:87]
    v_pk_mul_f32 v[140:141], v[122:123], s[86:87]
    v_exp_f32 v124, v124
    v_fract_f32 v125, v125
    v_exp_f32 v126, v126
    v_fract_f32 v127, v127
    v_exp_f32 v128, v128
    v_fract_f32 v129, v129
    v_cos_f32 v76, v125
    v_sin_f32 v77, v125
    v_cos_f32 v78, v127
    v_sin_f32 v79, v127
    v_cos_f32 v80, v129
    v_sin_f32 v81, v129
    v_pk_mul_f32 v[76:77], v[76:77], v[124:125] op_sel:[0,0] op_sel_hi:[1,0]
    v_pk_mul_f32 v[78:79], v[78:79], v[126:127] op_sel:[0,0] op_sel_hi:[1,0]
    v_pk_mul_f32 v[80:81], v[80:81], v[128:129] op_sel:[0,0] op_sel_hi:[1,0]
    v_exp_f32 v130, v130
    v_fract_f32 v131, v131
    v_exp_f32 v132, v132
    v_fract_f32 v133, v133
    v_exp_f32 v134, v134
    v_fract_f32 v135, v135
    v_cos_f32 v82, v131
    v_sin_f32 v83, v131
    v_cos_f32 v84, v133
    v_sin_f32 v85, v133
    v_cos_f32 v86, v135
    v_sin_f32 v87, v135
    v_pk_mul_f32 v[82:83], v[82:83], v[130:131] op_sel:[0,0] op_sel_hi:[1,0]
    v_pk_mul_f32 v[84:85], v[84:85], v[132:133] op_sel:[0,0] op_sel_hi:[1,0]
    v_pk_mul_f32 v[86:87], v[86:87], v[134:135] op_sel:[0,0] op_sel_hi:[1,0]
    v_exp_f32 v136, v136
    v_fract_f32 v137, v137
    v_exp_f32 v138, v138
    v_fract_f32 v139, v139
    v_exp_f32 v140, v140
    v_fract_f32 v141, v141
    v_cos_f32 v88, v137
    v_sin_f32 v89, v137
    v_cos_f32 v90, v139
    v_sin_f32 v91, v139
    v_cos_f32 v92, v141
    v_sin_f32 v93, v141
    v_pk_mul_f32 v[88:89], v[88:89], v[136:137] op_sel:[0,0] op_sel_hi:[1,0]
    v_pk_mul_f32 v[90:91], v[90:91], v[138:139] op_sel:[0,0] op_sel_hi:[1,0]
    v_pk_mul_f32 v[92:93], v[92:93], v[140:141] op_sel:[0,0] op_sel_hi:[1,0]
    v_mov_b32 v184, 0x3f80
    v_mov_b32 v185, 0x3f80
    v_mov_b32 v186, 0x3f80
    s_mov_b32 m0, s4
    s_nop 0
    ds_write_addtid_b32 v184 offset:0
    ds_write_addtid_b32 v185 offset:256
    ds_write_addtid_b32 v186 offset:512
    v_cvt_pk_bf16_f32 v188, v76, v77
    v_cvt_pk_bf16_f32 v189, v78, v79
    v_cvt_pk_bf16_f32 v190, v80, v81
    ds_write_addtid_b32 v188 offset:800
    ds_write_addtid_b32 v189 offset:1056
    ds_write_addtid_b32 v190 offset:1312
    v_pk_mul_f32 v[106:107], v[76:77], v[76:77] op_sel:[0,0] op_sel_hi:[0,1]
    v_pk_mul_f32 v[108:109], v[78:79], v[78:79] op_sel:[0,0] op_sel_hi:[0,1]
    v_pk_mul_f32 v[110:111], v[80:81], v[80:81] op_sel:[0,0] op_sel_hi:[0,1]
    v_pk_fma_f32 v[118:119], v[76:77], v[76:77], v[106:107] op_sel:[1,1,0] op_sel_hi:[1,0,1] neg_lo:[0,1,0]
    v_pk_fma_f32 v[120:121], v[78:79], v[78:79], v[108:109] op_sel:[1,1,0] op_sel_hi:[1,0,1] neg_lo:[0,1,0]
    v_pk_fma_f32 v[122:123], v[80:81], v[80:81], v[110:111] op_sel:[1,1,0] op_sel_hi:[1,0,1] neg_lo:[0,1,0]
    v_cvt_pk_bf16_f32 v184, v118, v119
    v_cvt_pk_bf16_f32 v185, v120, v121
    v_cvt_pk_bf16_f32 v186, v122, v123
    ds_write_addtid_b32 v184 offset:1600
    ds_write_addtid_b32 v185 offset:1856
    ds_write_addtid_b32 v186 offset:2112
    v_pk_mul_f32 v[106:107], v[118:119], v[76:77] op_sel:[0,0] op_sel_hi:[0,1]
    v_pk_mul_f32 v[108:109], v[120:121], v[78:79] op_sel:[0,0] op_sel_hi:[0,1]
    v_pk_mul_f32 v[110:111], v[122:123], v[80:81] op_sel:[0,0] op_sel_hi:[0,1]
    v_pk_fma_f32 v[94:95], v[118:119], v[76:77], v[106:107] op_sel:[1,1,0] op_sel_hi:[1,0,1] neg_lo:[0,1,0]
    v_pk_fma_f32 v[96:97], v[120:121], v[78:79], v[108:109] op_sel:[1,1,0] op_sel_hi:[1,0,1] neg_lo:[0,1,0]
    v_pk_fma_f32 v[98:99], v[122:123], v[80:81], v[110:111] op_sel:[1,1,0] op_sel_hi:[1,0,1] neg_lo:[0,1,0]
    v_cvt_pk_bf16_f32 v188, v94, v95
    v_cvt_pk_bf16_f32 v189, v96, v97
    v_cvt_pk_bf16_f32 v190, v98, v99
    ds_write_addtid_b32 v188 offset:2400
    ds_write_addtid_b32 v189 offset:2656
    ds_write_addtid_b32 v190 offset:2912
    v_pk_mul_f32 v[106:107], v[94:95], v[76:77] op_sel:[0,0] op_sel_hi:[0,1]
    v_pk_mul_f32 v[108:109], v[96:97], v[78:79] op_sel:[0,0] op_sel_hi:[0,1]
    v_pk_mul_f32 v[110:111], v[98:99], v[80:81] op_sel:[0,0] op_sel_hi:[0,1]
    v_pk_fma_f32 v[124:125], v[94:95], v[76:77], v[106:107] op_sel:[1,1,0] op_sel_hi:[1,0,1] neg_lo:[0,1,0]
    v_pk_fma_f32 v[126:127], v[96:97], v[78:79], v[108:109] op_sel:[1,1,0] op_sel_hi:[1,0,1] neg_lo:[0,1,0]
    v_pk_fma_f32 v[128:129], v[98:99], v[80:81], v[110:111] op_sel:[1,1,0] op_sel_hi:[1,0,1] neg_lo:[0,1,0]
    v_cvt_pk_bf16_f32 v184, v124, v125
    v_cvt_pk_bf16_f32 v185, v126, v127
    v_cvt_pk_bf16_f32 v186, v128, v129
    ds_write_addtid_b32 v184 offset:3200
    ds_write_addtid_b32 v185 offset:3456
    ds_write_addtid_b32 v186 offset:3712
    v_pk_mul_f32 v[106:107], v[124:125], v[76:77] op_sel:[0,0] op_sel_hi:[0,1]
    v_pk_mul_f32 v[108:109], v[126:127], v[78:79] op_sel:[0,0] op_sel_hi:[0,1]
    v_pk_mul_f32 v[110:111], v[128:129], v[80:81] op_sel:[0,0] op_sel_hi:[0,1]
    v_pk_fma_f32 v[94:95], v[124:125], v[76:77], v[106:107] op_sel:[1,1,0] op_sel_hi:[1,0,1] neg_lo:[0,1,0]
    v_pk_fma_f32 v[96:97], v[126:127], v[78:79], v[108:109] op_sel:[1,1,0] op_sel_hi:[1,0,1] neg_lo:[0,1,0]
    v_pk_fma_f32 v[98:99], v[128:129], v[80:81], v[110:111] op_sel:[1,1,0] op_sel_hi:[1,0,1] neg_lo:[0,1,0]
    v_cvt_pk_bf16_f32 v188, v94, v95
    v_cvt_pk_bf16_f32 v189, v96, v97
    v_cvt_pk_bf16_f32 v190, v98, v99
    ds_write_addtid_b32 v188 offset:4000
    ds_write_addtid_b32 v189 offset:4256
    ds_write_addtid_b32 v190 offset:4512
    v_pk_mul_f32 v[106:107], v[94:95], v[76:77] op_sel:[0,0] op_sel_hi:[0,1]
    v_pk_mul_f32 v[108:109], v[96:97], v[78:79] op_sel:[0,0] op_sel_hi:[0,1]
    v_pk_mul_f32 v[110:111], v[98:99], v[80:81] op_sel:[0,0] op_sel_hi:[0,1]
    v_pk_fma_f32 v[130:131], v[94:95], v[76:77], v[106:107] op_sel:[1,1,0] op_sel_hi:[1,0,1] neg_lo:[0,1,0]
    v_pk_fma_f32 v[132:133], v[96:97], v[78:79], v[108:109] op_sel:[1,1,0] op_sel_hi:[1,0,1] neg_lo:[0,1,0]
    v_pk_fma_f32 v[134:135], v[98:99], v[80:81], v[110:111] op_sel:[1,1,0] op_sel_hi:[1,0,1] neg_lo:[0,1,0]
    v_cvt_pk_bf16_f32 v184, v130, v131
    v_cvt_pk_bf16_f32 v185, v132, v133
    v_cvt_pk_bf16_f32 v186, v134, v135
    ds_write_addtid_b32 v184 offset:4800
    ds_write_addtid_b32 v185 offset:5056
    ds_write_addtid_b32 v186 offset:5312
    v_pk_mul_f32 v[106:107], v[130:131], v[76:77] op_sel:[0,0] op_sel_hi:[0,1]
    v_pk_mul_f32 v[108:109], v[132:133], v[78:79] op_sel:[0,0] op_sel_hi:[0,1]
    v_pk_mul_f32 v[110:111], v[134:135], v[80:81] op_sel:[0,0] op_sel_hi:[0,1]
    v_pk_fma_f32 v[94:95], v[130:131], v[76:77], v[106:107] op_sel:[1,1,0] op_sel_hi:[1,0,1] neg_lo:[0,1,0]
    v_pk_fma_f32 v[96:97], v[132:133], v[78:79], v[108:109] op_sel:[1,1,0] op_sel_hi:[1,0,1] neg_lo:[0,1,0]
    v_pk_fma_f32 v[98:99], v[134:135], v[80:81], v[110:111] op_sel:[1,1,0] op_sel_hi:[1,0,1] neg_lo:[0,1,0]
    v_cvt_pk_bf16_f32 v188, v94, v95
    v_cvt_pk_bf16_f32 v189, v96, v97
    v_cvt_pk_bf16_f32 v190, v98, v99
    ds_write_addtid_b32 v188 offset:5600
    ds_write_addtid_b32 v189 offset:5856
    ds_write_addtid_b32 v190 offset:6112
    global_load_dwordx2 v[12:13], v54, s[16:17] offset:0
    v_pk_mul_f32 v[106:107], v[94:95], v[76:77] op_sel:[0,0] op_sel_hi:[0,1]
    v_pk_mul_f32 v[108:109], v[96:97], v[78:79] op_sel:[0,0] op_sel_hi:[0,1]
    v_pk_mul_f32 v[110:111], v[98:99], v[80:81] op_sel:[0,0] op_sel_hi:[0,1]
    v_pk_fma_f32 v[136:137], v[94:95], v[76:77], v[106:107] op_sel:[1,1,0] op_sel_hi:[1,0,1] neg_lo:[0,1,0]
    v_pk_fma_f32 v[138:139], v[96:97], v[78:79], v[108:109] op_sel:[1,1,0] op_sel_hi:[1,0,1] neg_lo:[0,1,0]
    v_pk_fma_f32 v[140:141], v[98:99], v[80:81], v[110:111] op_sel:[1,1,0] op_sel_hi:[1,0,1] neg_lo:[0,1,0]
    v_cvt_pk_bf16_f32 v184, v136, v137
    v_cvt_pk_bf16_f32 v185, v138, v139
    v_cvt_pk_bf16_f32 v186, v140, v141
    ds_write_addtid_b32 v184 offset:6400
    ds_write_addtid_b32 v185 offset:6656
    ds_write_addtid_b32 v186 offset:6912
    v_pk_mul_f32 v[106:107], v[136:137], v[76:77] op_sel:[0,0] op_sel_hi:[0,1]
    v_pk_mul_f32 v[108:109], v[138:139], v[78:79] op_sel:[0,0] op_sel_hi:[0,1]
    v_pk_mul_f32 v[110:111], v[140:141], v[80:81] op_sel:[0,0] op_sel_hi:[0,1]
    v_pk_fma_f32 v[94:95], v[136:137], v[76:77], v[106:107] op_sel:[1,1,0] op_sel_hi:[1,0,1] neg_lo:[0,1,0]
    v_pk_fma_f32 v[96:97], v[138:139], v[78:79], v[108:109] op_sel:[1,1,0] op_sel_hi:[1,0,1] neg_lo:[0,1,0]
    v_pk_fma_f32 v[98:99], v[140:141], v[80:81], v[110:111] op_sel:[1,1,0] op_sel_hi:[1,0,1] neg_lo:[0,1,0]
    v_cvt_pk_bf16_f32 v188, v94, v95
    v_cvt_pk_bf16_f32 v189, v96, v97
    v_cvt_pk_bf16_f32 v190, v98, v99
    ds_write_addtid_b32 v188 offset:7200
    ds_write_addtid_b32 v189 offset:7456
    ds_write_addtid_b32 v190 offset:7712
    v_pk_mul_f32 v[106:107], v[94:95], v[76:77] op_sel:[0,0] op_sel_hi:[0,1]
    v_pk_mul_f32 v[108:109], v[96:97], v[78:79] op_sel:[0,0] op_sel_hi:[0,1]
    v_pk_mul_f32 v[110:111], v[98:99], v[80:81] op_sel:[0,0] op_sel_hi:[0,1]
    v_pk_fma_f32 v[142:143], v[94:95], v[76:77], v[106:107] op_sel:[1,1,0] op_sel_hi:[1,0,1] neg_lo:[0,1,0]
    v_pk_fma_f32 v[144:145], v[96:97], v[78:79], v[108:109] op_sel:[1,1,0] op_sel_hi:[1,0,1] neg_lo:[0,1,0]
    v_pk_fma_f32 v[146:147], v[98:99], v[80:81], v[110:111] op_sel:[1,1,0] op_sel_hi:[1,0,1] neg_lo:[0,1,0]
    v_cvt_pk_bf16_f32 v184, v142, v143
    v_cvt_pk_bf16_f32 v185, v144, v145
    v_cvt_pk_bf16_f32 v186, v146, v147
    ds_write_addtid_b32 v184 offset:8000
    ds_write_addtid_b32 v185 offset:8256
    ds_write_addtid_b32 v186 offset:8512
    v_pk_mul_f32 v[106:107], v[142:143], v[76:77] op_sel:[0,0] op_sel_hi:[0,1]
    v_pk_mul_f32 v[108:109], v[144:145], v[78:79] op_sel:[0,0] op_sel_hi:[0,1]
    v_pk_mul_f32 v[110:111], v[146:147], v[80:81] op_sel:[0,0] op_sel_hi:[0,1]
    v_pk_fma_f32 v[94:95], v[142:143], v[76:77], v[106:107] op_sel:[1,1,0] op_sel_hi:[1,0,1] neg_lo:[0,1,0]
    v_pk_fma_f32 v[96:97], v[144:145], v[78:79], v[108:109] op_sel:[1,1,0] op_sel_hi:[1,0,1] neg_lo:[0,1,0]
    v_pk_fma_f32 v[98:99], v[146:147], v[80:81], v[110:111] op_sel:[1,1,0] op_sel_hi:[1,0,1] neg_lo:[0,1,0]
    v_cvt_pk_bf16_f32 v188, v94, v95
    v_cvt_pk_bf16_f32 v189, v96, v97
    v_cvt_pk_bf16_f32 v190, v98, v99
    ds_write_addtid_b32 v188 offset:8800
    ds_write_addtid_b32 v189 offset:9056
    ds_write_addtid_b32 v190 offset:9312
    v_pk_mul_f32 v[106:107], v[94:95], v[76:77] op_sel:[0,0] op_sel_hi:[0,1]
    v_pk_mul_f32 v[108:109], v[96:97], v[78:79] op_sel:[0,0] op_sel_hi:[0,1]
    v_pk_mul_f32 v[110:111], v[98:99], v[80:81] op_sel:[0,0] op_sel_hi:[0,1]
    v_pk_fma_f32 v[148:149], v[94:95], v[76:77], v[106:107] op_sel:[1,1,0] op_sel_hi:[1,0,1] neg_lo:[0,1,0]
    v_pk_fma_f32 v[150:151], v[96:97], v[78:79], v[108:109] op_sel:[1,1,0] op_sel_hi:[1,0,1] neg_lo:[0,1,0]
    v_pk_fma_f32 v[152:153], v[98:99], v[80:81], v[110:111] op_sel:[1,1,0] op_sel_hi:[1,0,1] neg_lo:[0,1,0]
    v_cvt_pk_bf16_f32 v184, v148, v149
    v_cvt_pk_bf16_f32 v185, v150, v151
    v_cvt_pk_bf16_f32 v186, v152, v153
    ds_write_addtid_b32 v184 offset:9600
    ds_write_addtid_b32 v185 offset:9856
    ds_write_addtid_b32 v186 offset:10112
    v_pk_mul_f32 v[106:107], v[148:149], v[76:77] op_sel:[0,0] op_sel_hi:[0,1]
    v_pk_mul_f32 v[108:109], v[150:151], v[78:79] op_sel:[0,0] op_sel_hi:[0,1]
    v_pk_mul_f32 v[110:111], v[152:153], v[80:81] op_sel:[0,0] op_sel_hi:[0,1]
    v_pk_fma_f32 v[94:95], v[148:149], v[76:77], v[106:107] op_sel:[1,1,0] op_sel_hi:[1,0,1] neg_lo:[0,1,0]
    v_pk_fma_f32 v[96:97], v[150:151], v[78:79], v[108:109] op_sel:[1,1,0] op_sel_hi:[1,0,1] neg_lo:[0,1,0]
    v_pk_fma_f32 v[98:99], v[152:153], v[80:81], v[110:111] op_sel:[1,1,0] op_sel_hi:[1,0,1] neg_lo:[0,1,0]
    v_cvt_pk_bf16_f32 v188, v94, v95
    v_cvt_pk_bf16_f32 v189, v96, v97
    v_cvt_pk_bf16_f32 v190, v98, v99
    ds_write_addtid_b32 v188 offset:10400
    ds_write_addtid_b32 v189 offset:10656
    ds_write_addtid_b32 v190 offset:10912
    v_pk_mul_f32 v[106:107], v[94:95], v[76:77] op_sel:[0,0] op_sel_hi:[0,1]
    v_pk_mul_f32 v[108:109], v[96:97], v[78:79] op_sel:[0,0] op_sel_hi:[0,1]
    v_pk_mul_f32 v[110:111], v[98:99], v[80:81] op_sel:[0,0] op_sel_hi:[0,1]
    v_pk_fma_f32 v[154:155], v[94:95], v[76:77], v[106:107] op_sel:[1,1,0] op_sel_hi:[1,0,1] neg_lo:[0,1,0]
    v_pk_fma_f32 v[156:157], v[96:97], v[78:79], v[108:109] op_sel:[1,1,0] op_sel_hi:[1,0,1] neg_lo:[0,1,0]
    v_pk_fma_f32 v[158:159], v[98:99], v[80:81], v[110:111] op_sel:[1,1,0] op_sel_hi:[1,0,1] neg_lo:[0,1,0]
    v_cvt_pk_bf16_f32 v184, v154, v155
    v_cvt_pk_bf16_f32 v185, v156, v157
    v_cvt_pk_bf16_f32 v186, v158, v159
    ds_write_addtid_b32 v184 offset:11200
    ds_write_addtid_b32 v185 offset:11456
    ds_write_addtid_b32 v186 offset:11712
    v_pk_mul_f32 v[106:107], v[154:155], v[76:77] op_sel:[0,0] op_sel_hi:[0,1]
    v_pk_mul_f32 v[108:109], v[156:157], v[78:79] op_sel:[0,0] op_sel_hi:[0,1]
    v_pk_mul_f32 v[110:111], v[158:159], v[80:81] op_sel:[0,0] op_sel_hi:[0,1]
    v_pk_fma_f32 v[94:95], v[154:155], v[76:77], v[106:107] op_sel:[1,1,0] op_sel_hi:[1,0,1] neg_lo:[0,1,0]
    v_pk_fma_f32 v[96:97], v[156:157], v[78:79], v[108:109] op_sel:[1,1,0] op_sel_hi:[1,0,1] neg_lo:[0,1,0]
    v_pk_fma_f32 v[98:99], v[158:159], v[80:81], v[110:111] op_sel:[1,1,0] op_sel_hi:[1,0,1] neg_lo:[0,1,0]
    v_cvt_pk_bf16_f32 v188, v94, v95
    v_cvt_pk_bf16_f32 v189, v96, v97
    v_cvt_pk_bf16_f32 v190, v98, v99
    ds_write_addtid_b32 v188 offset:12000
    ds_write_addtid_b32 v189 offset:12256
    ds_write_addtid_b32 v190 offset:12512
    s_waitcnt vmcnt(12)
    v_lshlrev_b32 v100, 16, v62
    v_and_b32 v102, 0xffff0000, v62
    s_waitcnt vmcnt(11)
    v_lshlrev_b32 v104, 16, v68
    s_waitcnt vmcnt(10)
    v_lshlrev_b32 v101, 16, v63
    v_and_b32 v103, 0xffff0000, v63
    s_waitcnt vmcnt(9)
    v_lshlrev_b32 v105, 16, v69
    s_waitcnt vmcnt(8)
    v_lshlrev_b32 v112, 16, v64
    v_and_b32 v114, 0xffff0000, v64
    s_waitcnt vmcnt(7)
    v_lshlrev_b32 v116, 16, v70
    s_waitcnt vmcnt(6)
    v_lshlrev_b32 v113, 16, v65
    v_and_b32 v115, 0xffff0000, v65
    s_waitcnt vmcnt(5)
    v_lshlrev_b32 v117, 16, v71
    v_pk_mul_f32 v[100:101], v[100:101], v[72:73] op_sel:[0,0] op_sel_hi:[1,0]
    v_pk_mul_f32 v[102:103], v[102:103], v[72:73] op_sel:[0,0] op_sel_hi:[1,0]
    v_pk_mul_f32 v[104:105], v[104:105], v[72:73] op_sel:[0,0] op_sel_hi:[1,0]
    v_pk_mul_f32 v[106:107], v[112:113], v[100:101] op_sel:[0,0] op_sel_hi:[0,1]
    v_pk_mul_f32 v[108:109], v[114:115], v[102:103] op_sel:[0,0] op_sel_hi:[0,1]
    v_pk_mul_f32 v[110:111], v[116:117], v[104:105] op_sel:[0,0] op_sel_hi:[0,1]
    v_pk_fma_f32 v[94:95], v[112:113], v[100:101], v[106:107] op_sel:[1,1,0] op_sel_hi:[1,0,1] neg_lo:[0,1,0]
    v_pk_fma_f32 v[96:97], v[114:115], v[102:103], v[108:109] op_sel:[1,1,0] op_sel_hi:[1,0,1] neg_lo:[0,1,0]
    v_pk_fma_f32 v[98:99], v[116:117], v[104:105], v[110:111] op_sel:[1,1,0] op_sel_hi:[1,0,1] neg_lo:[0,1,0]
    s_waitcnt vmcnt(4)
    v_lshlrev_b32 v74, 16, v74
    v_cndmask_b32 v40, 0, v74, s[6:7]
    v_cndmask_b32 v41, 0, v74, s[8:9]
    v_cndmask_b32 v42, 0, v74, s[10:11]
    v_cndmask_b32 v43, 0, v74, s[12:13]
    s_mov_b32 s6, 0x05040100
    s_mov_b32 s7, 0x07060302
    v_cvt_pk_bf16_f32 v184, v94, -v95
    v_cvt_pk_bf16_f32 v185, v96, -v97
    v_cvt_pk_bf16_f32 v186, v98, -v99
    s_mov_b32 m0, s5
    s_nop 0
    ds_write_addtid_b32 v184 offset:49152
    ds_write_addtid_b32 v185 offset:49408
    ds_write_addtid_b32 v186 offset:49664
    global_load_dwordx2 v[14:15], v54, s[16:17] offset:1280
    ds_read_b128 a[48:51], v214 offset:0
    v_pk_mul_f32 v[106:107], v[94:95], v[82:83] op_sel:[0,0] op_sel_hi:[0,1]
    v_pk_mul_f32 v[108:109], v[96:97], v[84:85] op_sel:[0,0] op_sel_hi:[0,1]
    v_pk_mul_f32 v[110:111], v[98:99], v[86:87] op_sel:[0,0] op_sel_hi:[0,1]
    v_pk_fma_f32 v[100:101], v[94:95], v[82:83], v[106:107] op_sel:[1,1,0] op_sel_hi:[1,0,1] neg_lo:[0,1,0]
    v_pk_fma_f32 v[102:103], v[96:97], v[84:85], v[108:109] op_sel:[1,1,0] op_sel_hi:[1,0,1] neg_lo:[0,1,0]
    v_pk_fma_f32 v[104:105], v[98:99], v[86:87], v[110:111] op_sel:[1,1,0] op_sel_hi:[1,0,1] neg_lo:[0,1,0]
    v_cvt_pk_bf16_f32 v188, v100, -v101
    v_cvt_pk_bf16_f32 v189, v102, -v103
    v_cvt_pk_bf16_f32 v190, v104, -v105
    ds_write_addtid_b32 v188 offset:49952
    ds_write_addtid_b32 v189 offset:50208
    ds_write_addtid_b32 v190 offset:50464
    ds_read_b128 a[52:55], v214 offset:64
    v_pk_mul_f32 v[106:107], v[100:101], v[82:83] op_sel:[0,0] op_sel_hi:[0,1]
    v_pk_mul_f32 v[108:109], v[102:103], v[84:85] op_sel:[0,0] op_sel_hi:[0,1]
    v_pk_mul_f32 v[110:111], v[104:105], v[86:87] op_sel:[0,0] op_sel_hi:[0,1]
    v_pk_fma_f32 v[94:95], v[100:101], v[82:83], v[106:107] op_sel:[1,1,0] op_sel_hi:[1,0,1] neg_lo:[0,1,0]
    v_pk_fma_f32 v[96:97], v[102:103], v[84:85], v[108:109] op_sel:[1,1,0] op_sel_hi:[1,0,1] neg_lo:[0,1,0]
    v_pk_fma_f32 v[98:99], v[104:105], v[86:87], v[110:111] op_sel:[1,1,0] op_sel_hi:[1,0,1] neg_lo:[0,1,0]
    v_cvt_pk_bf16_f32 v184, v94, -v95
    v_cvt_pk_bf16_f32 v185, v96, -v97
    v_cvt_pk_bf16_f32 v186, v98, -v99
    ds_write_addtid_b32 v184 offset:50752
    ds_write_addtid_b32 v185 offset:51008
    ds_write_addtid_b32 v186 offset:51264
    ds_read_b128 a[56:59], v214 offset:128
    v_pk_mul_f32 v[106:107], v[94:95], v[82:83] op_sel:[0,0] op_sel_hi:[0,1]
    v_pk_mul_f32 v[108:109], v[96:97], v[84:85] op_sel:[0,0] op_sel_hi:[0,1]
    v_pk_mul_f32 v[110:111], v[98:99], v[86:87] op_sel:[0,0] op_sel_hi:[0,1]
    v_pk_fma_f32 v[100:101], v[94:95], v[82:83], v[106:107] op_sel:[1,1,0] op_sel_hi:[1,0,1] neg_lo:[0,1,0]
    v_pk_fma_f32 v[102:103], v[96:97], v[84:85], v[108:109] op_sel:[1,1,0] op_sel_hi:[1,0,1] neg_lo:[0,1,0]
    v_pk_fma_f32 v[104:105], v[98:99], v[86:87], v[110:111] op_sel:[1,1,0] op_sel_hi:[1,0,1] neg_lo:[0,1,0]
    v_cvt_pk_bf16_f32 v188, v100, -v101
    v_cvt_pk_bf16_f32 v189, v102, -v103
    v_cvt_pk_bf16_f32 v190, v104, -v105
    ds_write_addtid_b32 v188 offset:51552
    ds_write_addtid_b32 v189 offset:51808
    ds_write_addtid_b32 v190 offset:52064
    ds_read_b128 a[60:63], v214 offset:192
    v_pk_mul_f32 v[106:107], v[100:101], v[82:83] op_sel:[0,0] op_sel_hi:[0,1]
    v_pk_mul_f32 v[108:109], v[102:103], v[84:85] op_sel:[0,0] op_sel_hi:[0,1]
    v_pk_mul_f32 v[110:111], v[104:105], v[86:87] op_sel:[0,0] op_sel_hi:[0,1]
    v_pk_fma_f32 v[94:95], v[100:101], v[82:83], v[106:107] op_sel:[1,1,0] op_sel_hi:[1,0,1] neg_lo:[0,1,0]
    v_pk_fma_f32 v[96:97], v[102:103], v[84:85], v[108:109] op_sel:[1,1,0] op_sel_hi:[1,0,1] neg_lo:[0,1,0]
    v_pk_fma_f32 v[98:99], v[104:105], v[86:87], v[110:111] op_sel:[1,1,0] op_sel_hi:[1,0,1] neg_lo:[0,1,0]
    v_cvt_pk_bf16_f32 v184, v94, -v95
    v_cvt_pk_bf16_f32 v185, v96, -v97
    v_cvt_pk_bf16_f32 v186, v98, -v99
    ds_write_addtid_b32 v184 offset:52352
    ds_write_addtid_b32 v185 offset:52608
    ds_write_addtid_b32 v186 offset:52864
    ds_read_b128 a[64:67], v214 offset:256
    v_pk_mul_f32 v[106:107], v[94:95], v[82:83] op_sel:[0,0] op_sel_hi:[0,1]
    v_pk_mul_f32 v[108:109], v[96:97], v[84:85] op_sel:[0,0] op_sel_hi:[0,1]
    v_pk_mul_f32 v[110:111], v[98:99], v[86:87] op_sel:[0,0] op_sel_hi:[0,1]
    v_pk_fma_f32 v[100:101], v[94:95], v[82:83], v[106:107] op_sel:[1,1,0] op_sel_hi:[1,0,1] neg_lo:[0,1,0]
    v_pk_fma_f32 v[102:103], v[96:97], v[84:85], v[108:109] op_sel:[1,1,0] op_sel_hi:[1,0,1] neg_lo:[0,1,0]
    v_pk_fma_f32 v[104:105], v[98:99], v[86:87], v[110:111] op_sel:[1,1,0] op_sel_hi:[1,0,1] neg_lo:[0,1,0]
    v_cvt_pk_bf16_f32 v188, v100, -v101
    v_cvt_pk_bf16_f32 v189, v102, -v103
    v_cvt_pk_bf16_f32 v190, v104, -v105
    ds_write_addtid_b32 v188 offset:53152
    ds_write_addtid_b32 v189 offset:53408
    ds_write_addtid_b32 v190 offset:53664
    ds_read_b128 a[68:71], v214 offset:320
    v_pk_mul_f32 v[106:107], v[100:101], v[82:83] op_sel:[0,0] op_sel_hi:[0,1]
    v_pk_mul_f32 v[108:109], v[102:103], v[84:85] op_sel:[0,0] op_sel_hi:[0,1]
    v_pk_mul_f32 v[110:111], v[104:105], v[86:87] op_sel:[0,0] op_sel_hi:[0,1]
    v_pk_fma_f32 v[94:95], v[100:101], v[82:83], v[106:107] op_sel:[1,1,0] op_sel_hi:[1,0,1] neg_lo:[0,1,0]
    v_pk_fma_f32 v[96:97], v[102:103], v[84:85], v[108:109] op_sel:[1,1,0] op_sel_hi:[1,0,1] neg_lo:[0,1,0]
    v_pk_fma_f32 v[98:99], v[104:105], v[86:87], v[110:111] op_sel:[1,1,0] op_sel_hi:[1,0,1] neg_lo:[0,1,0]
    v_cvt_pk_bf16_f32 v184, v94, -v95
    v_cvt_pk_bf16_f32 v185, v96, -v97
    v_cvt_pk_bf16_f32 v186, v98, -v99
    ds_write_addtid_b32 v184 offset:53952
    ds_write_addtid_b32 v185 offset:54208
    ds_write_addtid_b32 v186 offset:54464
    ds_read_b128 a[72:75], v214 offset:384
    v_pk_mul_f32 v[106:107], v[94:95], v[82:83] op_sel:[0,0] op_sel_hi:[0,1]
    v_pk_mul_f32 v[108:109], v[96:97], v[84:85] op_sel:[0,0] op_sel_hi:[0,1]
    v_pk_mul_f32 v[110:111], v[98:99], v[86:87] op_sel:[0,0] op_sel_hi:[0,1]
    v_pk_fma_f32 v[100:101], v[94:95], v[82:83], v[106:107] op_sel:[1,1,0] op_sel_hi:[1,0,1] neg_lo:[0,1,0]
    v_pk_fma_f32 v[102:103], v[96:97], v[84:85], v[108:109] op_sel:[1,1,0] op_sel_hi:[1,0,1] neg_lo:[0,1,0]
    v_pk_fma_f32 v[104:105], v[98:99], v[86:87], v[110:111] op_sel:[1,1,0] op_sel_hi:[1,0,1] neg_lo:[0,1,0]
    v_cvt_pk_bf16_f32 v188, v100, -v101
    v_cvt_pk_bf16_f32 v189, v102, -v103
    v_cvt_pk_bf16_f32 v190, v104, -v105
    ds_write_addtid_b32 v188 offset:54752
    ds_write_addtid_b32 v189 offset:55008
    ds_write_addtid_b32 v190 offset:55264
    ds_read_b128 a[76:79], v214 offset:448
    v_pk_mul_f32 v[106:107], v[100:101], v[82:83] op_sel:[0,0] op_sel_hi:[0,1]
    v_pk_mul_f32 v[108:109], v[102:103], v[84:85] op_sel:[0,0] op_sel_hi:[0,1]
    v_pk_mul_f32 v[110:111], v[104:105], v[86:87] op_sel:[0,0] op_sel_hi:[0,1]
    v_pk_fma_f32 v[94:95], v[100:101], v[82:83], v[106:107] op_sel:[1,1,0] op_sel_hi:[1,0,1] neg_lo:[0,1,0]
    v_pk_fma_f32 v[96:97], v[102:103], v[84:85], v[108:109] op_sel:[1,1,0] op_sel_hi:[1,0,1] neg_lo:[0,1,0]
    v_pk_fma_f32 v[98:99], v[104:105], v[86:87], v[110:111] op_sel:[1,1,0] op_sel_hi:[1,0,1] neg_lo:[0,1,0]
    v_cvt_pk_bf16_f32 v184, v94, -v95
    v_cvt_pk_bf16_f32 v185, v96, -v97
    v_cvt_pk_bf16_f32 v186, v98, -v99
    ds_write_addtid_b32 v184 offset:55552
    ds_write_addtid_b32 v185 offset:55808
    ds_write_addtid_b32 v186 offset:56064
    ds_read_b128 a[80:83], v214 offset:512
    v_pk_mul_f32 v[106:107], v[94:95], v[82:83] op_sel:[0,0] op_sel_hi:[0,1]
    v_pk_mul_f32 v[108:109], v[96:97], v[84:85] op_sel:[0,0] op_sel_hi:[0,1]
    v_pk_mul_f32 v[110:111], v[98:99], v[86:87] op_sel:[0,0] op_sel_hi:[0,1]
    v_pk_fma_f32 v[100:101], v[94:95], v[82:83], v[106:107] op_sel:[1,1,0] op_sel_hi:[1,0,1] neg_lo:[0,1,0]
    v_pk_fma_f32 v[102:103], v[96:97], v[84:85], v[108:109] op_sel:[1,1,0] op_sel_hi:[1,0,1] neg_lo:[0,1,0]
    v_pk_fma_f32 v[104:105], v[98:99], v[86:87], v[110:111] op_sel:[1,1,0] op_sel_hi:[1,0,1] neg_lo:[0,1,0]
    v_cvt_pk_bf16_f32 v188, v100, -v101
    v_cvt_pk_bf16_f32 v189, v102, -v103
    v_cvt_pk_bf16_f32 v190, v104, -v105
    ds_write_addtid_b32 v188 offset:56352
    ds_write_addtid_b32 v189 offset:56608
    ds_write_addtid_b32 v190 offset:56864
    global_load_dwordx2 v[16:17], v55, s[16:17] offset:-2560
    ds_read_b128 a[84:87], v214 offset:576
    v_pk_mul_f32 v[106:107], v[100:101], v[82:83] op_sel:[0,0] op_sel_hi:[0,1]
    v_pk_mul_f32 v[108:109], v[102:103], v[84:85] op_sel:[0,0] op_sel_hi:[0,1]
    v_pk_mul_f32 v[110:111], v[104:105], v[86:87] op_sel:[0,0] op_sel_hi:[0,1]
    v_pk_fma_f32 v[94:95], v[100:101], v[82:83], v[106:107] op_sel:[1,1,0] op_sel_hi:[1,0,1] neg_lo:[0,1,0]
    v_pk_fma_f32 v[96:97], v[102:103], v[84:85], v[108:109] op_sel:[1,1,0] op_sel_hi:[1,0,1] neg_lo:[0,1,0]
    v_pk_fma_f32 v[98:99], v[104:105], v[86:87], v[110:111] op_sel:[1,1,0] op_sel_hi:[1,0,1] neg_lo:[0,1,0]
    v_cvt_pk_bf16_f32 v184, v94, -v95
    v_cvt_pk_bf16_f32 v185, v96, -v97
    v_cvt_pk_bf16_f32 v186, v98, -v99
    ds_write_addtid_b32 v184 offset:57152
    ds_write_addtid_b32 v185 offset:57408
    ds_write_addtid_b32 v186 offset:57664
    ds_read_b128 a[88:91], v214 offset:640
    v_pk_mul_f32 v[106:107], v[94:95], v[82:83] op_sel:[0,0] op_sel_hi:[0,1]
    v_pk_mul_f32 v[108:109], v[96:97], v[84:85] op_sel:[0,0] op_sel_hi:[0,1]
    v_pk_mul_f32 v[110:111], v[98:99], v[86:87] op_sel:[0,0] op_sel_hi:[0,1]
    v_pk_fma_f32 v[100:101], v[94:95], v[82:83], v[106:107] op_sel:[1,1,0] op_sel_hi:[1,0,1] neg_lo:[0,1,0]
    v_pk_fma_f32 v[102:103], v[96:97], v[84:85], v[108:109] op_sel:[1,1,0] op_sel_hi:[1,0,1] neg_lo:[0,1,0]
    v_pk_fma_f32 v[104:105], v[98:99], v[86:87], v[110:111] op_sel:[1,1,0] op_sel_hi:[1,0,1] neg_lo:[0,1,0]
    v_cvt_pk_bf16_f32 v188, v100, -v101
    v_cvt_pk_bf16_f32 v189, v102, -v103
    v_cvt_pk_bf16_f32 v190, v104, -v105
    ds_write_addtid_b32 v188 offset:57952
    ds_write_addtid_b32 v189 offset:58208
    ds_write_addtid_b32 v190 offset:58464
    ds_read_b128 a[92:95], v214 offset:704
    v_pk_mul_f32 v[106:107], v[100:101], v[82:83] op_sel:[0,0] op_sel_hi:[0,1]
    v_pk_mul_f32 v[108:109], v[102:103], v[84:85] op_sel:[0,0] op_sel_hi:[0,1]
    v_pk_mul_f32 v[110:111], v[104:105], v[86:87] op_sel:[0,0] op_sel_hi:[0,1]
    v_pk_fma_f32 v[94:95], v[100:101], v[82:83], v[106:107] op_sel:[1,1,0] op_sel_hi:[1,0,1] neg_lo:[0,1,0]
L_pg_c0:
    s_cbranch_execz L_rt_c0
    v_pk_fma_f32 v[96:97], v[102:103], v[84:85], v[108:109] op_sel:[1,1,0] op_sel_hi:[1,0,1] neg_lo:[0,1,0]
    v_pk_fma_f32 v[98:99], v[104:105], v[86:87], v[110:111] op_sel:[1,1,0] op_sel_hi:[1,0,1] neg_lo:[0,1,0]
    v_cvt_pk_bf16_f32 v184, v94, -v95
    v_cvt_pk_bf16_f32 v185, v96, -v97
    v_cvt_pk_bf16_f32 v186, v98, -v99
    ds_write_addtid_b32 v184 offset:58752
    ds_write_addtid_b32 v185 offset:59008
    ds_write_addtid_b32 v186 offset:59264
    v_pk_mul_f32 v[106:107], v[94:95], v[82:83] op_sel:[0,0] op_sel_hi:[0,1]
    v_pk_mul_f32 v[108:109], v[96:97], v[84:85] op_sel:[0,0] op_sel_hi:[0,1]
    v_pk_mul_f32 v[110:111], v[98:99], v[86:87] op_sel:[0,0] op_sel_hi:[0,1]
    v_pk_fma_f32 v[100:101], v[94:95], v[82:83], v[106:107] op_sel:[1,1,0] op_sel_hi:[1,0,1] neg_lo:[0,1,0]
    v_pk_fma_f32 v[102:103], v[96:97], v[84:85], v[108:109] op_sel:[1,1,0] op_sel_hi:[1,0,1] neg_lo:[0,1,0]
    v_pk_fma_f32 v[104:105], v[98:99], v[86:87], v[110:111] op_sel:[1,1,0] op_sel_hi:[1,0,1] neg_lo:[0,1,0]
    v_cvt_pk_bf16_f32 v188, v100, -v101
    v_cvt_pk_bf16_f32 v189, v102, -v103
    v_cvt_pk_bf16_f32 v190, v104, -v105
    ds_write_addtid_b32 v188 offset:59552
    ds_write_addtid_b32 v189 offset:59808
    ds_write_addtid_b32 v190 offset:60064
    v_lshlrev_b32 v56, 2, v0
    buffer_load_dword v57, v56, s[60:63], 0 offen sc1
    v_pk_mul_f32 v[106:107], v[100:101], v[82:83] op_sel:[0,0] op_sel_hi:[0,1]
    v_pk_mul_f32 v[108:109], v[102:103], v[84:85] op_sel:[0,0] op_sel_hi:[0,1]
    v_pk_mul_f32 v[110:111], v[104:105], v[86:87] op_sel:[0,0] op_sel_hi:[0,1]
    v_pk_fma_f32 v[94:95], v[100:101], v[82:83], v[106:107] op_sel:[1,1,0] op_sel_hi:[1,0,1] neg_lo:[0,1,0]
    v_pk_fma_f32 v[96:97], v[102:103], v[84:85], v[108:109] op_sel:[1,1,0] op_sel_hi:[1,0,1] neg_lo:[0,1,0]
    v_pk_fma_f32 v[98:99], v[104:105], v[86:87], v[110:111] op_sel:[1,1,0] op_sel_hi:[1,0,1] neg_lo:[0,1,0]
    v_cvt_pk_bf16_f32 v184, v94, -v95
    v_cvt_pk_bf16_f32 v185, v96, -v97
    v_cvt_pk_bf16_f32 v186, v98, -v99
    ds_write_addtid_b32 v184 offset:60352
    ds_write_addtid_b32 v185 offset:60608
    ds_write_addtid_b32 v186 offset:60864
    v_pk_mul_f32 v[106:107], v[94:95], v[82:83] op_sel:[0,0] op_sel_hi:[0,1]
    v_pk_mul_f32 v[108:109], v[96:97], v[84:85] op_sel:[0,0] op_sel_hi:[0,1]
    v_pk_mul_f32 v[110:111], v[98:99], v[86:87] op_sel:[0,0] op_sel_hi:[0,1]
    v_pk_fma_f32 v[100:101], v[94:95], v[82:83], v[106:107] op_sel:[1,1,0] op_sel_hi:[1,0,1] neg_lo:[0,1,0]
    v_pk_fma_f32 v[102:103], v[96:97], v[84:85], v[108:109] op_sel:[1,1,0] op_sel_hi:[1,0,1] neg_lo:[0,1,0]
    v_pk_fma_f32 v[104:105], v[98:99], v[86:87], v[110:111] op_sel:[1,1,0] op_sel_hi:[1,0,1] neg_lo:[0,1,0]
    v_cvt_pk_bf16_f32 v188, v100, -v101
    v_cvt_pk_bf16_f32 v189, v102, -v103
    v_cvt_pk_bf16_f32 v190, v104, -v105
    ds_write_addtid_b32 v188 offset:61152
    ds_write_addtid_b32 v189 offset:61408
    ds_write_addtid_b32 v190 offset:61664
    v_cvt_pk_bf16_f32 v184, v88, v89
    v_cvt_pk_bf16_f32 v185, v90, v91
    v_cvt_pk_bf16_f32 v186, v92, v93
    s_mov_b32 m0, s4
    s_nop 0
    ds_write_addtid_b32 v184 offset:0
    ds_write_addtid_b32 v185 offset:256
    ds_write_addtid_b32 v186 offset:512
    ds_read_b128 a[0:3], v215 offset:0
    v_pk_mul_f32 v[106:107], v[88:89], v[118:119] op_sel:[0,0] op_sel_hi:[0,1]
    v_pk_mul_f32 v[108:109], v[90:91], v[120:121] op_sel:[0,0] op_sel_hi:[0,1]
    v_pk_mul_f32 v[110:111], v[92:93], v[122:123] op_sel:[0,0] op_sel_hi:[0,1]
    v_pk_fma_f32 v[94:95], v[88:89], v[118:119], v[106:107] op_sel:[1,1,0] op_sel_hi:[1,0,1] neg_lo:[0,1,0]
    v_pk_fma_f32 v[96:97], v[90:91], v[120:121], v[108:109] op_sel:[1,1,0] op_sel_hi:[1,0,1] neg_lo:[0,1,0]
    v_pk_fma_f32 v[98:99], v[92:93], v[122:123], v[110:111] op_sel:[1,1,0] op_sel_hi:[1,0,1] neg_lo:[0,1,0]
    v_cvt_pk_bf16_f32 v188, v94, v95
    v_cvt_pk_bf16_f32 v189, v96, v97
    v_cvt_pk_bf16_f32 v190, v98, v99
    ds_write_addtid_b32 v188 offset:800
    ds_write_addtid_b32 v189 offset:1056
    ds_write_addtid_b32 v190 offset:1312
    ds_read_b128 a[4:7], v215 offset:64
    v_pk_mul_f32 v[106:107], v[88:89], v[124:125] op_sel:[0,0] op_sel_hi:[0,1]
    v_pk_mul_f32 v[108:109], v[90:91], v[126:127] op_sel:[0,0] op_sel_hi:[0,1]
    v_pk_mul_f32 v[110:111], v[92:93], v[128:129] op_sel:[0,0] op_sel_hi:[0,1]
    v_pk_fma_f32 v[94:95], v[88:89], v[124:125], v[106:107] op_sel:[1,1,0] op_sel_hi:[1,0,1] neg_lo:[0,1,0]
    v_pk_fma_f32 v[96:97], v[90:91], v[126:127], v[108:109] op_sel:[1,1,0] op_sel_hi:[1,0,1] neg_lo:[0,1,0]
    v_pk_fma_f32 v[98:99], v[92:93], v[128:129], v[110:111] op_sel:[1,1,0] op_sel_hi:[1,0,1] neg_lo:[0,1,0]
    v_cvt_pk_bf16_f32 v184, v94, v95
    v_cvt_pk_bf16_f32 v185, v96, v97
    v_cvt_pk_bf16_f32 v186, v98, v99
    ds_write_addtid_b32 v184 offset:1600
    ds_write_addtid_b32 v185 offset:1856
    ds_write_addtid_b32 v186 offset:2112
    global_load_dwordx2 v[18:19], v55, s[16:17] offset:-1280
    ds_read_b128 a[8:11], v215 offset:128
    v_pk_mul_f32 v[106:107], v[88:89], v[130:131] op_sel:[0,0] op_sel_hi:[0,1]
    v_pk_mul_f32 v[108:109], v[90:91], v[132:133] op_sel:[0,0] op_sel_hi:[0,1]
    v_pk_mul_f32 v[110:111], v[92:93], v[134:135] op_sel:[0,0] op_sel_hi:[0,1]
    v_pk_fma_f32 v[94:95], v[88:89], v[130:131], v[106:107] op_sel:[1,1,0] op_sel_hi:[1,0,1] neg_lo:[0,1,0]
    v_pk_fma_f32 v[96:97], v[90:91], v[132:133], v[108:109] op_sel:[1,1,0] op_sel_hi:[1,0,1] neg_lo:[0,1,0]
    v_pk_fma_f32 v[98:99], v[92:93], v[134:135], v[110:111] op_sel:[1,1,0] op_sel_hi:[1,0,1] neg_lo:[0,1,0]
    v_cvt_pk_bf16_f32 v188, v94, v95
    v_cvt_pk_bf16_f32 v189, v96, v97
    v_cvt_pk_bf16_f32 v190, v98, v99
    s_waitcnt lgkmcnt(8)
    v_mfma_f32_16x16x32_bf16 v[192:195], a[48:51], a[0:3], 0
    ds_write_addtid_b32 v188 offset:2400
    ds_write_addtid_b32 v189 offset:2656
    ds_write_addtid_b32 v190 offset:2912
    ds_read_b128 a[12:15], v215 offset:192
    v_pk_mul_f32 v[106:107], v[88:89], v[136:137] op_sel:[0,0] op_sel_hi:[0,1]
    v_pk_mul_f32 v[108:109], v[90:91], v[138:139] op_sel:[0,0] op_sel_hi:[0,1]
    v_pk_mul_f32 v[110:111], v[92:93], v[140:141] op_sel:[0,0] op_sel_hi:[0,1]
    v_pk_fma_f32 v[94:95], v[88:89], v[136:137], v[106:107] op_sel:[1,1,0] op_sel_hi:[1,0,1] neg_lo:[0,1,0]
    v_pk_fma_f32 v[96:97], v[90:91], v[138:139], v[108:109] op_sel:[1,1,0] op_sel_hi:[1,0,1] neg_lo:[0,1,0]
    v_pk_fma_f32 v[98:99], v[92:93], v[140:141], v[110:111] op_sel:[1,1,0] op_sel_hi:[1,0,1] neg_lo:[0,1,0]
    v_cvt_pk_bf16_f32 v184, v94, v95
    v_cvt_pk_bf16_f32 v185, v96, v97
    v_cvt_pk_bf16_f32 v186, v98, v99
    s_waitcnt lgkmcnt(8)
    v_mfma_f32_16x16x32_bf16 v[192:195], a[52:55], a[4:7], v[192:195]
    ds_write_addtid_b32 v184 offset:3200
    ds_write_addtid_b32 v185 offset:3456
    ds_write_addtid_b32 v186 offset:3712
    ds_read_b128 a[16:19], v215 offset:256
    v_pk_mul_f32 v[106:107], v[88:89], v[142:143] op_sel:[0,0] op_sel_hi:[0,1]
    v_pk_mul_f32 v[108:109], v[90:91], v[144:145] op_sel:[0,0] op_sel_hi:[0,1]
    v_pk_mul_f32 v[110:111], v[92:93], v[146:147] op_sel:[0,0] op_sel_hi:[0,1]
    v_pk_fma_f32 v[94:95], v[88:89], v[142:143], v[106:107] op_sel:[1,1,0] op_sel_hi:[1,0,1] neg_lo:[0,1,0]
    v_pk_fma_f32 v[96:97], v[90:91], v[144:145], v[108:109] op_sel:[1,1,0] op_sel_hi:[1,0,1] neg_lo:[0,1,0]
    v_pk_fma_f32 v[98:99], v[92:93], v[146:147], v[110:111] op_sel:[1,1,0] op_sel_hi:[1,0,1] neg_lo:[0,1,0]
    v_cvt_pk_bf16_f32 v188, v94, v95
    v_cvt_pk_bf16_f32 v189, v96, v97
    v_cvt_pk_bf16_f32 v190, v98, v99
    s_waitcnt lgkmcnt(8)
    v_mfma_f32_16x16x32_bf16 v[192:195], a[56:59], a[8:11], v[192:195]
    ds_write_addtid_b32 v188 offset:4000
    ds_write_addtid_b32 v189 offset:4256
    ds_write_addtid_b32 v190 offset:4512
    ds_read_b128 a[20:23], v215 offset:320
    v_pk_mul_f32 v[106:107], v[88:89], v[148:149] op_sel:[0,0] op_sel_hi:[0,1]
    v_pk_mul_f32 v[108:109], v[90:91], v[150:151] op_sel:[0,0] op_sel_hi:[0,1]
    v_pk_mul_f32 v[110:111], v[92:93], v[152:153] op_sel:[0,0] op_sel_hi:[0,1]
    v_pk_fma_f32 v[94:95], v[88:89], v[148:149], v[106:107] op_sel:[1,1,0] op_sel_hi:[1,0,1] neg_lo:[0,1,0]
    v_pk_fma_f32 v[96:97], v[90:91], v[150:151], v[108:109] op_sel:[1,1,0] op_sel_hi:[1,0,1] neg_lo:[0,1,0]
    v_pk_fma_f32 v[98:99], v[92:93], v[152:153], v[110:111] op_sel:[1,1,0] op_sel_hi:[1,0,1] neg_lo:[0,1,0]
    v_cvt_pk_bf16_f32 v184, v94, v95
    v_cvt_pk_bf16_f32 v185, v96, v97
    v_cvt_pk_bf16_f32 v186, v98, v99
    s_waitcnt lgkmcnt(8)
    v_mfma_f32_16x16x32_bf16 v[192:195], a[60:63], a[12:15], v[192:195]
    ds_write_addtid_b32 v184 offset:4800
    ds_write_addtid_b32 v185 offset:5056
    ds_write_addtid_b32 v186 offset:5312
    ds_read_b128 a[24:27], v215 offset:384
    v_pk_mul_f32 v[106:107], v[88:89], v[154:155] op_sel:[0,0] op_sel_hi:[0,1]
    v_pk_mul_f32 v[108:109], v[90:91], v[156:157] op_sel:[0,0] op_sel_hi:[0,1]
    v_pk_mul_f32 v[110:111], v[92:93], v[158:159] op_sel:[0,0] op_sel_hi:[0,1]
    v_pk_fma_f32 v[94:95], v[88:89], v[154:155], v[106:107] op_sel:[1,1,0] op_sel_hi:[1,0,1] neg_lo:[0,1,0]
    v_pk_fma_f32 v[96:97], v[90:91], v[156:157], v[108:109] op_sel:[1,1,0] op_sel_hi:[1,0,1] neg_lo:[0,1,0]
    v_pk_fma_f32 v[98:99], v[92:93], v[158:159], v[110:111] op_sel:[1,1,0] op_sel_hi:[1,0,1] neg_lo:[0,1,0]
    v_cvt_pk_bf16_f32 v188, v94, v95
    v_cvt_pk_bf16_f32 v189, v96, v97
    v_cvt_pk_bf16_f32 v190, v98, v99
    s_waitcnt lgkmcnt(8)
    v_mfma_f32_16x16x32_bf16 v[192:195], a[64:67], a[16:19], v[192:195]
    ds_write_addtid_b32 v188 offset:5600
    ds_write_addtid_b32 v189 offset:5856
    ds_write_addtid_b32 v190 offset:6112
    ds_read_b128 a[28:31], v215 offset:448
    v_pk_mul_f32 v[106:107], v[88:89], v[88:89] op_sel:[0,0] op_sel_hi:[0,1]
    v_pk_mul_f32 v[108:109], v[90:91], v[90:91] op_sel:[0,0] op_sel_hi:[0,1]
    v_pk_mul_f32 v[110:111], v[92:93], v[92:93] op_sel:[0,0] op_sel_hi:[0,1]
    v_pk_fma_f32 v[76:77], v[88:89], v[88:89], v[106:107] op_sel:[1,1,0] op_sel_hi:[1,0,1] neg_lo:[0,1,0]
    v_pk_fma_f32 v[78:79], v[90:91], v[90:91], v[108:109] op_sel:[1,1,0] op_sel_hi:[1,0,1] neg_lo:[0,1,0]
    v_pk_fma_f32 v[80:81], v[92:93], v[92:93], v[110:111] op_sel:[1,1,0] op_sel_hi:[1,0,1] neg_lo:[0,1,0]
    v_cvt_pk_bf16_f32 v184, v76, v77
    v_cvt_pk_bf16_f32 v185, v78, v79
    v_cvt_pk_bf16_f32 v186, v80, v81
    s_waitcnt lgkmcnt(8)
    v_mfma_f32_16x16x32_bf16 v[192:195], a[68:71], a[20:23], v[192:195]
    ds_write_addtid_b32 v184 offset:6400
    ds_write_addtid_b32 v185 offset:6656
    ds_write_addtid_b32 v186 offset:6912
    ds_read_b128 a[32:35], v215 offset:512
    v_pk_mul_f32 v[106:107], v[76:77], v[124:125] op_sel:[0,0] op_sel_hi:[0,1]
    v_pk_mul_f32 v[108:109], v[78:79], v[126:127] op_sel:[0,0] op_sel_hi:[0,1]
    v_pk_mul_f32 v[110:111], v[80:81], v[128:129] op_sel:[0,0] op_sel_hi:[0,1]
    v_pk_fma_f32 v[94:95], v[76:77], v[124:125], v[106:107] op_sel:[1,1,0] op_sel_hi:[1,0,1] neg_lo:[0,1,0]
    v_pk_fma_f32 v[96:97], v[78:79], v[126:127], v[108:109] op_sel:[1,1,0] op_sel_hi:[1,0,1] neg_lo:[0,1,0]
    v_pk_fma_f32 v[98:99], v[80:81], v[128:129], v[110:111] op_sel:[1,1,0] op_sel_hi:[1,0,1] neg_lo:[0,1,0]
    v_cvt_pk_bf16_f32 v188, v94, v95
    v_cvt_pk_bf16_f32 v189, v96, v97
    v_cvt_pk_bf16_f32 v190, v98, v99
    s_waitcnt lgkmcnt(8)
    v_mfma_f32_16x16x32_bf16 v[192:195], a[72:75], a[24:27], v[192:195]
    ds_write_addtid_b32 v188 offset:7200
    ds_write_addtid_b32 v189 offset:7456
    ds_write_addtid_b32 v190 offset:7712
    ds_read_b128 a[36:39], v215 offset:576
    v_pk_mul_f32 v[106:107], v[76:77], v[136:137] op_sel:[0,0] op_sel_hi:[0,1]
    v_pk_mul_f32 v[108:109], v[78:79], v[138:139] op_sel:[0,0] op_sel_hi:[0,1]
    v_pk_mul_f32 v[110:111], v[80:81], v[140:141] op_sel:[0,0] op_sel_hi:[0,1]
    v_pk_fma_f32 v[94:95], v[76:77], v[136:137], v[106:107] op_sel:[1,1,0] op_sel_hi:[1,0,1] neg_lo:[0,1,0]
    v_pk_fma_f32 v[96:97], v[78:79], v[138:139], v[108:109] op_sel:[1,1,0] op_sel_hi:[1,0,1] neg_lo:[0,1,0]
    v_pk_fma_f32 v[98:99], v[80:81], v[140:141], v[110:111] op_sel:[1,1,0] op_sel_hi:[1,0,1] neg_lo:[0,1,0]
    v_cvt_pk_bf16_f32 v184, v94, v95
    v_cvt_pk_bf16_f32 v185, v96, v97
    v_cvt_pk_bf16_f32 v186, v98, v99
    s_waitcnt lgkmcnt(8)
    v_mfma_f32_16x16x32_bf16 v[192:195], a[76:79], a[28:31], v[192:195]
    ds_write_addtid_b32 v184 offset:8000
    ds_write_addtid_b32 v185 offset:8256
    ds_write_addtid_b32 v186 offset:8512
    ds_read_b128 a[40:43], v215 offset:640
    v_pk_mul_f32 v[106:107], v[76:77], v[148:149] op_sel:[0,0] op_sel_hi:[0,1]
    v_pk_mul_f32 v[108:109], v[78:79], v[150:151] op_sel:[0,0] op_sel_hi:[0,1]
    v_pk_mul_f32 v[110:111], v[80:81], v[152:153] op_sel:[0,0] op_sel_hi:[0,1]
    v_pk_fma_f32 v[94:95], v[76:77], v[148:149], v[106:107] op_sel:[1,1,0] op_sel_hi:[1,0,1] neg_lo:[0,1,0]
    v_pk_fma_f32 v[96:97], v[78:79], v[150:151], v[108:109] op_sel:[1,1,0] op_sel_hi:[1,0,1] neg_lo:[0,1,0]
    v_pk_fma_f32 v[98:99], v[80:81], v[152:153], v[110:111] op_sel:[1,1,0] op_sel_hi:[1,0,1] neg_lo:[0,1,0]
    v_cvt_pk_bf16_f32 v188, v94, v95
    v_cvt_pk_bf16_f32 v189, v96, v97
    v_cvt_pk_bf16_f32 v190, v98, v99
    s_waitcnt lgkmcnt(8)
    v_mfma_f32_16x16x32_bf16 v[192:195], a[80:83], a[32:35], v[192:195]
    ds_write_addtid_b32 v188 offset:8800
    ds_write_addtid_b32 v189 offset:9056
    ds_write_addtid_b32 v190 offset:9312
    global_load_dwordx2 v[20:21], v55, s[16:17] offset:0
    ds_read_b128 a[44:47], v215 offset:704
    v_pk_mul_f32 v[106:107], v[76:77], v[88:89] op_sel:[0,0] op_sel_hi:[0,1]
    v_pk_mul_f32 v[108:109], v[78:79], v[90:91] op_sel:[0,0] op_sel_hi:[0,1]
    v_pk_mul_f32 v[110:111], v[80:81], v[92:93] op_sel:[0,0] op_sel_hi:[0,1]
    v_pk_fma_f32 v[82:83], v[76:77], v[88:89], v[106:107] op_sel:[1,1,0] op_sel_hi:[1,0,1] neg_lo:[0,1,0]
    v_pk_fma_f32 v[84:85], v[78:79], v[90:91], v[108:109] op_sel:[1,1,0] op_sel_hi:[1,0,1] neg_lo:[0,1,0]
    v_pk_fma_f32 v[86:87], v[80:81], v[92:93], v[110:111] op_sel:[1,1,0] op_sel_hi:[1,0,1] neg_lo:[0,1,0]
    v_cvt_pk_bf16_f32 v184, v82, v83
    v_cvt_pk_bf16_f32 v185, v84, v85
    v_cvt_pk_bf16_f32 v186, v86, v87
    s_waitcnt lgkmcnt(8)
    v_mfma_f32_16x16x32_bf16 v[192:195], a[84:87], a[36:39], v[192:195]
    ds_write_addtid_b32 v184 offset:9600
    ds_write_addtid_b32 v185 offset:9856
    ds_write_addtid_b32 v186 offset:10112
    v_pk_mul_f32 v[106:107], v[82:83], v[124:125] op_sel:[0,0] op_sel_hi:[0,1]
    v_pk_mul_f32 v[108:109], v[84:85], v[126:127] op_sel:[0,0] op_sel_hi:[0,1]
    v_pk_mul_f32 v[110:111], v[86:87], v[128:129] op_sel:[0,0] op_sel_hi:[0,1]
    v_pk_fma_f32 v[94:95], v[82:83], v[124:125], v[106:107] op_sel:[1,1,0] op_sel_hi:[1,0,1] neg_lo:[0,1,0]
    v_pk_fma_f32 v[96:97], v[84:85], v[126:127], v[108:109] op_sel:[1,1,0] op_sel_hi:[1,0,1] neg_lo:[0,1,0]
    v_pk_fma_f32 v[98:99], v[86:87], v[128:129], v[110:111] op_sel:[1,1,0] op_sel_hi:[1,0,1] neg_lo:[0,1,0]
    v_cvt_pk_bf16_f32 v188, v94, v95
    v_cvt_pk_bf16_f32 v189, v96, v97
    v_cvt_pk_bf16_f32 v190, v98, v99
    s_waitcnt lgkmcnt(7)
    v_mfma_f32_16x16x32_bf16 v[192:195], a[88:91], a[40:43], v[192:195]
    ds_write_addtid_b32 v188 offset:10400
    ds_write_addtid_b32 v189 offset:10656
    ds_write_addtid_b32 v190 offset:10912
    v_pk_mul_f32 v[106:107], v[82:83], v[136:137] op_sel:[0,0] op_sel_hi:[0,1]
    v_pk_mul_f32 v[108:109], v[84:85], v[138:139] op_sel:[0,0] op_sel_hi:[0,1]
    v_pk_mul_f32 v[110:111], v[86:87], v[140:141] op_sel:[0,0] op_sel_hi:[0,1]
    v_pk_fma_f32 v[94:95], v[82:83], v[136:137], v[106:107] op_sel:[1,1,0] op_sel_hi:[1,0,1] neg_lo:[0,1,0]
    v_pk_fma_f32 v[96:97], v[84:85], v[138:139], v[108:109] op_sel:[1,1,0] op_sel_hi:[1,0,1] neg_lo:[0,1,0]
    v_pk_fma_f32 v[98:99], v[86:87], v[140:141], v[110:111] op_sel:[1,1,0] op_sel_hi:[1,0,1] neg_lo:[0,1,0]
    v_cvt_pk_bf16_f32 v184, v94, v95
    v_cvt_pk_bf16_f32 v185, v96, v97
    v_cvt_pk_bf16_f32 v186, v98, v99
    s_waitcnt lgkmcnt(6)
    v_mfma_f32_16x16x32_bf16 v[192:195], a[92:95], a[44:47], v[192:195]
    ds_write_addtid_b32 v184 offset:11200
    ds_write_addtid_b32 v185 offset:11456
    ds_write_addtid_b32 v186 offset:11712
    v_pk_mul_f32 v[106:107], v[82:83], v[148:149] op_sel:[0,0] op_sel_hi:[0,1]
    v_pk_mul_f32 v[108:109], v[84:85], v[150:151] op_sel:[0,0] op_sel_hi:[0,1]
    v_pk_mul_f32 v[110:111], v[86:87], v[152:153] op_sel:[0,0] op_sel_hi:[0,1]
    v_pk_fma_f32 v[94:95], v[82:83], v[148:149], v[106:107] op_sel:[1,1,0] op_sel_hi:[1,0,1] neg_lo:[0,1,0]
    v_pk_fma_f32 v[96:97], v[84:85], v[150:151], v[108:109] op_sel:[1,1,0] op_sel_hi:[1,0,1] neg_lo:[0,1,0]
    v_pk_fma_f32 v[98:99], v[86:87], v[152:153], v[110:111] op_sel:[1,1,0] op_sel_hi:[1,0,1] neg_lo:[0,1,0]
    v_cvt_pk_bf16_f32 v188, v94, v95
    v_cvt_pk_bf16_f32 v189, v96, v97
    v_cvt_pk_bf16_f32 v190, v98, v99
    ds_write_addtid_b32 v188 offset:12000
    ds_write_addtid_b32 v189 offset:12256
    ds_write_addtid_b32 v190 offset:12512
    ds_read_b128 a[96:99], v214 offset:0
    ds_read_b128 a[100:103], v214 offset:64
    v_pk_mul_f32 v[106:107], v[82:83], v[88:89] op_sel:[0,0] op_sel_hi:[0,1]
    v_pk_mul_f32 v[108:109], v[84:85], v[90:91] op_sel:[0,0] op_sel_hi:[0,1]
    v_pk_mul_f32 v[110:111], v[86:87], v[92:93] op_sel:[0,0] op_sel_hi:[0,1]
    v_pk_fma_f32 v[76:77], v[82:83], v[88:89], v[106:107] op_sel:[1,1,0] op_sel_hi:[1,0,1] neg_lo:[0,1,0]
    v_pk_fma_f32 v[78:79], v[84:85], v[90:91], v[108:109] op_sel:[1,1,0] op_sel_hi:[1,0,1] neg_lo:[0,1,0]
    v_pk_fma_f32 v[80:81], v[86:87], v[92:93], v[110:111] op_sel:[1,1,0] op_sel_hi:[1,0,1] neg_lo:[0,1,0]
    v_cvt_pk_bf16_f32 v184, v76, v77
    v_cvt_pk_bf16_f32 v185, v78, v79
    v_cvt_pk_bf16_f32 v186, v80, v81
    ds_write2st64_b32 v226, v184, v185 offset0:0 offset1:1
    ds_write_b32 v213, v186 offset:0
    ds_read_b128 a[104:107], v214 offset:128
    ds_read_b128 a[108:111], v214 offset:192
    ds_write_b128 v217, v[192:195]
    v_pk_mul_f32 v[106:107], v[76:77], v[136:137] op_sel:[0,0] op_sel_hi:[0,1]
    v_pk_mul_f32 v[108:109], v[78:79], v[138:139] op_sel:[0,0] op_sel_hi:[0,1]
    v_pk_mul_f32 v[110:111], v[80:81], v[140:141] op_sel:[0,0] op_sel_hi:[0,1]
    v_pk_fma_f32 v[94:95], v[76:77], v[136:137], v[106:107] op_sel:[1,1,0] op_sel_hi:[1,0,1] neg_lo:[0,1,0]
    v_pk_fma_f32 v[96:97], v[78:79], v[138:139], v[108:109] op_sel:[1,1,0] op_sel_hi:[1,0,1] neg_lo:[0,1,0]
    v_pk_fma_f32 v[98:99], v[80:81], v[140:141], v[110:111] op_sel:[1,1,0] op_sel_hi:[1,0,1] neg_lo:[0,1,0]
    v_cvt_pk_bf16_f32 v188, v94, v95
    v_cvt_pk_bf16_f32 v189, v96, v97
    v_cvt_pk_bf16_f32 v190, v98, v99
    ds_write2st64_b32 v227, v188, v189 offset0:0 offset1:1
    ds_write_b32 v213, v190 offset:800
    ds_read_b128 a[112:115], v214 offset:256
    ds_read_b128 a[116:119], v214 offset:320
    v_pk_mul_f32 v[106:107], v[76:77], v[88:89] op_sel:[0,0] op_sel_hi:[0,1]
    v_pk_mul_f32 v[108:109], v[78:79], v[90:91] op_sel:[0,0] op_sel_hi:[0,1]
    v_pk_mul_f32 v[110:111], v[80:81], v[92:93] op_sel:[0,0] op_sel_hi:[0,1]
    v_pk_fma_f32 v[82:83], v[76:77], v[88:89], v[106:107] op_sel:[1,1,0] op_sel_hi:[1,0,1] neg_lo:[0,1,0]
    v_pk_fma_f32 v[84:85], v[78:79], v[90:91], v[108:109] op_sel:[1,1,0] op_sel_hi:[1,0,1] neg_lo:[0,1,0]
    v_pk_fma_f32 v[86:87], v[80:81], v[92:93], v[110:111] op_sel:[1,1,0] op_sel_hi:[1,0,1] neg_lo:[0,1,0]
    s_waitcnt lgkmcnt(10)
    v_mfma_f32_16x16x32_bf16 v[196:199], a[96:99], a[0:3], 0
    s_waitcnt lgkmcnt(9)
    v_cvt_pk_bf16_f32 v184, v82, v83
    v_cvt_pk_bf16_f32 v185, v84, v85
    v_cvt_pk_bf16_f32 v186, v86, v87
    v_mfma_f32_16x16x32_bf16 v[196:199], a[100:103], a[4:7], v[196:199]
    ds_write2st64_b32 v228, v184, v185 offset0:0 offset1:1
    ds_write_b32 v213, v186 offset:1600
    ds_read_b128 a[120:123], v214 offset:384
    ds_read_b128 a[124:127], v214 offset:448
    v_pk_mul_f32 v[106:107], v[82:83], v[136:137] op_sel:[0,0] op_sel_hi:[0,1]
    v_pk_mul_f32 v[108:109], v[84:85], v[138:139] op_sel:[0,0] op_sel_hi:[0,1]
    v_pk_mul_f32 v[110:111], v[86:87], v[140:141] op_sel:[0,0] op_sel_hi:[0,1]
    v_pk_fma_f32 v[94:95], v[82:83], v[136:137], v[106:107] op_sel:[1,1,0] op_sel_hi:[1,0,1] neg_lo:[0,1,0]
    v_pk_fma_f32 v[96:97], v[84:85], v[138:139], v[108:109] op_sel:[1,1,0] op_sel_hi:[1,0,1] neg_lo:[0,1,0]
    v_pk_fma_f32 v[98:99], v[86:87], v[140:141], v[110:111] op_sel:[1,1,0] op_sel_hi:[1,0,1] neg_lo:[0,1,0]
    s_waitcnt lgkmcnt(10)
    v_mfma_f32_16x16x32_bf16 v[196:199], a[104:107], a[8:11], v[196:199]
    s_waitcnt lgkmcnt(9)
    v_cvt_pk_bf16_f32 v188, v94, v95
    v_cvt_pk_bf16_f32 v189, v96, v97
    v_cvt_pk_bf16_f32 v190, v98, v99
    v_mfma_f32_16x16x32_bf16 v[196:199], a[108:111], a[12:15], v[196:199]
    ds_write2st64_b32 v229, v188, v189 offset0:0 offset1:1
    ds_write_b32 v213, v190 offset:2400
    ds_read_b128 a[128:131], v214 offset:512
    ds_read_b128 a[132:135], v214 offset:576
    v_pk_mul_f32 v[106:107], v[82:83], v[88:89] op_sel:[0,0] op_sel_hi:[0,1]
    v_pk_mul_f32 v[108:109], v[84:85], v[90:91] op_sel:[0,0] op_sel_hi:[0,1]
    v_pk_mul_f32 v[110:111], v[86:87], v[92:93] op_sel:[0,0] op_sel_hi:[0,1]
    v_pk_fma_f32 v[76:77], v[82:83], v[88:89], v[106:107] op_sel:[1,1,0] op_sel_hi:[1,0,1] neg_lo:[0,1,0]
    v_pk_fma_f32 v[78:79], v[84:85], v[90:91], v[108:109] op_sel:[1,1,0] op_sel_hi:[1,0,1] neg_lo:[0,1,0]
    v_pk_fma_f32 v[80:81], v[86:87], v[92:93], v[110:111] op_sel:[1,1,0] op_sel_hi:[1,0,1] neg_lo:[0,1,0]
    s_waitcnt lgkmcnt(9)
    v_mfma_f32_16x16x32_bf16 v[196:199], a[112:115], a[16:19], v[196:199]
    s_waitcnt lgkmcnt(8)
    v_cvt_pk_bf16_f32 v184, v76, v77
    v_cvt_pk_bf16_f32 v185, v78, v79
    v_cvt_pk_bf16_f32 v186, v80, v81
    v_mfma_f32_16x16x32_bf16 v[196:199], a[116:119], a[20:23], v[196:199]
    ds_write2st64_b32 v230, v184, v185 offset0:0 offset1:1
    ds_write_b32 v213, v186 offset:3200
    global_load_dwordx2 v[22:23], v55, s[16:17] offset:1280
    ds_read_b128 a[136:139], v214 offset:640
    ds_read_b128 a[140:143], v214 offset:704
    v_pk_mul_f32 v[106:107], v[76:77], v[136:137] op_sel:[0,0] op_sel_hi:[0,1]
    v_pk_mul_f32 v[108:109], v[78:79], v[138:139] op_sel:[0,0] op_sel_hi:[0,1]
    v_pk_mul_f32 v[110:111], v[80:81], v[140:141] op_sel:[0,0] op_sel_hi:[0,1]
    v_pk_fma_f32 v[94:95], v[76:77], v[136:137], v[106:107] op_sel:[1,1,0] op_sel_hi:[1,0,1] neg_lo:[0,1,0]
    v_pk_fma_f32 v[96:97], v[78:79], v[138:139], v[108:109] op_sel:[1,1,0] op_sel_hi:[1,0,1] neg_lo:[0,1,0]
    v_pk_fma_f32 v[98:99], v[80:81], v[140:141], v[110:111] op_sel:[1,1,0] op_sel_hi:[1,0,1] neg_lo:[0,1,0]
    s_waitcnt lgkmcnt(9)
    v_mfma_f32_16x16x32_bf16 v[196:199], a[120:123], a[24:27], v[196:199]
    s_waitcnt lgkmcnt(8)
    v_cvt_pk_bf16_f32 v188, v94, v95
    v_cvt_pk_bf16_f32 v189, v96, v97
    v_cvt_pk_bf16_f32 v190, v98, v99
    v_mfma_f32_16x16x32_bf16 v[196:199], a[124:127], a[28:31], v[196:199]
    ds_write2st64_b32 v231, v188, v189 offset0:0 offset1:1
    ds_write_b32 v213, v190 offset:4000
    v_pk_mul_f32 v[106:107], v[76:77], v[88:89] op_sel:[0,0] op_sel_hi:[0,1]
    v_pk_mul_f32 v[108:109], v[78:79], v[90:91] op_sel:[0,0] op_sel_hi:[0,1]
    v_pk_mul_f32 v[110:111], v[80:81], v[92:93] op_sel:[0,0] op_sel_hi:[0,1]
    v_pk_fma_f32 v[82:83], v[76:77], v[88:89], v[106:107] op_sel:[1,1,0] op_sel_hi:[1,0,1] neg_lo:[0,1,0]
    v_pk_fma_f32 v[84:85], v[78:79], v[90:91], v[108:109] op_sel:[1,1,0] op_sel_hi:[1,0,1] neg_lo:[0,1,0]
    v_pk_fma_f32 v[86:87], v[80:81], v[92:93], v[110:111] op_sel:[1,1,0] op_sel_hi:[1,0,1] neg_lo:[0,1,0]
    s_waitcnt lgkmcnt(7)
    v_mfma_f32_16x16x32_bf16 v[196:199], a[128:131], a[32:35], v[196:199]
    s_waitcnt lgkmcnt(6)
    v_cvt_pk_bf16_f32 v184, v82, v83
    v_cvt_pk_bf16_f32 v185, v84, v85
    v_cvt_pk_bf16_f32 v186, v86, v87
    v_mfma_f32_16x16x32_bf16 v[196:199], a[132:135], a[36:39], v[196:199]
    ds_write2st64_b32 v232, v184, v185 offset0:0 offset1:1
    ds_write_b32 v213, v186 offset:4800
    ds_write_b128 v224, v[204:207] offset:4096
    v_pk_mul_f32 v[106:107], v[82:83], v[136:137] op_sel:[0,0] op_sel_hi:[0,1]
    v_pk_mul_f32 v[108:109], v[84:85], v[138:139] op_sel:[0,0] op_sel_hi:[0,1]
    v_pk_mul_f32 v[110:111], v[86:87], v[140:141] op_sel:[0,0] op_sel_hi:[0,1]
    v_pk_fma_f32 v[94:95], v[82:83], v[136:137], v[106:107] op_sel:[1,1,0] op_sel_hi:[1,0,1] neg_lo:[0,1,0]
    v_pk_fma_f32 v[96:97], v[84:85], v[138:139], v[108:109] op_sel:[1,1,0] op_sel_hi:[1,0,1] neg_lo:[0,1,0]
    v_pk_fma_f32 v[98:99], v[86:87], v[140:141], v[110:111] op_sel:[1,1,0] op_sel_hi:[1,0,1] neg_lo:[0,1,0]
    s_waitcnt lgkmcnt(6)
    v_mfma_f32_16x16x32_bf16 v[196:199], a[136:139], a[40:43], v[196:199]
    s_waitcnt lgkmcnt(5)
    v_cvt_pk_bf16_f32 v188, v94, v95
    v_cvt_pk_bf16_f32 v189, v96, v97
    v_cvt_pk_bf16_f32 v190, v98, v99
    v_mfma_f32_16x16x32_bf16 v[196:199], a[140:143], a[44:47], v[196:199]
    ds_write2st64_b32 v233, v188, v189 offset0:0 offset1:1
    ds_write_b32 v213, v190 offset:5600
    v_pk_mul_f32 v[106:107], v[82:83], v[88:89] op_sel:[0,0] op_sel_hi:[0,1]
    v_pk_mul_f32 v[108:109], v[84:85], v[90:91] op_sel:[0,0] op_sel_hi:[0,1]
    v_pk_mul_f32 v[110:111], v[86:87], v[92:93] op_sel:[0,0] op_sel_hi:[0,1]
    v_pk_fma_f32 v[76:77], v[82:83], v[88:89], v[106:107] op_sel:[1,1,0] op_sel_hi:[1,0,1] neg_lo:[0,1,0]
    v_pk_fma_f32 v[78:79], v[84:85], v[90:91], v[108:109] op_sel:[1,1,0] op_sel_hi:[1,0,1] neg_lo:[0,1,0]
    v_pk_fma_f32 v[80:81], v[86:87], v[92:93], v[110:111] op_sel:[1,1,0] op_sel_hi:[1,0,1] neg_lo:[0,1,0]
    v_cvt_pk_bf16_f32 v184, v76, v77
    v_cvt_pk_bf16_f32 v185, v78, v79
    v_cvt_pk_bf16_f32 v186, v80, v81
    ds_write2st64_b32 v234, v184, v185 offset0:0 offset1:1
    ds_write_b32 v213, v186 offset:6400
    ds_write_b128 v218, v[196:199] offset:1024
    ds_read_b128 v[128:131], v220
    ds_read_b128 v[132:135], v220 offset:16
    ds_read_b128 a[48:51], v216 offset:0
    v_lshrrev_b32 v3, 4, v0
    v_bfe_u32 v4, v0, 2, 2
    v_and_b32 v5, 3, v0
    ds_read_b128 a[52:55], v216 offset:64
    s_mul_i32 s8, s3, 16640
    s_add_u32 s8, s8, 12528
    v_mul_u32_u24 v5, 4160, v5
    ds_read_b128 a[56:59], v216 offset:128
    v_sub_u32 v4, v3, v4
    v_lshl_add_u32 v4, v4, 4, s8
    v_sub_u32 v44, v4, v5
    ds_read_b128 a[60:63], v216 offset:192
    s_mul_i32 s8, s3, 10240
    s_add_u32 s8, s8, 66560
    v_lshl_add_u32 v4, v3, 10, v240
    ds_read_b128 a[64:67], v216 offset:256
    v_add_u32 v45, s8, v4
    s_lshl_b32 s8, s3, 12
    s_add_u32 s8, s8, 107520
    ds_read_b128 a[68:71], v216 offset:320
    v_mul_u32_u24 v4, 768, v3
    v_add3_u32 v46, s8, v4, v240
    s_mul_i32 s8, s3, 1280
    ds_read_b128 a[72:75], v216 offset:384
    s_add_u32 s8, s8, 66816
    v_add_u32 v47, s8, v240
    v_lshrrev_b32 v3, 1, v0
    ds_read_b128 a[76:79], v216 offset:448
    v_xor_b32 v3, v3, v0
    v_bfe_u32 v3, v3, 1, 1
    v_mul_u32_u24 v3, 6, v3
    ds_read_b128 a[80:83], v216 offset:512
    v_xor_b32 v3, v3, v0
    v_lshlrev_b32 v241, 4, v3
    ds_read_b128 a[84:87], v216 offset:576
    ds_read_b128 a[88:91], v216 offset:640
    ds_read_b128 a[92:95], v216 offset:704
    s_waitcnt lgkmcnt(12)
    v_cvt_pk_bf16_f32 v172, v135, v134
    v_cvt_pk_bf16_f32 v173, v133, v132
    v_cvt_pk_bf16_f32 v174, v131, v130
    v_cvt_pk_bf16_f32 v175, v129, v128
    s_mov_b32 exec_hi, 0
    v_cvt_pk_bf16_f32 v172, v132, v131
    v_cvt_pk_bf16_f32 v173, v130, v130
    v_cvt_pk_bf16_f32 v174, v130, v129
    v_cvt_pk_bf16_f32 v175, v128, v128
    s_mov_b32 exec_hi, -1
    s_waitcnt vmcnt(3)
    v_cmp_eq_u32 vcc, 0, v57
    s_nop 1
    s_cbranch_vccnz L_chk1_slow
L_chk1:
    s_mov_b32 s14, 0
    buffer_load_dwordx4 v[24:27], v52, s[48:51], s14 offen sc1
    s_mov_b32 s14, 4096
    buffer_load_dwordx4 v[28:31], v52, s[48:51], s14 offen sc1
    s_mov_b32 s14, 8192
    buffer_load_dwordx4 v[32:35], v52, s[48:51], s14 offen sc1
    s_mov_b32 s14, 12288
    buffer_load_dwordx4 v[36:39], v52, s[48:51], s14 offen sc1
    s_waitcnt lgkmcnt(11)
    v_mfma_f32_16x16x32_bf16 v[200:203], a[48:51], a[0:3], 0
    s_waitcnt lgkmcnt(10)
    v_mfma_f32_16x16x32_bf16 v[200:203], a[52:55], a[4:7], v[200:203]
    ds_write_b128 v221, v[172:175] offset:3072
    s_waitcnt lgkmcnt(10)
    v_mfma_f32_16x16x32_bf16 v[200:203], a[56:59], a[8:11], v[200:203]
    s_waitcnt lgkmcnt(9)
    v_mfma_f32_16x16x32_bf16 v[200:203], a[60:63], a[12:15], v[200:203]
    ds_read_b64 v[176:177], v221 offset:3088
    ds_read_b32 v183, v221 offset:3096
    s_waitcnt lgkmcnt(10)
    v_mfma_f32_16x16x32_bf16 v[200:203], a[64:67], a[16:19], v[200:203]
    s_waitcnt lgkmcnt(9)
    v_mfma_f32_16x16x32_bf16 v[200:203], a[68:71], a[20:23], v[200:203]
    s_waitcnt lgkmcnt(8)
    v_mov_b32 v178, v173
    v_mov_b32 v179, v174
    v_mfma_f32_16x16x32_bf16 v[200:203], a[72:75], a[24:27], v[200:203]
    s_waitcnt lgkmcnt(7)
    v_mov_b32 v180, v175
    v_mfma_f32_16x16x32_bf16 v[200:203], a[76:79], a[28:31], v[200:203]
    s_waitcnt lgkmcnt(6)
    v_mfma_f32_16x16x32_bf16 v[200:203], a[80:83], a[32:35], v[200:203]
    s_waitcnt lgkmcnt(5)
    v_mfma_f32_16x16x32_bf16 v[200:203], a[84:87], a[36:39], v[200:203]
    s_waitcnt lgkmcnt(1)
    ds_write_b128 v221, v[174:177] offset:11392
    v_mfma_f32_16x16x32_bf16 v[200:203], a[88:91], a[40:43], v[200:203]
    v_mfma_f32_16x16x32_bf16 v[200:203], a[92:95], a[44:47], v[200:203]
    v_mov_b32 v181, v176
    v_mov_b32 v182, v177
    ds_write_b128 v221, v[178:181] offset:7232
    s_nop 4
    ds_write_b64 v219, v[200:201] offset:2048
    ds_write_b64 v219, v[202:203] offset:2176
    ds_read_b64 v[124:125], v223 offset:1536
    ds_read_b32 v126, v223 offset:1544
    ds_read_b32 v122, v222 offset:2048
    ds_read_b32 v123, v222 offset:2052
    ds_read_b32 v120, v222 offset:2304
    ds_read_b32 v121, v222 offset:2308
    s_waitcnt lgkmcnt(10)
    ds_write_b128 v221, v[180:183] offset:15552
    s_waitcnt lgkmcnt(5)
    v_cvt_pk_bf16_f32 v160, v126, v126
    v_cvt_pk_bf16_f32 v161, v125, v125
    v_cvt_pk_bf16_f32 v162, v125, v124
    v_cvt_pk_bf16_f32 v163, v124, v124
    ds_write_b128 v221, v[160:163] offset:2048
    ds_read_b64 v[164:165], v221 offset:2064
    ds_read_b32 v171, v221 offset:2072
    s_waitcnt lgkmcnt(6)
    v_cndmask_b32 v127, v122, v123, s[100:101]
    v_cvt_pk_bf16_f32 v148, v123, v123
    v_cvt_pk_bf16_f32 v150, v122, v122
    v_cvt_pk_bf16_f32 v151, v122, v122
    v_cvt_pk_bf16_f32 v149, v123, v127
    ds_write_b128 v221, v[148:151] offset:1024
    ds_read_b64 v[152:153], v221 offset:1040
    ds_read_b32 v159, v221 offset:1048
    s_waitcnt lgkmcnt(7)
    v_cndmask_b32 v127, v120, v121, s[100:101]
    v_cvt_pk_bf16_f32 v136, v121, v121
    v_cvt_pk_bf16_f32 v138, v120, v120
    v_cvt_pk_bf16_f32 v139, v120, v120
    v_cvt_pk_bf16_f32 v137, v121, v127
    ds_write_b128 v221, v[136:139] offset:0
    ds_read_b64 v[140:141], v221 offset:16
    ds_read_b32 v147, v221 offset:24
    v_mov_b32 v166, v161
    v_mov_b32 v167, v162
    v_mov_b32 v168, v163
L_pg_c1:
    s_cbranch_execz L_rt_c1
    s_waitcnt lgkmcnt(7)
    v_mov_b32 v169, v164
    v_mov_b32 v170, v165
    ds_write_b128 v221, v[162:165] offset:10368
    v_mov_b32 v154, v149
    v_mov_b32 v155, v150
    v_mov_b32 v156, v151
    s_waitcnt lgkmcnt(5)
    v_mov_b32 v157, v152
    v_mov_b32 v158, v153
    ds_write_b128 v221, v[166:169] offset:6208
    v_mov_b32 v142, v137
    v_mov_b32 v143, v138
    v_mov_b32 v144, v139
    s_waitcnt lgkmcnt(3)
    v_mov_b32 v145, v140
    v_mov_b32 v146, v141
    ds_write_b128 v221, v[168:171] offset:14528
    v_perm_b32 v104, v10, v8, s6
    v_perm_b32 v105, v14, v12, s6
    s_waitcnt vmcnt(6)
    v_perm_b32 v106, v18, v16, s6
    s_waitcnt vmcnt(4)
    v_perm_b32 v107, v22, v20, s6
    v_perm_b32 v108, v10, v8, s7
    v_perm_b32 v109, v14, v12, s7
    ds_write_b128 v221, v[150:153] offset:9344
    v_perm_b32 v110, v18, v16, s7
    v_perm_b32 v111, v22, v20, s7
    v_perm_b32 v112, v11, v9, s6
    v_perm_b32 v113, v15, v13, s6
    v_perm_b32 v114, v19, v17, s6
    v_perm_b32 v115, v23, v21, s6
    ds_write_b128 v221, v[154:157] offset:5184
    v_perm_b32 v116, v11, v9, s7
    v_perm_b32 v117, v15, v13, s7
    v_perm_b32 v118, v19, v17, s7
    v_perm_b32 v119, v23, v21, s7
    v_lshlrev_b32 v72, 16, v8
    v_and_b32 v73, 0xffff0000, v8
    ds_write_b128 v221, v[156:159] offset:13504
    v_lshlrev_b32 v74, 16, v9
    v_and_b32 v75, 0xffff0000, v9
    v_lshlrev_b32 v76, 16, v10
    v_and_b32 v77, 0xffff0000, v10
    v_lshlrev_b32 v78, 16, v11
    v_and_b32 v79, 0xffff0000, v11
    ds_write_b128 v221, v[138:141] offset:8320
    v_lshlrev_b32 v80, 16, v12
    v_and_b32 v81, 0xffff0000, v12
    v_lshlrev_b32 v82, 16, v13
    v_and_b32 v83, 0xffff0000, v13
    v_lshlrev_b32 v84, 16, v14
    v_and_b32 v85, 0xffff0000, v14
    ds_write_b128 v221, v[142:145] offset:4160
    v_lshlrev_b32 v86, 16, v15
    v_and_b32 v87, 0xffff0000, v15
    v_lshlrev_b32 v88, 16, v16
    v_and_b32 v89, 0xffff0000, v16
    v_lshlrev_b32 v90, 16, v17
    v_and_b32 v91, 0xffff0000, v17
    s_waitcnt lgkmcnt(8)
    ds_write_b128 v221, v[144:147] offset:12480
    v_lshlrev_b32 v92, 16, v18
    v_and_b32 v93, 0xffff0000, v18
    v_lshlrev_b32 v94, 16, v19
    v_and_b32 v95, 0xffff0000, v19
    v_lshlrev_b32 v96, 16, v20
    v_and_b32 v97, 0xffff0000, v20
    s_barrier
    ds_write_b128 v225, v[104:107] offset:0
    v_lshlrev_b32 v98, 16, v21
    v_and_b32 v99, 0xffff0000, v21
    v_lshlrev_b32 v100, 16, v22
    v_and_b32 v101, 0xffff0000, v22
    v_lshlrev_b32 v102, 16, v23
    v_and_b32 v103, 0xffff0000, v23
    ds_write_b128 v225, v[108:111] offset:4096
    s_waitcnt vmcnt(2)
    v_min3_u32 v2, v24, v26, v28
    s_waitcnt vmcnt(1)
    v_min3_u32 v2, v2, v30, v32
    s_waitcnt vmcnt(0)
    v_min3_u32 v2, v2, v34, v36
    v_min_u32 v2, v2, v38
    v_cmp_eq_u32 vcc, 0, v2
    s_nop 1
    s_cbranch_vccnz L_chk3_slow
L_chk3:
    ds_write_b128 v225, v[112:115] offset:8192
    v_pk_fma_f32 v[72:73], v[72:73], v[24:25], v[24:25] op_sel:[0,0,1] op_sel_hi:[1,0,1]
    v_pk_fma_f32 v[74:75], v[74:75], v[24:25], v[24:25] op_sel:[0,0,1] op_sel_hi:[1,0,1]
    v_pk_fma_f32 v[76:77], v[76:77], v[26:27], v[26:27] op_sel:[0,0,1] op_sel_hi:[1,0,1]
    v_pk_fma_f32 v[78:79], v[78:79], v[26:27], v[26:27] op_sel:[0,0,1] op_sel_hi:[1,0,1]
    v_pk_fma_f32 v[80:81], v[80:81], v[28:29], v[28:29] op_sel:[0,0,1] op_sel_hi:[1,0,1]
    ds_write_b128 v225, v[116:119] offset:12288
    v_pk_fma_f32 v[82:83], v[82:83], v[28:29], v[28:29] op_sel:[0,0,1] op_sel_hi:[1,0,1]
    v_pk_fma_f32 v[84:85], v[84:85], v[30:31], v[30:31] op_sel:[0,0,1] op_sel_hi:[1,0,1]
    v_pk_fma_f32 v[86:87], v[86:87], v[30:31], v[30:31] op_sel:[0,0,1] op_sel_hi:[1,0,1]
    v_pk_fma_f32 v[88:89], v[88:89], v[32:33], v[32:33] op_sel:[0,0,1] op_sel_hi:[1,0,1]
    v_pk_fma_f32 v[90:91], v[90:91], v[32:33], v[32:33] op_sel:[0,0,1] op_sel_hi:[1,0,1]
    ds_write_b128 v45, v[204:207] offset:5120
    v_pk_fma_f32 v[92:93], v[92:93], v[34:35], v[34:35] op_sel:[0,0,1] op_sel_hi:[1,0,1]
    v_pk_fma_f32 v[94:95], v[94:95], v[34:35], v[34:35] op_sel:[0,0,1] op_sel_hi:[1,0,1]
    v_pk_fma_f32 v[96:97], v[96:97], v[36:37], v[36:37] op_sel:[0,0,1] op_sel_hi:[1,0,1]
    v_pk_fma_f32 v[98:99], v[98:99], v[36:37], v[36:37] op_sel:[0,0,1] op_sel_hi:[1,0,1]
    v_pk_fma_f32 v[100:101], v[100:101], v[38:39], v[38:39] op_sel:[0,0,1] op_sel_hi:[1,0,1]
    ds_write_b128 v45, v[204:207] offset:0
    v_pk_fma_f32 v[102:103], v[102:103], v[38:39], v[38:39] op_sel:[0,0,1] op_sel_hi:[1,0,1]
    v_cvt_pk_bf16_f32 v104, v72, v76
    v_cvt_pk_bf16_f32 v105, v80, v84
    v_cvt_pk_bf16_f32 v106, v88, v92
    v_cvt_pk_bf16_f32 v107, v96, v100
    ds_write_b128 v47, v[104:107] offset:5120
    v_cvt_pk_bf16_f32 v108, v73, v77
    v_cvt_pk_bf16_f32 v109, v81, v85
    v_cvt_pk_bf16_f32 v110, v89, v93
    v_cvt_pk_bf16_f32 v111, v97, v101
    s_bfe_u32 s4, s2, 0x10002
    s_lshl_b32 s4, s4, 3
    s_lshr_b32 s6, s2, 5
    s_bfe_u32 s5, s2, 0x20003
    s_lshl_b32 s7, s5, 1
    s_add_u32 s6, s6, s7
    s_and_b32 s6, s6, 7
    s_add_u32 s64, s4, s6
    s_and_b32 s4, s2, 3
    ds_write_b128 v47, v[108:111] offset:15360
    v_cvt_pk_bf16_f32 v112, v74, v78
    v_cvt_pk_bf16_f32 v113, v82, v86
    v_cvt_pk_bf16_f32 v114, v90, v94
    v_cvt_pk_bf16_f32 v115, v98, v102
    s_lshl_b32 s4, s4, 2
    s_add_u32 s65, s4, s5
    s_and_b32 s66, s2, 1
    s_and_b32 s4, s2, 2
    s_lshl_b32 s4, s4, 1
    s_add_u32 s67, s4, s5
    s_mul_i32 s72, s64, 163840
    s_mul_i32 s73, s3, 5120
    s_add_u32 s72, s72, s73
    ds_write_b128 v47, v[112:115] offset:25600
    v_cvt_pk_bf16_f32 v116, v75, v79
    v_cvt_pk_bf16_f32 v117, v83, v87
    v_cvt_pk_bf16_f32 v118, v91, v95
    v_cvt_pk_bf16_f32 v119, v99, v103
    s_add_u32 s72, s72, 6946816
    s_lshl_b32 s6, s65, 2
    s_add_u32 s6, s6, s3
    s_mul_i32 s68, s6, 61440
    s_add_u32 s68, s68, 1048576
    s_lshl_b32 s6, s67, 2
    s_add_u32 s6, s6, s3
    s_mul_i32 s70, s6, 61440
    s_add_u32 s70, s70, 4980736
    ds_write_b128 v47, v[116:119] offset:35840
    s_mul_i32 s4, s65, 3
    s_lshr_b32 s4, s4, 2
    s_min_u32 s4, s4, 10
    s_lshl_b32 s4, s4, 10
    s_add_u32 s4, s4, 118784
    v_and_b32 v56, 15, v0
    v_lshl_add_u32 v56, v56, 7, s4
    v_and_b32 v58, 4294966527, v56
    buffer_load_dword v59, v58, s[48:51], 0 offen sc1
    ds_read_b128 v[152:155], v44 offset:4032
    ds_read_b128 v[156:159], v44 offset:3008
    ds_read_b128 v[160:163], v44 offset:1984
    ds_read_b128 v[164:167], v44 offset:960
    s_waitcnt lgkmcnt(0)
    s_barrier
    ds_read_b128 v[24:27], v46 offset:0
    ds_read_b128 v[168:171], v45 offset:5376
    ds_read_b128 v[28:31], v46 offset:256
    ds_read_b128 v[172:175], v45 offset:5632
    ds_read_b128 v[32:35], v46 offset:512
    ds_read_b128 v[176:179], v45 offset:5888
    ds_read_b128 v[36:39], v46 offset:768
    ds_read_b128 v[180:183], v45 offset:6144
    s_waitcnt lgkmcnt(7)
    v_and_b32 v120, 0xffff0000, v24
    v_and_b32 v121, 0xffff0000, v25
    v_and_b32 v122, 0xffff0000, v26
    v_and_b32 v123, 0xffff0000, v27
    s_waitcnt lgkmcnt(5)
    v_and_b32 v124, 0xffff0000, v28
    v_and_b32 v125, 0xffff0000, v29
    v_and_b32 v126, 0xffff0000, v30
    v_and_b32 v127, 0xffff0000, v31
    s_waitcnt lgkmcnt(3)
    v_and_b32 v128, 0xffff0000, v32
    v_and_b32 v129, 0xffff0000, v33
    v_and_b32 v130, 0xffff0000, v34
    v_and_b32 v131, 0xffff0000, v35
    s_waitcnt lgkmcnt(1)
    v_and_b32 v132, 0xffff0000, v36
    v_and_b32 v133, 0xffff0000, v37
    v_and_b32 v134, 0xffff0000, v38
    v_and_b32 v135, 0xffff0000, v39
    v_mfma_f32_16x16x32_bf16 v[120:123], v[152:155], v[168:171], v[120:123]
    ds_read_b128 v[184:187], v44 offset:3968
    ds_read_b128 v[200:203], v45 offset:5360
    s_add_u32 s4, s3, 1
    v_mfma_f32_16x16x32_bf16 v[120:123], v[40:43], v[168:171], v[120:123]
    ds_read_b128 v[188:191], v44 offset:2944
    v_lshlrev_b32 v136, 16, v24
    v_lshlrev_b32 v137, 16, v25
    v_mfma_f32_16x16x32_bf16 v[124:127], v[152:155], v[172:175], v[124:127]
    ds_read_b128 v[204:207], v45 offset:5616
    s_lshr_b32 s4, s4, 2
    s_mul_i32 s4, s4, 5104
    v_mfma_f32_16x16x32_bf16 v[124:127], v[156:159], v[168:171], v[124:127]
    s_sub_u32 s4, 1280, s4
    v_lshlrev_b32 v138, 16, v26
    v_lshlrev_b32 v139, 16, v27
    v_mfma_f32_16x16x32_bf16 v[124:127], v[40:43], v[172:175], v[124:127]
    ds_read_b128 v[192:195], v44 offset:1920
    v_lshlrev_b32 v140, 16, v28
    v_lshlrev_b32 v141, 16, v29
    v_mfma_f32_16x16x32_bf16 v[128:131], v[152:155], v[176:179], v[128:131]
    ds_read_b128 v[208:211], v45 offset:5872
    v_mfma_f32_16x16x32_bf16 v[128:131], v[156:159], v[172:175], v[128:131]
    v_lshlrev_b32 v142, 16, v30
    v_lshlrev_b32 v143, 16, v31
    v_mfma_f32_16x16x32_bf16 v[128:131], v[160:163], v[168:171], v[128:131]
    ds_read_b128 v[196:199], v44 offset:896
    v_lshlrev_b32 v144, 16, v32
    v_lshlrev_b32 v145, 16, v33
    v_mfma_f32_16x16x32_bf16 v[128:131], v[40:43], v[176:179], v[128:131]
    ds_read_b128 v[212:215], v45 offset:6128
    s_waitcnt lgkmcnt(8)
    v_mfma_f32_16x16x32_bf16 v[132:135], v[152:155], v[180:183], v[132:135]
    v_lshlrev_b32 v146, 16, v34
    v_lshlrev_b32 v147, 16, v35
    v_mfma_f32_16x16x32_bf16 v[132:135], v[156:159], v[176:179], v[132:135]
    v_lshlrev_b32 v148, 16, v36
    v_lshlrev_b32 v149, 16, v37
    v_mfma_f32_16x16x32_bf16 v[132:135], v[160:163], v[172:175], v[132:135]
    v_lshlrev_b32 v150, 16, v38
    v_lshlrev_b32 v151, 16, v39
    v_mfma_f32_16x16x32_bf16 v[132:135], v[164:167], v[168:171], v[132:135]
    s_waitcnt lgkmcnt(4)
    v_mfma_f32_16x16x32_bf16 v[132:135], v[40:43], v[180:183], v[132:135]
    v_mfma_f32_16x16x32_bf16 v[120:123], v[184:187], v[200:203], v[120:123]
    ds_read_b128 v[152:155], v44 offset:3904
    ds_read_b128 v[168:171], v45 offset:5344
    v_add_u32 v48, s4, v47
    v_mfma_f32_16x16x32_bf16 v[124:127], v[184:187], v[204:207], v[124:127]
    ds_read_b128 v[156:159], v44 offset:2880
    v_cvt_pk_bf16_f32 v8, 0, v72
    v_cvt_pk_bf16_f32 v9, v76, v80
    v_mfma_f32_16x16x32_bf16 v[124:127], v[188:191], v[200:203], v[124:127]
    ds_read_b128 v[172:175], v45 offset:5600
    s_waitcnt lgkmcnt(6)
    s_mul_i32 s5, s3, 2112
    v_mfma_f32_16x16x32_bf16 v[128:131], v[184:187], v[208:211], v[128:131]
    s_add_u32 s5, s5, 107520
    v_cvt_pk_bf16_f32 v10, v84, v88
    v_cvt_pk_bf16_f32 v11, v92, v96
    v_mfma_f32_16x16x32_bf16 v[128:131], v[188:191], v[204:207], v[128:131]
    ds_read_b128 v[160:163], v44 offset:1856
    v_cvt_pk_bf16_f32 v12, 0, v73
    v_cvt_pk_bf16_f32 v13, v77, v81
    v_mfma_f32_16x16x32_bf16 v[128:131], v[192:195], v[200:203], v[128:131]
    ds_read_b128 v[176:179], v45 offset:5856
    s_waitcnt lgkmcnt(6)
    v_lshrrev_b32 v2, 4, v0
    v_mfma_f32_16x16x32_bf16 v[132:135], v[184:187], v[212:215], v[132:135]
    v_cvt_pk_bf16_f32 v14, v85, v89
    v_cvt_pk_bf16_f32 v15, v93, v97
    v_mfma_f32_16x16x32_bf16 v[132:135], v[188:191], v[208:211], v[132:135]
    ds_read_b128 v[164:167], v44 offset:832
    v_cvt_pk_bf16_f32 v16, 0, v74
    v_cvt_pk_bf16_f32 v17, v78, v82
    v_mfma_f32_16x16x32_bf16 v[132:135], v[192:195], v[204:207], v[132:135]
    ds_read_b128 v[180:183], v45 offset:6112
    s_waitcnt lgkmcnt(4)
    s_waitcnt vmcnt(0)
    v_cmp_gt_u32 vcc, 1, v59
    v_mfma_f32_16x16x32_bf16 v[132:135], v[196:199], v[200:203], v[132:135]
    s_cbranch_vccnz L_chk7_slow
L_chk7:
    v_mfma_f32_16x16x32_bf16 v[120:123], v[152:155], v[168:171], v[120:123]
    ds_read_b128 v[184:187], v44 offset:3840
    ds_read_b128 v[200:203], v45 offset:5328
    v_mul_u32_u24 v2, 528, v2
    v_mfma_f32_16x16x32_bf16 v[124:127], v[152:155], v[172:175], v[124:127]
    ds_read_b128 v[188:191], v44 offset:2816
    v_cvt_pk_bf16_f32 v18, v86, v90
    v_cvt_pk_bf16_f32 v19, v94, v98
    v_mfma_f32_16x16x32_bf16 v[124:127], v[156:159], v[168:171], v[124:127]
    ds_read_b128 v[204:207], v45 offset:5584
    s_waitcnt lgkmcnt(6)
    v_and_b32 v3, 1, v0
    v_mfma_f32_16x16x32_bf16 v[128:131], v[152:155], v[176:179], v[128:131]
    s_add_u32 s69, s68, 0
    v_cvt_pk_bf16_f32 v20, 0, v75
    v_cvt_pk_bf16_f32 v21, v79, v83
    v_mfma_f32_16x16x32_bf16 v[128:131], v[156:159], v[172:175], v[128:131]
    ds_read_b128 v[192:195], v44 offset:1792
    v_cvt_pk_bf16_f32 v22, v87, v91
    v_cvt_pk_bf16_f32 v23, v95, v99
    v_mfma_f32_16x16x32_bf16 v[128:131], v[160:163], v[168:171], v[128:131]
    ds_read_b128 v[208:211], v45 offset:5840
    s_waitcnt lgkmcnt(6)
    v_lshl_add_u32 v2, v3, 8, v2
    v_mfma_f32_16x16x32_bf16 v[132:135], v[152:155], v[180:183], v[132:135]
    buffer_load_dwordx4 a[0:3], v241, s[48:51], s69 offen offset:0 sc1
    buffer_load_dwordx4 a[4:7], v241, s[48:51], s69 offen offset:1024 sc1
    v_mfma_f32_16x16x32_bf16 v[132:135], v[156:159], v[176:179], v[132:135]
    ds_read_b128 v[196:199], v44 offset:768
    buffer_load_dword v57, v56, s[48:51], 0 offen sc1
    v_mfma_f32_16x16x32_bf16 v[132:135], v[160:163], v[172:175], v[132:135]
    ds_read_b128 v[212:215], v45 offset:6096
    s_waitcnt lgkmcnt(4)
    v_bfe_u32 v3, v0, 1, 3
    v_mfma_f32_16x16x32_bf16 v[132:135], v[164:167], v[168:171], v[132:135]
    ds_write_b128 v47, v[8:11] offset:0
    v_mfma_f32_16x16x32_bf16 v[120:123], v[184:187], v[200:203], v[120:123]
    ds_read_b128 v[152:155], v44 offset:3776
    ds_read_b128 v[168:171], v45 offset:5312
    v_lshl_add_u32 v2, v3, 3, v2
    v_mfma_f32_16x16x32_bf16 v[124:127], v[184:187], v[204:207], v[124:127]
    ds_read_b128 v[156:159], v44 offset:2752
    v_add_u32 v49, s5, v2
    v_and_b32 v2, 15, v0
    v_mfma_f32_16x16x32_bf16 v[124:127], v[188:191], v[200:203], v[124:127]
    ds_read_b128 v[172:175], v45 offset:5568
    s_waitcnt lgkmcnt(7)
    v_mul_u32_u24 v2, 528, v2
    v_mfma_f32_16x16x32_bf16 v[128:131], v[184:187], v[208:211], v[128:131]
    buffer_load_dwordx4 a[8:11], v241, s[48:51], s69 offen offset:2048 sc1
    v_mfma_f32_16x16x32_bf16 v[128:131], v[188:191], v[204:207], v[128:131]
    ds_read_b128 v[160:163], v44 offset:1728
    v_mfma_f32_16x16x32_bf16 v[128:131], v[192:195], v[200:203], v[128:131]
    ds_read_b128 v[176:179], v45 offset:5824
    s_waitcnt lgkmcnt(7)
    v_mfma_f32_16x16x32_bf16 v[132:135], v[184:187], v[212:215], v[132:135]
    buffer_load_dwordx4 a[12:15], v241, s[48:51], s69 offen offset:3072 sc1
    v_mfma_f32_16x16x32_bf16 v[132:135], v[188:191], v[208:211], v[132:135]
    ds_read_b128 v[164:167], v44 offset:704
    v_mfma_f32_16x16x32_bf16 v[132:135], v[192:195], v[204:207], v[132:135]
    ds_read_b128 v[180:183], v45 offset:6080
    s_waitcnt lgkmcnt(4)
    v_mfma_f32_16x16x32_bf16 v[132:135], v[196:199], v[200:203], v[132:135]
    ds_write_b128 v47, v[12:15] offset:10240
    v_mfma_f32_16x16x32_bf16 v[120:123], v[152:155], v[168:171], v[120:123]
    ds_read_b128 v[184:187], v44 offset:3712
    ds_read_b128 v[200:203], v45 offset:5296
    v_lshrrev_b32 v3, 4, v0
    v_mfma_f32_16x16x32_bf16 v[124:127], v[152:155], v[172:175], v[124:127]
    ds_read_b128 v[188:191], v44 offset:2688
    v_lshl_add_u32 v2, v3, 3, v2
    s_lshl_b32 s5, s3, 6
    v_mfma_f32_16x16x32_bf16 v[124:127], v[156:159], v[168:171], v[124:127]
    ds_read_b128 v[204:207], v45 offset:5552
    s_waitcnt lgkmcnt(7)
    s_add_u32 s5, s5, 107520
    v_mfma_f32_16x16x32_bf16 v[128:131], v[152:155], v[176:179], v[128:131]
    s_add_u32 s69, s68, 4096
    buffer_load_dwordx4 a[16:19], v241, s[48:51], s69 offen offset:0 sc1
    v_mfma_f32_16x16x32_bf16 v[128:131], v[156:159], v[172:175], v[128:131]
    ds_read_b128 v[192:195], v44 offset:1664
    v_mfma_f32_16x16x32_bf16 v[128:131], v[160:163], v[168:171], v[128:131]
    ds_read_b128 v[208:211], v45 offset:5808
    s_waitcnt lgkmcnt(7)
    v_mfma_f32_16x16x32_bf16 v[132:135], v[152:155], v[180:183], v[132:135]
    buffer_load_dwordx4 a[20:23], v241, s[48:51], s69 offen offset:1024 sc1
    v_mfma_f32_16x16x32_bf16 v[132:135], v[156:159], v[176:179], v[132:135]
    ds_read_b128 v[196:199], v44 offset:640
    v_mfma_f32_16x16x32_bf16 v[132:135], v[160:163], v[172:175], v[132:135]
    ds_read_b128 v[212:215], v45 offset:6064
    s_waitcnt lgkmcnt(4)
    v_mfma_f32_16x16x32_bf16 v[132:135], v[164:167], v[168:171], v[132:135]
    ds_write_b128 v47, v[16:19] offset:20480
    v_mfma_f32_16x16x32_bf16 v[120:123], v[184:187], v[200:203], v[120:123]
    ds_read_b128 v[152:155], v44 offset:3648
    ds_read_b128 v[168:171], v45 offset:5280
    v_add_u32 v50, s5, v2
    v_mfma_f32_16x16x32_bf16 v[124:127], v[184:187], v[204:207], v[124:127]
    ds_read_b128 v[156:159], v44 offset:2624
    s_and_b32 s6, s15, 1
    s_bfe_u32 s4, s15, 0x20001
    v_mfma_f32_16x16x32_bf16 v[124:127], v[188:191], v[200:203], v[124:127]
    ds_read_b128 v[172:175], v45 offset:5536
    s_waitcnt lgkmcnt(7)
    s_lshl2_add_u32 s6, s6, s4
    v_mfma_f32_16x16x32_bf16 v[128:131], v[184:187], v[208:211], v[128:131]
    buffer_load_dwordx4 a[24:27], v241, s[48:51], s69 offen offset:2048 sc1
    v_mfma_f32_16x16x32_bf16 v[128:131], v[188:191], v[204:207], v[128:131]
    ds_read_b128 v[160:163], v44 offset:1600
    v_mfma_f32_16x16x32_bf16 v[128:131], v[192:195], v[200:203], v[128:131]
    ds_read_b128 v[176:179], v45 offset:5792
    s_waitcnt lgkmcnt(7)
    v_mfma_f32_16x16x32_bf16 v[132:135], v[184:187], v[212:215], v[132:135]
    buffer_load_dwordx4 a[28:31], v241, s[48:51], s69 offen offset:3072 sc1
    v_mfma_f32_16x16x32_bf16 v[132:135], v[188:191], v[208:211], v[132:135]
    ds_read_b128 v[164:167], v44 offset:576
    v_mfma_f32_16x16x32_bf16 v[132:135], v[192:195], v[204:207], v[132:135]
    ds_read_b128 v[180:183], v45 offset:6048
    s_waitcnt lgkmcnt(4)
    v_mfma_f32_16x16x32_bf16 v[132:135], v[196:199], v[200:203], v[132:135]
    ds_write_b128 v47, v[20:23] offset:30720
    v_mfma_f32_16x16x32_bf16 v[120:123], v[152:155], v[168:171], v[120:123]
    ds_read_b128 v[184:187], v44 offset:3584
    ds_read_b128 v[200:203], v45 offset:5264
    s_andn2_b32 s4, s15, 7
    v_mfma_f32_16x16x32_bf16 v[124:127], v[152:155], v[172:175], v[124:127]
    ds_read_b128 v[188:191], v44 offset:2560
    s_add_u32 s6, s6, s4
    s_lshl_b32 s6, s6, 7
    v_mfma_f32_16x16x32_bf16 v[124:127], v[156:159], v[168:171], v[124:127]
    ds_read_b128 v[204:207], v45 offset:5520
    s_waitcnt lgkmcnt(7)
    s_mul_i32 s5, s3, 655360
    v_mfma_f32_16x16x32_bf16 v[128:131], v[152:155], v[176:179], v[128:131]
    s_add_u32 s69, s68, 8192
    buffer_load_dwordx4 a[32:35], v241, s[48:51], s69 offen offset:0 sc1
    v_mfma_f32_16x16x32_bf16 v[128:131], v[156:159], v[172:175], v[128:131]
    ds_read_b128 v[192:195], v44 offset:1536
    v_mfma_f32_16x16x32_bf16 v[128:131], v[160:163], v[168:171], v[128:131]
    ds_read_b128 v[208:211], v45 offset:5776
    s_waitcnt lgkmcnt(7)
    v_mfma_f32_16x16x32_bf16 v[132:135], v[152:155], v[180:183], v[132:135]
    buffer_load_dwordx4 a[36:39], v241, s[48:51], s69 offen offset:1024 sc1
    v_mfma_f32_16x16x32_bf16 v[132:135], v[156:159], v[176:179], v[132:135]
    ds_read_b128 v[196:199], v44 offset:512
    s_waitcnt vmcnt(8)
    v_cmp_gt_u32 vcc, 1, v57
    v_mfma_f32_16x16x32_bf16 v[132:135], v[160:163], v[172:175], v[132:135]
    ds_read_b128 v[212:215], v45 offset:6032
    s_waitcnt lgkmcnt(4)
    s_cbranch_vccnz L_chk5_slow
L_chk5:
    v_mfma_f32_16x16x32_bf16 v[132:135], v[164:167], v[168:171], v[132:135]
    buffer_load_dwordx4 a[40:43], v241, s[48:51], s69 offen offset:2048 sc1
    v_mfma_f32_16x16x32_bf16 v[120:123], v[184:187], v[200:203], v[120:123]
    ds_read_b128 v[152:155], v44 offset:3520
    ds_read_b128 v[168:171], v45 offset:5248
    s_add_u32 s5, s5, s6
    v_mfma_f32_16x16x32_bf16 v[124:127], v[184:187], v[204:207], v[124:127]
    ds_read_b128 v[156:159], v44 offset:2496
    s_add_u32 s5, s5, 6946816
    v_lshrrev_b32 v2, 5, v0
    v_mfma_f32_16x16x32_bf16 v[124:127], v[188:191], v[200:203], v[124:127]
    ds_read_b128 v[172:175], v45 offset:5504
    s_waitcnt lgkmcnt(6)
    v_bfe_u32 v3, v0, 3, 2
    v_mfma_f32_16x16x32_bf16 v[128:131], v[184:187], v[208:211], v[128:131]
    buffer_load_dwordx4 a[44:47], v241, s[48:51], s69 offen offset:3072 sc1
    v_mfma_f32_16x16x32_bf16 v[128:131], v[188:191], v[204:207], v[128:131]
    ds_read_b128 v[160:163], v44 offset:1472
    v_mfma_f32_16x16x32_bf16 v[128:131], v[192:195], v[200:203], v[128:131]
    ds_read_b128 v[176:179], v45 offset:5760
    s_waitcnt lgkmcnt(6)
    v_mfma_f32_16x16x32_bf16 v[132:135], v[184:187], v[212:215], v[132:135]
    s_add_u32 s69, s68, 12288
    buffer_load_dwordx4 a[48:51], v241, s[48:51], s69 offen offset:0 sc1
    v_mfma_f32_16x16x32_bf16 v[132:135], v[188:191], v[208:211], v[132:135]
    ds_read_b128 v[164:167], v44 offset:448
    s_barrier
    v_mfma_f32_16x16x32_bf16 v[132:135], v[192:195], v[204:207], v[132:135]
    ds_read_b128 v[180:183], v45 offset:6016
    s_waitcnt lgkmcnt(4)
    v_mfma_f32_16x16x32_bf16 v[132:135], v[196:199], v[200:203], v[132:135]
    buffer_load_dwordx4 a[52:55], v241, s[48:51], s69 offen offset:1024 sc1
    v_mfma_f32_16x16x32_bf16 v[120:123], v[152:155], v[168:171], v[120:123]
    ds_read_b128 v[184:187], v44 offset:3456
    ds_read_b128 v[200:203], v45 offset:5232
    v_lshl_add_u32 v2, v2, 3, v3
    v_mfma_f32_16x16x32_bf16 v[124:127], v[152:155], v[172:175], v[124:127]
    ds_read_b128 v[188:191], v44 offset:2432
    ds_write_b16_d16_hi v48, v107 offset:0
    v_mfma_f32_16x16x32_bf16 v[124:127], v[156:159], v[168:171], v[124:127]
    ds_read_b128 v[204:207], v45 offset:5488
    s_waitcnt lgkmcnt(7)
    v_mul_u32_u24 v2, 20480, v2
    v_mfma_f32_16x16x32_bf16 v[128:131], v[152:155], v[176:179], v[128:131]
    buffer_load_dwordx4 a[56:59], v241, s[48:51], s69 offen offset:2048 sc1
    v_mfma_f32_16x16x32_bf16 v[128:131], v[156:159], v[172:175], v[128:131]
    ds_read_b128 v[192:195], v44 offset:1408
    v_and_b32 v3, 0x70, v240
    v_mfma_f32_16x16x32_bf16 v[128:131], v[160:163], v[168:171], v[128:131]
    ds_read_b128 v[208:211], v45 offset:5744
    s_waitcnt lgkmcnt(7)
    v_add3_u32 v51, s5, v2, v3
    v_mfma_f32_16x16x32_bf16 v[132:135], v[152:155], v[180:183], v[132:135]
    v_mfma_f32_16x16x32_bf16 v[132:135], v[156:159], v[176:179], v[132:135]
    ds_read_b128 v[196:199], v44 offset:384
    ds_write_b16_d16_hi v48, v111 offset:10240
    v_mfma_f32_16x16x32_bf16 v[132:135], v[160:163], v[172:175], v[132:135]
    ds_read_b128 v[212:215], v45 offset:6000
    s_waitcnt lgkmcnt(5)
    v_mfma_f32_16x16x32_bf16 v[132:135], v[164:167], v[168:171], v[132:135]
    buffer_load_dwordx4 a[60:63], v241, s[48:51], s69 offen offset:3072 sc1
    v_mfma_f32_16x16x32_bf16 v[120:123], v[184:187], v[200:203], v[120:123]
    ds_read_b128 v[152:155], v44 offset:3392
    ds_read_b128 v[168:171], v45 offset:5216
    v_mfma_f32_16x16x32_bf16 v[124:127], v[184:187], v[204:207], v[124:127]
    ds_read_b128 v[156:159], v44 offset:2368
    ds_write_b16_d16_hi v48, v115 offset:20480
    v_mfma_f32_16x16x32_bf16 v[124:127], v[188:191], v[200:203], v[124:127]
    ds_read_b128 v[172:175], v45 offset:5472
    s_waitcnt lgkmcnt(8)
    v_mfma_f32_16x16x32_bf16 v[128:131], v[184:187], v[208:211], v[128:131]
    s_add_u32 s69, s68, 16384
    buffer_load_dwordx4 a[64:67], v241, s[48:51], s69 offen offset:0 sc1
    v_mfma_f32_16x16x32_bf16 v[128:131], v[188:191], v[204:207], v[128:131]
    ds_read_b128 v[160:163], v44 offset:1344
    v_mfma_f32_16x16x32_bf16 v[128:131], v[192:195], v[200:203], v[128:131]
    ds_read_b128 v[176:179], v45 offset:5728
    s_waitcnt lgkmcnt(7)
    v_mfma_f32_16x16x32_bf16 v[132:135], v[184:187], v[212:215], v[132:135]
    buffer_load_dwordx4 a[68:71], v241, s[48:51], s69 offen offset:1024 sc1
    v_mfma_f32_16x16x32_bf16 v[132:135], v[188:191], v[208:211], v[132:135]
    ds_read_b128 v[164:167], v44 offset:320
    ds_write_b16_d16_hi v48, v119 offset:30720
    v_mfma_f32_16x16x32_bf16 v[132:135], v[192:195], v[204:207], v[132:135]
    ds_read_b128 v[180:183], v45 offset:5984
    s_waitcnt lgkmcnt(5)
    v_mfma_f32_16x16x32_bf16 v[132:135], v[196:199], v[200:203], v[132:135]
    buffer_load_dwordx4 a[72:75], v241, s[48:51], s69 offen offset:2048 sc1
    v_mfma_f32_16x16x32_bf16 v[120:123], v[152:155], v[168:171], v[120:123]
    ds_read_b128 v[184:187], v44 offset:3328
    ds_read_b128 v[200:203], v45 offset:5200
    v_mfma_f32_16x16x32_bf16 v[124:127], v[152:155], v[172:175], v[124:127]
    ds_read_b128 v[188:191], v44 offset:2304
    v_mfma_f32_16x16x32_bf16 v[124:127], v[156:159], v[168:171], v[124:127]
    ds_read_b128 v[204:207], v45 offset:5456
    s_waitcnt lgkmcnt(7)
    v_mfma_f32_16x16x32_bf16 v[128:131], v[152:155], v[176:179], v[128:131]
    buffer_load_dwordx4 a[76:79], v241, s[48:51], s69 offen offset:3072 sc1
    v_mfma_f32_16x16x32_bf16 v[128:131], v[156:159], v[172:175], v[128:131]
    ds_read_b128 v[192:195], v44 offset:1280
    v_mfma_f32_16x16x32_bf16 v[128:131], v[160:163], v[168:171], v[128:131]
    ds_read_b128 v[208:211], v45 offset:5712
    s_waitcnt lgkmcnt(6)
    v_mfma_f32_16x16x32_bf16 v[132:135], v[152:155], v[180:183], v[132:135]
    s_add_u32 s69, s68, 20480
    v_mfma_f32_16x16x32_bf16 v[132:135], v[156:159], v[176:179], v[132:135]
    ds_read_b128 v[196:199], v44 offset:256
    v_mfma_f32_16x16x32_bf16 v[132:135], v[160:163], v[172:175], v[132:135]
    ds_read_b128 v[212:215], v45 offset:5968
    s_waitcnt lgkmcnt(4)
    v_mfma_f32_16x16x32_bf16 v[132:135], v[164:167], v[168:171], v[132:135]
    buffer_load_dwordx4 a[80:83], v241, s[48:51], s69 offen offset:0 sc1
    v_mfma_f32_16x16x32_bf16 v[120:123], v[184:187], v[200:203], v[120:123]
    ds_read_b128 v[152:155], v44 offset:3264
    ds_read_b128 v[168:171], v45 offset:5184
    v_mfma_f32_16x16x32_bf16 v[124:127], v[184:187], v[204:207], v[124:127]
    ds_read_b128 v[156:159], v44 offset:2240
    v_mfma_f32_16x16x32_bf16 v[124:127], v[188:191], v[200:203], v[124:127]
    ds_read_b128 v[172:175], v45 offset:5440
    s_waitcnt lgkmcnt(6)
    v_mfma_f32_16x16x32_bf16 v[128:131], v[184:187], v[208:211], v[128:131]
    buffer_load_dwordx4 a[84:87], v241, s[48:51], s69 offen offset:1024 sc1
    v_mfma_f32_16x16x32_bf16 v[128:131], v[188:191], v[204:207], v[128:131]
    ds_read_b128 v[160:163], v44 offset:1216
    v_mfma_f32_16x16x32_bf16 v[128:131], v[192:195], v[200:203], v[128:131]
    ds_read_b128 v[176:179], v45 offset:5696
    s_waitcnt lgkmcnt(6)
    v_mfma_f32_16x16x32_bf16 v[132:135], v[184:187], v[212:215], v[132:135]
    buffer_load_dwordx4 a[88:91], v241, s[48:51], s69 offen offset:2048 sc1
    v_mfma_f32_16x16x32_bf16 v[132:135], v[188:191], v[208:211], v[132:135]
    ds_read_b128 v[164:167], v44 offset:192
    s_barrier
    v_mfma_f32_16x16x32_bf16 v[132:135], v[192:195], v[204:207], v[132:135]
    ds_read_b128 v[180:183], v45 offset:5952
    s_waitcnt lgkmcnt(4)
    v_mfma_f32_16x16x32_bf16 v[132:135], v[196:199], v[200:203], v[132:135]
    buffer_load_dwordx4 a[92:95], v241, s[48:51], s69 offen offset:3072 sc1
    v_mfma_f32_16x16x32_bf16 v[120:123], v[152:155], v[168:171], v[120:123]
    ds_read_b128 v[184:187], v44 offset:3200
    ds_read_b128 v[200:203], v45 offset:5168
    s_lshl_b32 s4, s2, 7
    v_mfma_f32_16x16x32_bf16 v[124:127], v[152:155], v[172:175], v[124:127]
    ds_read_b128 v[188:191], v44 offset:2176
    s_add_u32 s4, s4, 98304
    s_mul_i32 s5, s79, 1
    v_mfma_f32_16x16x32_bf16 v[124:127], v[156:159], v[168:171], v[124:127]
    ds_read_b128 v[204:207], v45 offset:5424
    s_waitcnt lgkmcnt(6)
    v_mul_u32_u24 v252, 20480, v0
    v_mfma_f32_16x16x32_bf16 v[128:131], v[152:155], v[176:179], v[128:131]
    s_add_u32 s69, s68, 24576
    buffer_load_dwordx4 a[96:99], v241, s[48:51], s69 offen offset:0 sc1
    v_mfma_f32_16x16x32_bf16 v[128:131], v[156:159], v[172:175], v[128:131]
    ds_read_b128 v[192:195], v44 offset:1152
    v_add_u32 v252, s4, v252
    v_mov_b32 v2, 2147483632
    v_mfma_f32_16x16x32_bf16 v[128:131], v[160:163], v[168:171], v[128:131]
L_pg_c2:
    s_cbranch_execz L_rt_c2
    ds_read_b128 v[208:211], v45 offset:5680
    s_waitcnt lgkmcnt(6)
    v_mfma_f32_16x16x32_bf16 v[132:135], v[152:155], v[180:183], v[132:135]
    v_mfma_f32_16x16x32_bf16 v[132:135], v[156:159], v[176:179], v[132:135]
    ds_read_b128 v[196:199], v44 offset:128
    v_mfma_f32_16x16x32_bf16 v[132:135], v[160:163], v[172:175], v[132:135]
    ds_read_b128 v[212:215], v45 offset:5936
    s_waitcnt lgkmcnt(4)
    v_mfma_f32_16x16x32_bf16 v[132:135], v[164:167], v[168:171], v[132:135]
    buffer_load_dwordx4 a[100:103], v241, s[48:51], s69 offen offset:1024 sc1
    v_mfma_f32_16x16x32_bf16 v[120:123], v[184:187], v[200:203], v[120:123]
    ds_read_b128 v[152:155], v44 offset:3136
    ds_read_b128 v[168:171], v45 offset:5152
    v_cmp_gt_u32 s[8:9], s5, v0
    v_mfma_f32_16x16x32_bf16 v[124:127], v[184:187], v[204:207], v[124:127]
    ds_read_b128 v[156:159], v44 offset:2112
    v_cndmask_b32 v252, v2, v252, s[8:9]
    s_mul_i32 s4, s67, 5
    v_mfma_f32_16x16x32_bf16 v[124:127], v[188:191], v[200:203], v[124:127]
    ds_read_b128 v[172:175], v45 offset:5408
    s_waitcnt lgkmcnt(6)
    s_lshr_b32 s4, s4, 3
    v_mfma_f32_16x16x32_bf16 v[128:131], v[184:187], v[208:211], v[128:131]
    buffer_load_dwordx4 a[104:107], v241, s[48:51], s69 offen offset:2048 sc1
    v_mfma_f32_16x16x32_bf16 v[128:131], v[188:191], v[204:207], v[128:131]
    ds_read_b128 v[160:163], v44 offset:1088
    s_min_u32 s4, s4, 3
    s_mul_i32 s5, s3, 20
    v_mfma_f32_16x16x32_bf16 v[128:131], v[192:195], v[200:203], v[128:131]
    ds_read_b128 v[176:179], v45 offset:5664
    s_waitcnt lgkmcnt(6)
    v_mfma_f32_16x16x32_bf16 v[132:135], v[184:187], v[212:215], v[132:135]
    buffer_load_dwordx4 a[108:111], v241, s[48:51], s69 offen offset:3072 sc1
    v_mfma_f32_16x16x32_bf16 v[132:135], v[188:191], v[208:211], v[132:135]
    ds_read_b128 v[164:167], v44 offset:64
    v_mfma_f32_16x16x32_bf16 v[132:135], v[192:195], v[204:207], v[132:135]
    ds_read_b128 v[180:183], v45 offset:5920
    s_waitcnt lgkmcnt(4)
    v_mfma_f32_16x16x32_bf16 v[132:135], v[196:199], v[200:203], v[132:135]
    s_add_u32 s69, s68, 28672
    buffer_load_dwordx4 a[112:115], v241, s[48:51], s69 offen offset:0 sc1
    v_mfma_f32_16x16x32_bf16 v[120:123], v[152:155], v[168:171], v[120:123]
    ds_read_b128 v[184:187], v44 offset:3072
    ds_read_b128 v[200:203], v45 offset:5136
    s_add_u32 s4, s4, s5
    v_mfma_f32_16x16x32_bf16 v[124:127], v[152:155], v[172:175], v[124:127]
    ds_read_b128 v[188:191], v44 offset:2048
    s_lshl_b32 s4, s4, 5
    s_sub_u32 s4, 203744, s4
    v_mfma_f32_16x16x32_bf16 v[124:127], v[156:159], v[168:171], v[124:127]
    ds_read_b128 v[204:207], v45 offset:5392
    s_waitcnt lgkmcnt(6)
    v_bfe_u32 v234, v0, 1, 2
    v_mfma_f32_16x16x32_bf16 v[128:131], v[152:155], v[176:179], v[128:131]
    buffer_load_dwordx4 a[116:119], v241, s[48:51], s69 offen offset:1024 sc1
    v_mfma_f32_16x16x32_bf16 v[128:131], v[156:159], v[172:175], v[128:131]
    ds_read_b128 v[192:195], v44 offset:1024
    v_mul_u32_u24 v234, 5, v234
    v_and_b32 v235, 1, v0
    v_mfma_f32_16x16x32_bf16 v[128:131], v[160:163], v[168:171], v[128:131]
    ds_read_b128 v[208:211], v45 offset:5648
    s_waitcnt lgkmcnt(6)
    v_mfma_f32_16x16x32_bf16 v[132:135], v[152:155], v[180:183], v[132:135]
    v_mfma_f32_16x16x32_bf16 v[132:135], v[156:159], v[176:179], v[132:135]
    ds_read_b128 v[196:199], v44 offset:0
    v_mfma_f32_16x16x32_bf16 v[132:135], v[160:163], v[172:175], v[132:135]
    ds_read_b128 v[212:215], v45 offset:5904
    s_waitcnt lgkmcnt(4)
    v_mfma_f32_16x16x32_bf16 v[132:135], v[164:167], v[168:171], v[132:135]
    buffer_load_dwordx4 a[120:123], v241, s[48:51], s69 offen offset:2048 sc1
    v_mfma_f32_16x16x32_bf16 v[120:123], v[184:187], v[200:203], v[120:123]
    ds_read_b128 v[152:155], v44 offset:4032
    ds_read_b128 v[168:171], v45 offset:256
    v_add_lshl_u32 v234, v234, v235, 5
    v_mfma_f32_16x16x32_bf16 v[124:127], v[184:187], v[204:207], v[124:127]
    ds_read_b128 v[156:159], v44 offset:3008
    v_sub_u32 v234, s4, v234
    s_lshl_b32 s4, s65, 2
    v_mfma_f32_16x16x32_bf16 v[124:127], v[188:191], v[200:203], v[124:127]
    ds_read_b128 v[172:175], v45 offset:512
    s_waitcnt lgkmcnt(6)
    s_add_u32 s4, s4, s3
    v_mfma_f32_16x16x32_bf16 v[128:131], v[184:187], v[208:211], v[128:131]
    buffer_load_dwordx4 a[124:127], v241, s[48:51], s69 offen offset:3072 sc1
    v_mfma_f32_16x16x32_bf16 v[128:131], v[188:191], v[204:207], v[128:131]
    ds_read_b128 v[160:163], v44 offset:1984
    s_mul_i32 s4, s4, 1536
    s_add_u32 s4, s4, 786432
    v_mfma_f32_16x16x32_bf16 v[128:131], v[192:195], v[200:203], v[128:131]
    ds_read_b128 v[176:179], v45 offset:768
    s_waitcnt lgkmcnt(6)
    v_mfma_f32_16x16x32_bf16 v[132:135], v[184:187], v[212:215], v[132:135]
    s_add_u32 s69, s68, 32768
    buffer_load_dwordx4 a[128:131], v241, s[48:51], s69 offen offset:0 sc1
    v_mfma_f32_16x16x32_bf16 v[132:135], v[188:191], v[208:211], v[132:135]
    ds_read_b128 v[164:167], v44 offset:960
    v_mfma_f32_16x16x32_bf16 v[132:135], v[192:195], v[204:207], v[132:135]
    ds_read_b128 v[180:183], v45 offset:1024
    s_waitcnt lgkmcnt(4)
    v_mfma_f32_16x16x32_bf16 v[132:135], v[196:199], v[200:203], v[132:135]
    buffer_load_dwordx4 a[132:135], v241, s[48:51], s69 offen offset:1024 sc1
    v_mfma_f32_16x16x32_bf16 v[136:139], v[152:155], v[168:171], v[136:139]
    ds_read_b128 v[184:187], v44 offset:3968
    ds_read_b128 v[200:203], v45 offset:240
    v_cvt_pk_bf16_f32 v8, v120, v121
    v_mfma_f32_16x16x32_bf16 v[136:139], v[40:43], v[168:171], v[136:139]
    ds_read_b128 v[188:191], v44 offset:2944
    v_cvt_pk_bf16_f32 v9, v122, v123
    v_lshrrev_b32 v54, 1, v0
    v_mfma_f32_16x16x32_bf16 v[140:143], v[152:155], v[172:175], v[140:143]
    ds_read_b128 v[204:207], v45 offset:496
    s_waitcnt lgkmcnt(6)
    ds_write_b64 v49, v[8:9] offset:0
    v_cvt_pk_bf16_f32 v10, v124, v125
    v_mfma_f32_16x16x32_bf16 v[140:143], v[156:159], v[168:171], v[140:143]
    v_cvt_pk_bf16_f32 v11, v126, v127
    v_bfi_b32 v54, 7, v0, v54
    v_mfma_f32_16x16x32_bf16 v[140:143], v[40:43], v[172:175], v[140:143]
    ds_read_b128 v[192:195], v44 offset:1920
    ds_write_b64 v49, v[10:11] offset:64
    v_cvt_pk_bf16_f32 v12, v128, v129
    v_mfma_f32_16x16x32_bf16 v[144:147], v[152:155], v[176:179], v[144:147]
    ds_read_b128 v[208:211], v45 offset:752
    s_waitcnt lgkmcnt(8)
    v_cvt_pk_bf16_f32 v13, v130, v131
    v_mfma_f32_16x16x32_bf16 v[144:147], v[156:159], v[172:175], v[144:147]
    ds_write_b64 v49, v[12:13] offset:128
    v_cvt_pk_bf16_f32 v14, v132, v133
    v_mfma_f32_16x16x32_bf16 v[144:147], v[160:163], v[168:171], v[144:147]
    ds_read_b128 v[196:199], v44 offset:896
    v_cvt_pk_bf16_f32 v15, v134, v135
    v_lshl_add_u32 v54, v54, 4, s4
    v_mfma_f32_16x16x32_bf16 v[144:147], v[40:43], v[176:179], v[144:147]
    ds_read_b128 v[212:215], v45 offset:1008
    ds_write_b64 v49, v[14:15] offset:192
    v_mfma_f32_16x16x32_bf16 v[148:151], v[152:155], v[180:183], v[148:151]
    s_and_b32 s4, s2, 0
    s_lshl_b32 s4, s4, 2
    s_add_u32 s4, s4, s3
    v_mfma_f32_16x16x32_bf16 v[148:151], v[156:159], v[176:179], v[148:151]
    v_mfma_f32_16x16x32_bf16 v[148:151], v[160:163], v[172:175], v[148:151]
    v_mfma_f32_16x16x32_bf16 v[148:151], v[164:167], v[168:171], v[148:151]
    s_waitcnt lgkmcnt(8)
    s_waitcnt lgkmcnt(0)
    s_barrier
    v_mfma_f32_16x16x32_bf16 v[148:151], v[40:43], v[180:183], v[148:151]
    ds_read_b64_tr_b16 v[24:25], v50 offset:0
    ds_read_b64_tr_b16 v[26:27], v50 offset:256
    v_mfma_f32_16x16x32_bf16 v[136:139], v[184:187], v[200:203], v[136:139]
    ds_read_b128 v[72:75], v44 offset:3904
    ds_read_b128 v[88:91], v45 offset:224
    ds_read_b64_tr_b16 v[28:29], v50 offset:32
    ds_read_b64_tr_b16 v[30:31], v50 offset:288
    v_mfma_f32_16x16x32_bf16 v[140:143], v[184:187], v[204:207], v[140:143]
    ds_read_b128 v[76:79], v44 offset:2880
    s_mul_i32 s4, s4, 5120
    s_add_u32 s4, s4, 98304
    v_mfma_f32_16x16x32_bf16 v[140:143], v[188:191], v[200:203], v[140:143]
    ds_read_b128 v[92:95], v45 offset:480
    v_min_u32 v251, 39, v0
    v_mfma_f32_16x16x32_bf16 v[144:147], v[184:187], v[208:211], v[144:147]
    v_lshl_add_u32 v251, v251, 7, s4
    v_mov_b32 v3, 2147483632
    v_mfma_f32_16x16x32_bf16 v[144:147], v[188:191], v[204:207], v[144:147]
    ds_read_b128 v[80:83], v44 offset:1856
    s_lshr_b32 s4, s65, 2
    v_mfma_f32_16x16x32_bf16 v[144:147], v[192:195], v[200:203], v[144:147]
    ds_read_b128 v[96:99], v45 offset:736
    v_mfma_f32_16x16x32_bf16 v[148:151], v[184:187], v[212:215], v[148:151]
    s_mov_b32 s14, 0
    s_waitcnt lgkmcnt(8)
    buffer_store_dwordx4 v[24:27], v51, s[48:51], s14 offen sc1
    v_mfma_f32_16x16x32_bf16 v[148:151], v[188:191], v[208:211], v[148:151]
    ds_read_b128 v[84:87], v44 offset:832
    v_mfma_f32_16x16x32_bf16 v[148:151], v[192:195], v[204:207], v[148:151]
    ds_read_b128 v[100:103], v45 offset:992
    s_waitcnt lgkmcnt(4)
    v_mfma_f32_16x16x32_bf16 v[148:151], v[196:199], v[200:203], v[148:151]
    s_mov_b32 s14, 327680
    buffer_store_dwordx4 v[28:31], v51, s[48:51], s14 offen sc1
    v_mfma_f32_16x16x32_bf16 v[136:139], v[72:75], v[88:91], v[136:139]
    ds_read_b128 v[104:107], v44 offset:3840
    ds_read_b128 v[120:123], v45 offset:208
    s_mul_i32 s4, s4, 20480
    v_mfma_f32_16x16x32_bf16 v[140:143], v[72:75], v[92:95], v[140:143]
    ds_read_b128 v[108:111], v44 offset:2816
    s_and_b32 s5, s65, 3
    s_lshl_b32 s5, s5, 5
    v_mfma_f32_16x16x32_bf16 v[140:143], v[76:79], v[88:91], v[140:143]
    ds_read_b128 v[124:127], v45 offset:464
    s_waitcnt lgkmcnt(6)
    s_add_u32 s4, s4, s5
    v_mfma_f32_16x16x32_bf16 v[144:147], v[72:75], v[96:99], v[144:147]
    buffer_load_dwordx4 a[136:139], v241, s[48:51], s69 offen offset:2048 sc1
    v_mfma_f32_16x16x32_bf16 v[144:147], v[76:79], v[92:95], v[144:147]
    ds_read_b128 v[112:115], v44 offset:1792
    s_add_u32 s4, s4, s72
    v_lshrrev_b32 v2, 1, v0
    v_mfma_f32_16x16x32_bf16 v[144:147], v[80:83], v[88:91], v[144:147]
    ds_read_b128 v[128:131], v45 offset:720
    s_waitcnt lgkmcnt(6)
    v_mfma_f32_16x16x32_bf16 v[148:151], v[72:75], v[100:103], v[148:151]
    v_mfma_f32_16x16x32_bf16 v[148:151], v[76:79], v[96:99], v[148:151]
    ds_read_b128 v[116:119], v44 offset:768
    v_mfma_f32_16x16x32_bf16 v[148:151], v[80:83], v[92:95], v[148:151]
    ds_read_b128 v[132:135], v45 offset:976
    s_waitcnt lgkmcnt(4)
    v_mfma_f32_16x16x32_bf16 v[148:151], v[84:87], v[88:91], v[148:151]
    buffer_load_dwordx4 a[140:143], v241, s[48:51], s69 offen offset:3072 sc1
    v_mfma_f32_16x16x32_bf16 v[136:139], v[104:107], v[120:123], v[136:139]
    ds_read_b128 v[72:75], v44 offset:3776
    ds_read_b128 v[88:91], v45 offset:192
    v_lshl_add_u32 v2, v2, 7, s4
    v_mfma_f32_16x16x32_bf16 v[140:143], v[104:107], v[124:127], v[140:143]
    ds_read_b128 v[76:79], v44 offset:2752
    v_and_or_b32 v228, v240, 16, v2
    v_cmp_gt_u32 s[8:9], 16, v0
    v_mfma_f32_16x16x32_bf16 v[140:143], v[108:111], v[120:123], v[140:143]
    ds_read_b128 v[92:95], v45 offset:448
    s_waitcnt lgkmcnt(6)
    v_cndmask_b32 v229, v3, v228, s[8:9]
    v_mfma_f32_16x16x32_bf16 v[144:147], v[104:107], v[128:131], v[144:147]
    s_add_u32 s69, s68, 36864
    buffer_load_dwordx4 a[144:147], v241, s[48:51], s69 offen offset:0 sc1
    v_mfma_f32_16x16x32_bf16 v[144:147], v[108:111], v[124:127], v[144:147]
    ds_read_b128 v[80:83], v44 offset:1728
    v_lshlrev_b32 v242, 3, v0
    v_mfma_f32_16x16x32_bf16 v[144:147], v[112:115], v[120:123], v[144:147]
    ds_read_b128 v[96:99], v45 offset:704
    s_waitcnt lgkmcnt(6)
    v_add_u32 v243, 81920, v242
    v_mfma_f32_16x16x32_bf16 v[148:151], v[104:107], v[132:135], v[148:151]
    buffer_load_dwordx4 a[148:151], v241, s[48:51], s69 offen offset:1024 sc1
    v_mfma_f32_16x16x32_bf16 v[148:151], v[108:111], v[128:131], v[148:151]
    ds_read_b128 v[84:87], v44 offset:704
    v_mfma_f32_16x16x32_bf16 v[148:151], v[112:115], v[124:127], v[148:151]
    ds_read_b128 v[100:103], v45 offset:960
    s_waitcnt lgkmcnt(4)
    v_mfma_f32_16x16x32_bf16 v[148:151], v[116:119], v[120:123], v[148:151]
    buffer_load_dwordx4 a[152:155], v241, s[48:51], s69 offen offset:2048 sc1
    v_mfma_f32_16x16x32_bf16 v[136:139], v[72:75], v[88:91], v[136:139]
    ds_read_b128 v[104:107], v44 offset:3712
    ds_read_b128 v[120:123], v45 offset:176
    s_mul_i32 s5, s64, 393216
    v_mfma_f32_16x16x32_bf16 v[140:143], v[72:75], v[92:95], v[140:143]
    ds_read_b128 v[108:111], v44 offset:2688
    s_lshl_b32 s6, s65, 2
    s_add_u32 s6, s6, s3
    v_mfma_f32_16x16x32_bf16 v[140:143], v[76:79], v[88:91], v[140:143]
    ds_read_b128 v[124:127], v45 offset:432
    s_waitcnt lgkmcnt(6)
    s_mul_i32 s7, s6, 768
    v_mfma_f32_16x16x32_bf16 v[144:147], v[72:75], v[96:99], v[144:147]
    buffer_load_dwordx4 a[156:159], v241, s[48:51], s69 offen offset:3072 sc1
    v_mfma_f32_16x16x32_bf16 v[144:147], v[76:79], v[92:95], v[144:147]
    ds_read_b128 v[112:115], v44 offset:1664
    s_add_u32 s5, s5, s7
    s_add_u32 s5, s5, 9568256
    v_mfma_f32_16x16x32_bf16 v[144:147], v[80:83], v[88:91], v[144:147]
    ds_read_b128 v[128:131], v45 offset:688
    s_waitcnt lgkmcnt(6)
    v_mfma_f32_16x16x32_bf16 v[148:151], v[72:75], v[100:103], v[148:151]
    s_add_u32 s69, s68, 40960
    v_mfma_f32_16x16x32_bf16 v[148:151], v[76:79], v[96:99], v[148:151]
    ds_read_b128 v[116:119], v44 offset:640
    v_mfma_f32_16x16x32_bf16 v[148:151], v[80:83], v[92:95], v[148:151]
    ds_read_b128 v[132:135], v45 offset:944
    s_waitcnt lgkmcnt(4)
    v_mfma_f32_16x16x32_bf16 v[148:151], v[84:87], v[88:91], v[148:151]
    buffer_load_dwordx4 a[160:163], v241, s[48:51], s69 offen offset:0 sc1
    v_mfma_f32_16x16x32_bf16 v[136:139], v[104:107], v[120:123], v[136:139]
    ds_read_b128 v[72:75], v44 offset:3648
    ds_read_b128 v[88:91], v45 offset:160
    v_add_u32 v2, s5, v240
    v_mfma_f32_16x16x32_bf16 v[140:143], v[104:107], v[124:127], v[140:143]
    ds_read_b128 v[76:79], v44 offset:2624
    v_mov_b32 v3, 2147483632
    v_cmp_gt_u32 s[8:9], 48, v0
    v_mfma_f32_16x16x32_bf16 v[140:143], v[108:111], v[120:123], v[140:143]
    ds_read_b128 v[92:95], v45 offset:416
    s_waitcnt lgkmcnt(6)
    v_cndmask_b32 v244, v3, v2, s[8:9]
    v_mfma_f32_16x16x32_bf16 v[144:147], v[104:107], v[128:131], v[144:147]
    buffer_load_dwordx4 a[164:167], v241, s[48:51], s69 offen offset:1024 sc1
    v_mfma_f32_16x16x32_bf16 v[144:147], v[108:111], v[124:127], v[144:147]
    ds_read_b128 v[80:83], v44 offset:1600
    s_lshl_b32 s4, s64, 10
    s_add_u32 s4, s4, 16384
    v_mfma_f32_16x16x32_bf16 v[144:147], v[112:115], v[120:123], v[144:147]
    ds_read_b128 v[96:99], v45 offset:672
    s_waitcnt lgkmcnt(6)
    v_mfma_f32_16x16x32_bf16 v[148:151], v[104:107], v[132:135], v[148:151]
    buffer_load_dwordx4 a[168:171], v241, s[48:51], s69 offen offset:2048 sc1
    v_mfma_f32_16x16x32_bf16 v[148:151], v[108:111], v[128:131], v[148:151]
    ds_read_b128 v[84:87], v44 offset:576
    v_mfma_f32_16x16x32_bf16 v[148:151], v[112:115], v[124:127], v[148:151]
    ds_read_b128 v[100:103], v45 offset:928
    s_waitcnt lgkmcnt(4)
    v_mfma_f32_16x16x32_bf16 v[148:151], v[116:119], v[120:123], v[148:151]
    buffer_load_dwordx4 a[172:175], v241, s[48:51], s69 offen offset:3072 sc1
    v_mfma_f32_16x16x32_bf16 v[136:139], v[72:75], v[88:91], v[136:139]
    ds_read_b128 v[104:107], v44 offset:3584
    ds_read_b128 v[120:123], v45 offset:144
    v_and_b32 v2, 15, v0
    v_mfma_f32_16x16x32_bf16 v[140:143], v[72:75], v[92:95], v[140:143]
    ds_read_b128 v[108:111], v44 offset:2560
    v_lshl_add_u32 v245, v2, 4, s4
    s_lshl_b32 s5, s64, 4
    v_mfma_f32_16x16x32_bf16 v[140:143], v[76:79], v[88:91], v[140:143]
    ds_read_b128 v[124:127], v45 offset:400
    s_waitcnt lgkmcnt(6)
    s_add_u32 s5, s5, s65
    v_mfma_f32_16x16x32_bf16 v[144:147], v[72:75], v[96:99], v[144:147]
    s_add_u32 s69, s68, 45056
    buffer_load_dwordx4 a[176:179], v241, s[48:51], s69 offen offset:0 sc1
    v_mfma_f32_16x16x32_bf16 v[144:147], v[76:79], v[92:95], v[144:147]
    ds_read_b128 v[112:115], v44 offset:1536
    s_lshl_b32 s5, s5, 5
    s_add_u32 s5, s5, s3
    v_mfma_f32_16x16x32_bf16 v[144:147], v[80:83], v[88:91], v[144:147]
    ds_read_b128 v[128:131], v45 offset:656
    s_waitcnt lgkmcnt(6)
    v_mfma_f32_16x16x32_bf16 v[148:151], v[72:75], v[100:103], v[148:151]
    v_mfma_f32_16x16x32_bf16 v[148:151], v[76:79], v[96:99], v[148:151]
    ds_read_b128 v[116:119], v44 offset:512
    v_mfma_f32_16x16x32_bf16 v[148:151], v[80:83], v[92:95], v[148:151]
    ds_read_b128 v[132:135], v45 offset:912
    s_waitcnt lgkmcnt(4)
    v_mfma_f32_16x16x32_bf16 v[148:151], v[84:87], v[88:91], v[148:151]
    buffer_load_dwordx4 a[180:183], v241, s[48:51], s69 offen offset:1024 sc1
    v_mfma_f32_16x16x32_bf16 v[136:139], v[104:107], v[120:123], v[136:139]
    ds_read_b128 v[72:75], v44 offset:3520
    ds_read_b128 v[88:91], v45 offset:128
    s_lshl_b32 s5, s5, 2
    v_mfma_f32_16x16x32_bf16 v[140:143], v[104:107], v[124:127], v[140:143]
    ds_read_b128 v[76:79], v44 offset:2496
    s_add_u32 s5, s5, 131072
    v_mov_b32 v2, s5
    v_mfma_f32_16x16x32_bf16 v[140:143], v[108:111], v[120:123], v[140:143]
    ds_read_b128 v[92:95], v45 offset:384
    s_waitcnt lgkmcnt(6)
    v_cmp_eq_u32 s[8:9], 0, v0
    v_mfma_f32_16x16x32_bf16 v[144:147], v[104:107], v[128:131], v[144:147]
    buffer_load_dwordx4 a[184:187], v241, s[48:51], s69 offen offset:2048 sc1
    v_mfma_f32_16x16x32_bf16 v[144:147], v[108:111], v[124:127], v[144:147]
    ds_read_b128 v[80:83], v44 offset:1472
    s_waitcnt vmcnt(13)
    s_barrier
    v_mfma_f32_16x16x32_bf16 v[144:147], v[112:115], v[120:123], v[144:147]
    ds_read_b128 v[96:99], v45 offset:640
    s_waitcnt lgkmcnt(6)
    v_cndmask_b32 v246, v3, v2, s[8:9]
    v_mfma_f32_16x16x32_bf16 v[148:151], v[104:107], v[132:135], v[148:151]
    s_lshr_b32 s5, s65, 3
    v_mov_b32 v5, 1
    buffer_store_dword v5, v252, s[48:51], 0 offen sc1
    v_mfma_f32_16x16x32_bf16 v[148:151], v[108:111], v[128:131], v[148:151]
    ds_read_b128 v[84:87], v44 offset:448
    v_mfma_f32_16x16x32_bf16 v[148:151], v[112:115], v[124:127], v[148:151]
    ds_read_b128 v[100:103], v45 offset:896
    s_waitcnt lgkmcnt(4)
    v_mfma_f32_16x16x32_bf16 v[148:151], v[116:119], v[120:123], v[148:151]
    buffer_load_dwordx4 a[188:191], v241, s[48:51], s69 offen offset:3072 sc1
    v_mfma_f32_16x16x32_bf16 v[136:139], v[72:75], v[88:91], v[136:139]
    ds_read_b128 v[104:107], v44 offset:3456
    ds_read_b128 v[120:123], v45 offset:112
    s_lshl_b32 s5, s5, 8
    v_mfma_f32_16x16x32_bf16 v[140:143], v[72:75], v[92:95], v[140:143]
    ds_read_b128 v[108:111], v44 offset:2432
    s_add_u32 s4, s4, s5
    s_and_b32 s5, s65, 3
    v_mfma_f32_16x16x32_bf16 v[140:143], v[76:79], v[88:91], v[140:143]
    ds_read_b128 v[124:127], v45 offset:368
    s_waitcnt lgkmcnt(6)
    s_lshl_b32 s5, s5, 6
    v_mfma_f32_16x16x32_bf16 v[144:147], v[72:75], v[96:99], v[144:147]
    s_add_u32 s69, s68, 49152
    buffer_load_dwordx4 a[192:195], v241, s[48:51], s69 offen offset:0 sc1
    v_mfma_f32_16x16x32_bf16 v[144:147], v[76:79], v[92:95], v[144:147]
    ds_read_b128 v[112:115], v44 offset:1408
    s_add_u32 s4, s4, s5
    s_and_b32 s5, s65, 4
    v_mfma_f32_16x16x32_bf16 v[144:147], v[80:83], v[88:91], v[144:147]
    ds_read_b128 v[128:131], v45 offset:624
    s_waitcnt lgkmcnt(6)
    v_mfma_f32_16x16x32_bf16 v[148:151], v[72:75], v[100:103], v[148:151]
    buffer_load_dword v235, v234, s[48:51], 0 offen sc1
    v_mfma_f32_16x16x32_bf16 v[148:151], v[76:79], v[96:99], v[148:151]
    ds_read_b128 v[116:119], v44 offset:384
    v_mfma_f32_16x16x32_bf16 v[148:151], v[80:83], v[92:95], v[148:151]
    ds_read_b128 v[132:135], v45 offset:880
    s_waitcnt lgkmcnt(4)
    v_mfma_f32_16x16x32_bf16 v[148:151], v[84:87], v[88:91], v[148:151]
    buffer_load_dwordx4 a[196:199], v241, s[48:51], s69 offen offset:1024 sc1
    buffer_load_dwordx4 a[200:203], v241, s[48:51], s69 offen offset:2048 sc1
    v_mfma_f32_16x16x32_bf16 v[136:139], v[104:107], v[120:123], v[136:139]
    ds_read_b128 v[72:75], v44 offset:3392
    ds_read_b128 v[88:91], v45 offset:96
    s_lshl_b32 s5, s5, 1
    v_mfma_f32_16x16x32_bf16 v[140:143], v[104:107], v[124:127], v[140:143]
    ds_read_b128 v[76:79], v44 offset:2368
    s_add_u32 s4, s4, s5
    v_add_u32 v2, s4, v240
    v_mfma_f32_16x16x32_bf16 v[140:143], v[108:111], v[120:123], v[140:143]
    ds_read_b128 v[92:95], v45 offset:352
    s_waitcnt lgkmcnt(6)
    s_lshl_b32 s4, s79, 2
    v_mfma_f32_16x16x32_bf16 v[144:147], v[104:107], v[128:131], v[144:147]
    buffer_load_dwordx4 a[204:207], v241, s[48:51], s69 offen offset:3072 sc1
    v_mfma_f32_16x16x32_bf16 v[144:147], v[108:111], v[124:127], v[144:147]
    ds_read_b128 v[80:83], v44 offset:1344
    v_cmp_gt_u32 s[8:9], s4, v0
    v_mfma_f32_16x16x32_bf16 v[144:147], v[112:115], v[120:123], v[144:147]
    ds_read_b128 v[96:99], v45 offset:608
    s_waitcnt lgkmcnt(6)
    v_cndmask_b32 v232, v3, v2, s[8:9]
    v_mfma_f32_16x16x32_bf16 v[148:151], v[104:107], v[132:135], v[148:151]
    s_add_u32 s69, s68, 53248
    v_mfma_f32_16x16x32_bf16 v[148:151], v[108:111], v[128:131], v[148:151]
    ds_read_b128 v[84:87], v44 offset:320
    v_mfma_f32_16x16x32_bf16 v[148:151], v[112:115], v[124:127], v[148:151]
    ds_read_b128 v[100:103], v45 offset:864
    s_waitcnt lgkmcnt(4)
    v_mfma_f32_16x16x32_bf16 v[148:151], v[116:119], v[120:123], v[148:151]
    buffer_load_dwordx4 a[208:211], v241, s[48:51], s69 offen offset:0 sc1
    v_mfma_f32_16x16x32_bf16 v[136:139], v[72:75], v[88:91], v[136:139]
    ds_read_b128 v[104:107], v44 offset:3328
    ds_read_b128 v[120:123], v45 offset:80
    v_and_b32 v2, 1, v0
    v_mfma_f32_16x16x32_bf16 v[140:143], v[72:75], v[92:95], v[140:143]
    ds_read_b128 v[108:111], v44 offset:2304
    v_lshrrev_b32 v3, 4, v0
    s_lshl_b32 s4, s3, 2
    v_mfma_f32_16x16x32_bf16 v[140:143], v[76:79], v[88:91], v[140:143]
    ds_read_b128 v[124:127], v45 offset:336
    s_waitcnt lgkmcnt(6)
    v_lshl_add_u32 v2, v2, 2, v3
    v_mfma_f32_16x16x32_bf16 v[144:147], v[72:75], v[96:99], v[144:147]
    buffer_load_dwordx4 a[212:215], v241, s[48:51], s69 offen offset:1024 sc1
    v_mfma_f32_16x16x32_bf16 v[144:147], v[76:79], v[92:95], v[144:147]
    ds_read_b128 v[112:115], v44 offset:1280
    s_add_u32 s4, s4, 143360
    v_lshl_add_u32 v230, v2, 4, s4
    v_mfma_f32_16x16x32_bf16 v[144:147], v[80:83], v[88:91], v[144:147]
    ds_read_b128 v[128:131], v45 offset:592
    s_waitcnt lgkmcnt(6)
    v_mfma_f32_16x16x32_bf16 v[148:151], v[72:75], v[100:103], v[148:151]
    buffer_load_dwordx4 a[216:219], v241, s[48:51], s69 offen offset:2048 sc1
    v_mfma_f32_16x16x32_bf16 v[148:151], v[76:79], v[96:99], v[148:151]
    ds_read_b128 v[116:119], v44 offset:256
    v_mfma_f32_16x16x32_bf16 v[148:151], v[80:83], v[92:95], v[148:151]
    ds_read_b128 v[132:135], v45 offset:848
    s_waitcnt lgkmcnt(4)
    v_mfma_f32_16x16x32_bf16 v[148:151], v[84:87], v[88:91], v[148:151]
    buffer_load_dwordx4 a[220:223], v241, s[48:51], s69 offen offset:3072 sc1
    v_mfma_f32_16x16x32_bf16 v[136:139], v[104:107], v[120:123], v[136:139]
    ds_read_b128 v[72:75], v44 offset:3264
    ds_read_b128 v[88:91], v45 offset:64
    v_and_b32 v3, 3, v0
    v_mfma_f32_16x16x32_bf16 v[140:143], v[104:107], v[124:127], v[140:143]
    ds_read_b128 v[76:79], v44 offset:2240
    s_mov_b32 s4, 143360
    v_lshl_add_u32 v231, v3, 5, s4
    v_mfma_f32_16x16x32_bf16 v[140:143], v[108:111], v[120:123], v[140:143]
    ds_read_b128 v[92:95], v45 offset:320
    s_waitcnt lgkmcnt(6)
    s_lshl_b32 s4, s64, 2
    v_mfma_f32_16x16x32_bf16 v[144:147], v[104:107], v[128:131], v[144:147]
    s_add_u32 s69, s68, 57344
    buffer_load_dwordx4 a[224:227], v241, s[48:51], s69 offen offset:0 sc1
    v_mfma_f32_16x16x32_bf16 v[144:147], v[108:111], v[124:127], v[144:147]
    ds_read_b128 v[80:83], v44 offset:1216
    s_add_u32 s4, s4, s3
    s_lshl_b32 s4, s4, 9
    v_mfma_f32_16x16x32_bf16 v[144:147], v[112:115], v[120:123], v[144:147]
    ds_read_b128 v[96:99], v45 offset:576
    s_waitcnt lgkmcnt(6)
    v_mfma_f32_16x16x32_bf16 v[148:151], v[104:107], v[132:135], v[148:151]
    v_mfma_f32_16x16x32_bf16 v[148:151], v[108:111], v[128:131], v[148:151]
    ds_read_b128 v[84:87], v44 offset:192
    v_mfma_f32_16x16x32_bf16 v[148:151], v[112:115], v[124:127], v[148:151]
    ds_read_b128 v[100:103], v45 offset:832
    s_waitcnt lgkmcnt(4)
    v_mfma_f32_16x16x32_bf16 v[148:151], v[116:119], v[120:123], v[148:151]
    buffer_load_dwordx4 a[228:231], v241, s[48:51], s69 offen offset:1024 sc1
    v_mfma_f32_16x16x32_bf16 v[136:139], v[72:75], v[88:91], v[136:139]
    ds_read_b128 v[104:107], v44 offset:3200
    ds_read_b128 v[120:123], v45 offset:48
    s_add_u32 s4, s4, 131072
    v_mfma_f32_16x16x32_bf16 v[140:143], v[72:75], v[92:95], v[140:143]
    ds_read_b128 v[108:111], v44 offset:2176
    v_bfe_u32 v2, v0, 2, 2
    v_mfma_f32_16x16x32_bf16 v[140:143], v[76:79], v[88:91], v[140:143]
    ds_read_b128 v[124:127], v45 offset:304
    s_waitcnt lgkmcnt(6)
    v_lshl_add_u32 v2, v2, 5, v3
    v_mfma_f32_16x16x32_bf16 v[144:147], v[72:75], v[96:99], v[144:147]
    buffer_load_dwordx4 a[232:235], v241, s[48:51], s69 offen offset:2048 sc1
    v_mfma_f32_16x16x32_bf16 v[144:147], v[76:79], v[92:95], v[144:147]
    ds_read_b128 v[112:115], v44 offset:1152
    v_lshl_add_u32 v247, v2, 2, s4
    s_lshl_b32 s4, s64, 3
    v_mfma_f32_16x16x32_bf16 v[144:147], v[80:83], v[88:91], v[144:147]
    ds_read_b128 v[128:131], v45 offset:560
    s_waitcnt lgkmcnt(6)
    s_add_u32 s4, s4, s66
    v_mfma_f32_16x16x32_bf16 v[148:151], v[72:75], v[100:103], v[148:151]
    buffer_load_dwordx4 a[236:239], v241, s[48:51], s69 offen offset:3072 sc1
    v_mfma_f32_16x16x32_bf16 v[148:151], v[76:79], v[96:99], v[148:151]
    ds_read_b128 v[116:119], v44 offset:128
    v_mfma_f32_16x16x32_bf16 v[148:151], v[80:83], v[92:95], v[148:151]
    ds_read_b128 v[132:135], v45 offset:816
    s_waitcnt lgkmcnt(4)
    v_mfma_f32_16x16x32_bf16 v[148:151], v[84:87], v[88:91], v[148:151]
    buffer_load_dwordx4 v[60:63], v54, s[48:51], 0 offen offset:0 sc1
    v_mfma_f32_16x16x32_bf16 v[136:139], v[104:107], v[120:123], v[136:139]
    ds_read_b128 v[72:75], v44 offset:3136
    ds_read_b128 v[88:91], v45 offset:32
    s_mul_i32 s76, s4, 49152
    v_mfma_f32_16x16x32_bf16 v[140:143], v[104:107], v[124:127], v[140:143]
    ds_read_b128 v[76:79], v44 offset:2112
    s_mul_i32 s5, s3, 12288
    s_add_u32 s76, s76, s5
    v_mfma_f32_16x16x32_bf16 v[140:143], v[108:111], v[120:123], v[140:143]
    ds_read_b128 v[92:95], v45 offset:288
    s_waitcnt lgkmcnt(6)
    s_add_u32 s76, s76, 9568256
    v_mfma_f32_16x16x32_bf16 v[144:147], v[104:107], v[128:131], v[144:147]
    buffer_load_dwordx4 v[64:67], v54, s[48:51], 0 offen offset:512 sc1
    v_mfma_f32_16x16x32_bf16 v[144:147], v[108:111], v[124:127], v[144:147]
    ds_read_b128 v[80:83], v44 offset:1088
    s_mul_i32 s91, s3, 3072
    s_add_u32 s4, s73, 20480
    v_mfma_f32_16x16x32_bf16 v[144:147], v[112:115], v[120:123], v[144:147]
    ds_read_b128 v[96:99], v45 offset:544
    s_waitcnt lgkmcnt(6)
    v_mfma_f32_16x16x32_bf16 v[148:151], v[104:107], v[132:135], v[148:151]
    v_mfma_f32_16x16x32_bf16 v[148:151], v[108:111], v[128:131], v[148:151]
    ds_read_b128 v[84:87], v44 offset:64
    v_mfma_f32_16x16x32_bf16 v[148:151], v[112:115], v[124:127], v[148:151]
    ds_read_b128 v[100:103], v45 offset:800
    s_waitcnt lgkmcnt(4)
    v_mfma_f32_16x16x32_bf16 v[148:151], v[116:119], v[120:123], v[148:151]
    buffer_load_dwordx4 v[68:71], v54, s[48:51], 0 offen offset:1024 sc1
    v_mfma_f32_16x16x32_bf16 v[136:139], v[72:75], v[88:91], v[136:139]
    ds_read_b128 v[104:107], v44 offset:3072
    ds_read_b128 v[120:123], v45 offset:16
    v_add_u32 v248, s4, v240
    v_mfma_f32_16x16x32_bf16 v[140:143], v[72:75], v[92:95], v[140:143]
    ds_read_b128 v[108:111], v44 offset:2048
    s_waitcnt vmcnt(14)
    v_cmp_gt_u32 vcc, 2, v235
    v_add_u32 v249, 61440, v248
    v_mfma_f32_16x16x32_bf16 v[140:143], v[76:79], v[88:91], v[140:143]
    ds_read_b128 v[124:127], v45 offset:272
    s_waitcnt lgkmcnt(6)
    s_cbranch_vccnz L_chk9_slow
L_chk9:
    v_mfma_f32_16x16x32_bf16 v[144:147], v[72:75], v[96:99], v[144:147]
    s_add_u32 s71, s70, 16384
    buffer_load_dwordx4 v[200:203], v240, s[48:51], s71 offen offset:2048 sc1
    v_mfma_f32_16x16x32_bf16 v[144:147], v[76:79], v[92:95], v[144:147]
    ds_read_b128 v[112:115], v44 offset:1024
    s_add_u32 s4, s91, 143872
    v_add_u32 v250, s4, v240
    v_mfma_f32_16x16x32_bf16 v[144:147], v[80:83], v[88:91], v[144:147]
    ds_read_b128 v[128:131], v45 offset:528
    s_waitcnt lgkmcnt(6)
    s_mov_b32 s82, s70
    v_mfma_f32_16x16x32_bf16 v[148:151], v[72:75], v[100:103], v[148:151]
    buffer_load_dword v59, v251, s[48:51], 0 offen sc1
    v_mfma_f32_16x16x32_bf16 v[148:151], v[76:79], v[96:99], v[148:151]
    ds_read_b128 v[116:119], v44 offset:0
L_pg_c3:
    s_cbranch_execz L_rt_c3
    v_mfma_f32_16x16x32_bf16 v[148:151], v[80:83], v[92:95], v[148:151]
    ds_read_b128 v[132:135], v45 offset:784
    s_waitcnt lgkmcnt(4)
    v_mfma_f32_16x16x32_bf16 v[148:151], v[84:87], v[88:91], v[148:151]
    buffer_load_dwordx4 v[204:207], v240, s[48:51], s71 offen offset:3072 sc1
    v_mfma_f32_16x16x32_bf16 v[136:139], v[104:107], v[120:123], v[136:139]
    s_add_u32 s71, s70, 20480
    buffer_load_dwordx4 v[208:211], v240, s[48:51], s71 offen offset:0 sc1
    v_mfma_f32_16x16x32_bf16 v[140:143], v[104:107], v[124:127], v[140:143]
    v_mfma_f32_16x16x32_bf16 v[140:143], v[108:111], v[120:123], v[140:143]
    s_waitcnt lgkmcnt(2)
    v_mfma_f32_16x16x32_bf16 v[144:147], v[104:107], v[128:131], v[144:147]
    buffer_load_dwordx4 v[212:215], v240, s[48:51], s71 offen offset:1024 sc1
    v_mfma_f32_16x16x32_bf16 v[144:147], v[108:111], v[124:127], v[144:147]
    v_mfma_f32_16x16x32_bf16 v[144:147], v[112:115], v[120:123], v[144:147]
    s_waitcnt lgkmcnt(0)
    v_mfma_f32_16x16x32_bf16 v[148:151], v[104:107], v[132:135], v[148:151]
    v_mfma_f32_16x16x32_bf16 v[148:151], v[108:111], v[128:131], v[148:151]
    v_mfma_f32_16x16x32_bf16 v[148:151], v[112:115], v[124:127], v[148:151]
    v_mfma_f32_16x16x32_bf16 v[148:151], v[116:119], v[120:123], v[148:151]
    s_add_u32 s71, s70, 28672
    buffer_load_dwordx4 a[240:243], v240, s[48:51], s71 offen offset:0 sc1
    v_cvt_pk_bf16_f32 v16, v136, v137
    v_cvt_pk_bf16_f32 v17, v138, v139
    ds_write_b64 v49, v[16:17] offset:16384
    buffer_load_dwordx4 a[244:247], v240, s[48:51], s71 offen offset:1024 sc1
    v_cvt_pk_bf16_f32 v18, v140, v141
    v_cvt_pk_bf16_f32 v19, v142, v143
    ds_write_b64 v49, v[18:19] offset:16448
    buffer_load_dwordx4 a[248:251], v240, s[48:51], s71 offen offset:2048 sc1
    v_cvt_pk_bf16_f32 v20, v144, v145
    v_cvt_pk_bf16_f32 v21, v146, v147
    ds_write_b64 v49, v[20:21] offset:16512
    buffer_load_dwordx4 a[252:255], v240, s[48:51], s71 offen offset:3072 sc1
    v_cvt_pk_bf16_f32 v22, v148, v149
    v_cvt_pk_bf16_f32 v23, v150, v151
    ds_write_b64 v49, v[22:23] offset:16576
    s_waitcnt vmcnt(7)
    v_cmp_gt_u32 vcc, 1, v59
    s_nop 1
    s_cbranch_vccnz L_chk11_slow
L_chk11:
    s_waitcnt lgkmcnt(0)
    s_barrier
    s_mov_b32 s12, 0
    buffer_load_dwordx4 v[216:219], v228, s[48:51], s12 offen sc1
    s_mov_b32 s12, 4096
    buffer_load_dwordx4 v[220:223], v229, s[48:51], s12 offen sc1
    s_add_u32 m0, s73, 0
    s_add_u32 s74, s72, 0
    buffer_load_dwordx4 v240, s[48:51], s74 offen offset:0 sc1 lds
    buffer_load_dwordx4 v240, s[48:51], s74 offen offset:1024 sc1 lds
    buffer_load_dwordx4 v240, s[48:51], s74 offen offset:2048 sc1 lds
    buffer_load_dwordx4 v240, s[48:51], s74 offen offset:3072 sc1 lds
    s_add_u32 m0, s73, 4096
    s_add_u32 s74, s72, 4096
    buffer_load_dwordx4 v240, s[48:51], s74 offen offset:0 sc1 lds
    ds_read_b64_tr_b16 v[32:33], v50 offset:16384
    ds_read_b64_tr_b16 v[34:35], v50 offset:16640
    ds_read_b64_tr_b16 v[36:37], v50 offset:16416
    ds_read_b64_tr_b16 v[38:39], v50 offset:16672
    s_mov_b32 s14, 81920
    s_waitcnt lgkmcnt(2)
    buffer_store_dwordx4 v[32:35], v51, s[48:51], s14 offen sc1
    s_mov_b32 s14, 409600
    s_waitcnt lgkmcnt(0)
    buffer_store_dwordx4 v[36:39], v51, s[48:51], s14 offen sc1
    s_branch L_ffn
.p2align 8
L_helper:
    s_sub_u32 s15, s2, 160
    s_cmp_eq_u32 s3, 0
    s_cbranch_scc0 L_nozero
    v_mov_b32 v60, 0
    v_mov_b32 v61, 0
    v_mov_b32 v62, 0
    v_mov_b32 v63, 0
    s_mul_i32 s5, s15, 104
    s_addk_i32 s5, 6112
    v_add_lshl_u32 v55, s5, v0, 4
    v_and_b32 v56, 16, v0
    v_mad_u32_u24 v56, v56, 63, v0
    s_lshl_b32 s4, s15, 4
    v_add_lshl_u32 v56, s4, v56, 4
    v_cmp_gt_u32 vcc, 32, v0
    s_waitcnt lgkmcnt(0)
    global_store_dwordx4 v55, v[60:63], s[46:47] offset:1024 sc1
    v_cndmask_b32 v56, v55, v56, vcc
    global_store_dwordx4 v56, v[60:63], s[46:47] sc1
    s_mov_b64 exec, 255
    global_store_dwordx4 v55, v[60:63], s[46:47] offset:2048 sc1
    s_mov_b64 exec, -1
L_nozero:
    s_barrier
    s_and_b32 s6, s15, 3
    s_lshl2_add_u32 s6, s6, s3
    s_and_b32 s5, s15, 12
    s_lshr_b32 s4, s15, 4
    s_add_u32 s4, s4, s5
    s_lshl_b32 s6, s6, 6
    s_add_u32 s6, s6, s4
    v_and_b32 v2, 48, v0
    v_add_u32 v2, s6, v2
    v_bfe_u32 v3, v0, 3, 1
    v_lshl_add_u32 v2, v2, 1, v3
    v_mul_u32_u24 v2, 80, v2
    v_and_or_b32 v2, v0, 7, v2
    v_lshlrev_b32 v2, 4, v2
    s_waitcnt lgkmcnt(0)
    global_load_dwordx4 v[8:11], v2, s[16:17] offset:0
    global_load_dwordx4 v[12:15], v2, s[16:17] offset:128
    global_load_dwordx4 v[16:19], v2, s[16:17] offset:256
    global_load_dwordx4 v[20:23], v2, s[16:17] offset:384
    global_load_dwordx4 v[24:27], v2, s[16:17] offset:512
    global_load_dwordx4 v[28:31], v2, s[16:17] offset:640
    global_load_dwordx4 v[32:35], v2, s[16:17] offset:768
    global_load_dwordx4 v[36:39], v2, s[16:17] offset:896
    global_load_dwordx4 v[40:43], v2, s[16:17] offset:1024
    global_load_dwordx4 v[44:47], v2, s[16:17] offset:1152
    s_mov_b32 s50, 15859712
    s_mov_b32 s51, 0x20000
    s_mov_b32 s54, 2621440
    s_mov_b32 s55, 0x20000
    s_movk_i32 s62, 256
    s_mov_b32 s63, 0x20000
    s_cmp_eq_u32 s3, 0
    s_cselect_b32 s79, 1, 0
    v_lshlrev_b32 v240, 4, v0
    s_waitcnt lgkmcnt(0)
    s_mov_b64 s[48:49], s[46:47]
    s_mov_b64 s[52:53], s[42:43]
    s_mov_b64 s[60:61], s[44:45]
    v_mov_b32 v57, 2147483632
    s_waitcnt vmcnt(10)
    s_lshl_b32 s4, s15, 2
    s_cmp_eq_u32 s3, 0
    s_cselect_b32 s5, 1, 0
    v_mov_b32 v56, s4
    v_cmp_gt_u32 vcc, s5, v0
    s_nop 1
    v_cndmask_b32 v56, v57, v56, vcc
    v_mov_b32 v58, 1
    buffer_store_dword v58, v56, s[60:63], 0 offen sc1
    s_barrier
    s_add_u32 s4, s15, 32
    s_mul_i32 s5, s4, 43
    s_lshr_b32 s5, s5, 9
    s_mul_i32 s6, s5, 95
    s_lshl_b32 s4, s4, 3
    s_sub_u32 s88, s4, s6
    s_and_b32 s4, s88, 7
    s_mul_i32 s4, s4, 10
    s_and_b32 s5, s3, 1
    s_add_u32 s4, s4, s5
    s_mulk_i32 s4, 24576
    s_lshr_b32 s6, s88, 3
    s_lshl_b32 s6, s6, 8
    s_add_u32 s4, s4, s6
    v_lshrrev_b32 v51, 4, v0
    v_mul_u32_u24 v50, 3072, v51
    v_lshl_add_u32 v51, s3, 2, v51
    v_xor_b32 v51, v51, v0
    v_and_b32 v51, 15, v51
    v_lshl_add_u32 v50, v51, 4, v50
    s_lshl_b32 s5, s5, 11
    s_lshr_b32 s6, s3, 1
    s_mulk_i32 s6, 20480
    s_add_u32 m0, s5, s6
    v_add_u32 v51, 11264, v50
    s_mov_b32 s58, 1966080
    s_mov_b32 s59, 0x20000
    s_mov_b32 s5, 49152
    s_bitcmp1_b32 s3, 1
    s_waitcnt lgkmcnt(0)
    s_cselect_b64 s[56:57], s[38:39], s[36:37]
    buffer_load_dwordx4 v50, s[56:59], s4 offen nt lds
    buffer_load_dwordx4 v51, s[56:59], s4 offen offset:1024 nt lds
    s_addk_i32 m0, 4096
    s_add_u32 s4, s4, s5
    buffer_load_dwordx4 v50, s[56:59], s4 offen nt lds
    buffer_load_dwordx4 v51, s[56:59], s4 offen offset:1024 nt lds
    s_addk_i32 m0, 4096
    s_add_u32 s4, s4, s5
    buffer_load_dwordx4 v50, s[56:59], s4 offen nt lds
    buffer_load_dwordx4 v51, s[56:59], s4 offen offset:1024 nt lds
    s_addk_i32 m0, 4096
    s_add_u32 s4, s4, s5
    buffer_load_dwordx4 v50, s[56:59], s4 offen nt lds
    buffer_load_dwordx4 v51, s[56:59], s4 offen offset:1024 nt lds
    s_addk_i32 m0, 4096
    s_add_u32 s4, s4, s5
    buffer_load_dwordx4 v50, s[56:59], s4 offen nt lds
    buffer_load_dwordx4 v51, s[56:59], s4 offen offset:1024 nt lds
    s_barrier
    s_mov_b32 s4, 0x3f803f80
    v_mov_b32 v4, 0
    v_mov_b32 v5, 0
    v_mov_b32 v6, 0
    v_mov_b32 v7, 0
    s_waitcnt vmcnt(20)
    v_dot2c_f32_bf16 v4, s4, v8
    v_dot2c_f32_bf16 v6, v8, v8
    v_dot2c_f32_bf16 v5, s4, v9
    v_dot2c_f32_bf16 v7, v9, v9
    v_dot2c_f32_bf16 v4, s4, v10
    v_dot2c_f32_bf16 v6, v10, v10
    v_dot2c_f32_bf16 v5, s4, v11
    v_dot2c_f32_bf16 v7, v11, v11
    s_waitcnt vmcnt(19)
    v_dot2c_f32_bf16 v4, s4, v12
    v_dot2c_f32_bf16 v6, v12, v12
    v_dot2c_f32_bf16 v5, s4, v13
    v_dot2c_f32_bf16 v7, v13, v13
    v_dot2c_f32_bf16 v4, s4, v14
    v_dot2c_f32_bf16 v6, v14, v14
    v_dot2c_f32_bf16 v5, s4, v15
    v_dot2c_f32_bf16 v7, v15, v15
    s_waitcnt vmcnt(18)
    v_dot2c_f32_bf16 v4, s4, v16
    v_dot2c_f32_bf16 v6, v16, v16
    v_dot2c_f32_bf16 v5, s4, v17
    v_dot2c_f32_bf16 v7, v17, v17
    v_dot2c_f32_bf16 v4, s4, v18
    v_dot2c_f32_bf16 v6, v18, v18
    v_dot2c_f32_bf16 v5, s4, v19
    v_dot2c_f32_bf16 v7, v19, v19
    s_waitcnt vmcnt(17)
    v_dot2c_f32_bf16 v4, s4, v20
    v_dot2c_f32_bf16 v6, v20, v20
    v_dot2c_f32_bf16 v5, s4, v21
    v_dot2c_f32_bf16 v7, v21, v21
    v_dot2c_f32_bf16 v4, s4, v22
    v_dot2c_f32_bf16 v6, v22, v22
    v_dot2c_f32_bf16 v5, s4, v23
    v_dot2c_f32_bf16 v7, v23, v23
    s_waitcnt vmcnt(16)
    v_dot2c_f32_bf16 v4, s4, v24
    v_dot2c_f32_bf16 v6, v24, v24
    v_dot2c_f32_bf16 v5, s4, v25
    v_dot2c_f32_bf16 v7, v25, v25
    v_dot2c_f32_bf16 v4, s4, v26
    v_dot2c_f32_bf16 v6, v26, v26
    v_dot2c_f32_bf16 v5, s4, v27
    v_dot2c_f32_bf16 v7, v27, v27
    s_waitcnt vmcnt(15)
    v_dot2c_f32_bf16 v4, s4, v28
    v_dot2c_f32_bf16 v6, v28, v28
    v_dot2c_f32_bf16 v5, s4, v29
    v_dot2c_f32_bf16 v7, v29, v29
    v_dot2c_f32_bf16 v4, s4, v30
    v_dot2c_f32_bf16 v6, v30, v30
    v_dot2c_f32_bf16 v5, s4, v31
    v_dot2c_f32_bf16 v7, v31, v31
    s_waitcnt vmcnt(14)
    v_dot2c_f32_bf16 v4, s4, v32
    v_dot2c_f32_bf16 v6, v32, v32
    v_dot2c_f32_bf16 v5, s4, v33
    v_dot2c_f32_bf16 v7, v33, v33
    v_dot2c_f32_bf16 v4, s4, v34
    v_dot2c_f32_bf16 v6, v34, v34
    v_dot2c_f32_bf16 v5, s4, v35
    v_dot2c_f32_bf16 v7, v35, v35
    s_waitcnt vmcnt(13)
    v_dot2c_f32_bf16 v4, s4, v36
    v_dot2c_f32_bf16 v6, v36, v36
    v_dot2c_f32_bf16 v5, s4, v37
    v_dot2c_f32_bf16 v7, v37, v37
    v_dot2c_f32_bf16 v4, s4, v38
    v_dot2c_f32_bf16 v6, v38, v38
    v_dot2c_f32_bf16 v5, s4, v39
    v_dot2c_f32_bf16 v7, v39, v39
    s_waitcnt vmcnt(12)
    v_dot2c_f32_bf16 v4, s4, v40
    v_dot2c_f32_bf16 v6, v40, v40
    v_dot2c_f32_bf16 v5, s4, v41
    v_dot2c_f32_bf16 v7, v41, v41
    v_dot2c_f32_bf16 v4, s4, v42
    v_dot2c_f32_bf16 v6, v42, v42
    v_dot2c_f32_bf16 v5, s4, v43
    v_dot2c_f32_bf16 v7, v43, v43
    s_waitcnt vmcnt(11)
    v_dot2c_f32_bf16 v4, s4, v44
    v_dot2c_f32_bf16 v6, v44, v44
    v_dot2c_f32_bf16 v5, s4, v45
    v_dot2c_f32_bf16 v7, v45, v45
    v_dot2c_f32_bf16 v4, s4, v46
    v_dot2c_f32_bf16 v6, v46, v46
    v_dot2c_f32_bf16 v5, s4, v47
    v_dot2c_f32_bf16 v7, v47, v47
    s_nop 1
    v_add_f32 v4, v4, v5
    v_add_f32 v6, v6, v7
    s_nop 0
    v_add_f32_dpp v4, v4, v4 quad_perm:[1,0,3,2] row_mask:0xf bank_mask:0xf
    v_add_f32_dpp v6, v6, v6 quad_perm:[1,0,3,2] row_mask:0xf bank_mask:0xf
    s_nop 0
    v_add_f32_dpp v4, v4, v4 quad_perm:[2,3,0,1] row_mask:0xf bank_mask:0xf
    v_add_f32_dpp v6, v6, v6 quad_perm:[2,3,0,1] row_mask:0xf bank_mask:0xf
    s_nop 0
    v_add_f32_dpp v4, v4, v4 row_half_mirror row_mask:0xf bank_mask:0xf
    v_add_f32_dpp v6, v6, v6 row_half_mirror row_mask:0xf bank_mask:0xf
    v_mul_f32 v4, 0x3acccccd, v4
    v_mul_f32 v6, 0x3acccccd, v6
    v_fma_f32 v6, -v4, v4, v6
    v_max_f32 v6, 0, v6
    v_cvt_pk_bf16_f32 v5, v4, v6
    v_lshlrev_b32 v7, 16, v5
    v_and_b32 v5, 0xffff0000, v5
    v_add_f32 v5, 0x3727c5ac, v5
    v_cvt_pk_bf16_f32 v5, v5, v5
    v_and_b32 v5, 0xffff0000, v5
    v_sqrt_f32 v5, v5
    s_nop 0
    v_cvt_pk_bf16_f32 v5, v5, v5
    v_and_b32 v8, 0xffff0000, v5
    v_rcp_f32 v10, v8
    s_lshl_b32 s4, s15, 8
    s_lshl_b32 s5, s3, 6
    s_add_u32 s4, s4, s5
    v_or_b32 v10, 1, v10
    v_mul_f32 v11, -v7, v10
    v_and_b32 v3, 7, v0
    v_add_u32 v2, s4, v0
    v_cmp_eq_u32 vcc, 0, v3
    v_mov_b32 v9, 2147483632
    s_nop 0
    v_cndmask_b32 v2, v9, v2, vcc
    buffer_store_dwordx2 v[10:11], v2, s[48:51], 0 offen sc1
    s_branch L_h_pack
.p2align 8
L_h_nostat:
    s_sub_u32 s15, s2, 160
    s_sub_u32 s4, s15, 64
    s_mul_i32 s5, s4, 43
    s_lshr_b32 s5, s5, 9
    s_mul_i32 s6, s5, 95
    s_lshl_b32 s4, s4, 3
    s_sub_u32 s88, s4, s6
    s_and_b32 s4, s88, 7
    s_mul_i32 s4, s4, 10
    s_and_b32 s5, s3, 1
    s_add_u32 s4, s4, s5
    s_mulk_i32 s4, 24576
    s_lshr_b32 s6, s88, 3
    s_lshl_b32 s6, s6, 8
    s_add_u32 s4, s4, s6
    v_lshrrev_b32 v51, 4, v0
    v_mul_u32_u24 v50, 3072, v51
    v_lshl_add_u32 v51, s3, 2, v51
    v_xor_b32 v51, v51, v0
    v_and_b32 v51, 15, v51
    v_lshl_add_u32 v50, v51, 4, v50
    s_lshl_b32 s5, s5, 11
    s_lshr_b32 s6, s3, 1
    s_mulk_i32 s6, 20480
    s_add_u32 m0, s5, s6
    v_add_u32 v51, 11264, v50
    s_mov_b32 s58, 1966080
    s_mov_b32 s59, 0x20000
    s_mov_b32 s5, 49152
    s_bitcmp1_b32 s3, 1
    s_waitcnt lgkmcnt(0)
    s_cselect_b64 s[56:57], s[38:39], s[36:37]
    buffer_load_dwordx4 v50, s[56:59], s4 offen nt lds
    buffer_load_dwordx4 v51, s[56:59], s4 offen offset:1024 nt lds
    s_addk_i32 m0, 4096
    s_add_u32 s4, s4, s5
    buffer_load_dwordx4 v50, s[56:59], s4 offen nt lds
    buffer_load_dwordx4 v51, s[56:59], s4 offen offset:1024 nt lds
    s_addk_i32 m0, 4096
    s_add_u32 s4, s4, s5
    buffer_load_dwordx4 v50, s[56:59], s4 offen nt lds
    buffer_load_dwordx4 v51, s[56:59], s4 offen offset:1024 nt lds
    s_addk_i32 m0, 4096
    s_add_u32 s4, s4, s5
    buffer_load_dwordx4 v50, s[56:59], s4 offen nt lds
    buffer_load_dwordx4 v51, s[56:59], s4 offen offset:1024 nt lds
    s_addk_i32 m0, 4096
    s_add_u32 s4, s4, s5
    buffer_load_dwordx4 v50, s[56:59], s4 offen nt lds
    buffer_load_dwordx4 v51, s[56:59], s4 offen offset:1024 nt lds
    s_mov_b32 s50, 15859712
    s_mov_b32 s51, 0x20000
    s_mov_b32 s54, 2621440
    s_mov_b32 s55, 0x20000
    s_movk_i32 s62, 256
    s_mov_b32 s63, 0x20000
    s_cmp_eq_u32 s3, 0
    s_cselect_b32 s79, 1, 0
    v_lshlrev_b32 v240, 4, v0
    s_waitcnt lgkmcnt(0)
    s_mov_b64 s[48:49], s[46:47]
    s_mov_b64 s[52:53], s[42:43]
    s_mov_b64 s[60:61], s[44:45]
    v_mov_b32 v8, 2147483632
    buffer_store_dword v8, v8, s[48:51], 0 offen
L_h_pack:
    s_sub_u32 s14, 95, s15
    v_lshrrev_b32 v2, 1, v0
    v_xor_b32 v2, v2, v0
    v_bfe_u32 v2, v2, 1, 1
    v_mul_u32_u24 v2, 6, v2
    v_xor_b32 v2, v2, v0
    v_lshlrev_b32 v241, 4, v2
    v_bfe_u32 v2, v0, 2, 2
    v_bfe_u32 v3, v0, 4, 1
    v_and_b32 v4, 1, v0
    v_lshl_add_u32 v5, v3, 2, v2
    v_lshl_add_u32 v5, v4, 3, v5
    v_lshl_add_u32 v2, v3, 3, v2
    v_lshlrev_b32 v2, 8, v2
    v_mul_u32_u24 v4, 20480, v4
    v_bfe_u32 v3, v0, 1, 1
    v_lshl_add_u32 v4, v3, 3, v4
    v_lshrrev_b32 v8, 5, v0
    v_lshl_add_u32 v8, s3, 2, v8
    v_xor_b32 v5, v5, v8
    v_lshl_add_u32 v4, v5, 4, v4
    v_add3_u32 v2, v2, v4, 0
    v_xor_b32 v3, 32, v2
    s_lshr_b32 s6, s88, 3
    v_lshl_add_u32 v8, s6, 4, v8
    v_and_b32 v9, 31, v0
    v_lshlrev_b32 v9, 4, v9
    v_add_u32 v10, 0, v8
    v_mul_u32_u24 v11, 171, v10
    v_lshrrev_b32 v11, 9, v11
    v_mad_u32_u24 v10, v11, 57, v10
    v_lshl_add_u32 v4, v10, 10, v9
    v_add_u32 v10, 2, v8
    v_mul_u32_u24 v11, 171, v10
    v_lshrrev_b32 v11, 9, v11
    v_mad_u32_u24 v10, v11, 57, v10
    v_lshl_add_u32 v5, v10, 10, v9
    v_mov_b32 v6, 0
    v_mov_b32 v7, 0
    s_mov_b32 s10, 0x3f803f80
    s_and_b32 s7, s88, 7
    s_mul_i32 s8, s7, 5
    s_waitcnt vmcnt(9)
    s_barrier
    ds_read_b64_tr_b16 v[64:65], v2 offset:0
    ds_read_b64_tr_b16 v[66:67], v2 offset:1024
    ds_read_b64_tr_b16 v[84:85], v3 offset:0
    ds_read_b64_tr_b16 v[86:87], v3 offset:1024
    s_lshr_b32 s9, s8, 1
    s_mul_i32 s9, s9, 2048
    s_lshl_b32 s11, s8, 9
    s_add_u32 s9, s9, s11
    s_add_u32 s9, s9, 1048576
    s_add_u32 s8, s8, 1
    s_waitcnt lgkmcnt(3)
    v_dot2c_f32_bf16 v6, s10, v64
    v_dot2c_f32_bf16 v6, s10, v65
    s_waitcnt lgkmcnt(2)
    v_dot2c_f32_bf16 v6, s10, v66
    v_dot2c_f32_bf16 v6, s10, v67
    buffer_store_dwordx4 v[64:67], v4, s[48:51], s9 offen sc1
    s_waitcnt lgkmcnt(1)
    v_dot2c_f32_bf16 v7, s10, v84
    v_dot2c_f32_bf16 v7, s10, v85
    s_waitcnt lgkmcnt(0)
    v_dot2c_f32_bf16 v7, s10, v86
    v_dot2c_f32_bf16 v7, s10, v87
    buffer_store_dwordx4 v[84:87], v5, s[48:51], s9 offen sc1
    s_waitcnt vmcnt(9)
    s_barrier
    ds_read_b64_tr_b16 v[68:69], v2 offset:4096
    ds_read_b64_tr_b16 v[70:71], v2 offset:5120
    ds_read_b64_tr_b16 v[88:89], v3 offset:4096
    ds_read_b64_tr_b16 v[90:91], v3 offset:5120
    s_lshr_b32 s9, s8, 1
    s_mul_i32 s9, s9, 2048
    s_lshl_b32 s11, s8, 9
    s_add_u32 s9, s9, s11
    s_add_u32 s9, s9, 1048576
    s_add_u32 s8, s8, 1
    s_waitcnt lgkmcnt(3)
    v_dot2c_f32_bf16 v6, s10, v68
    v_dot2c_f32_bf16 v6, s10, v69
    s_waitcnt lgkmcnt(2)
    v_dot2c_f32_bf16 v6, s10, v70
    v_dot2c_f32_bf16 v6, s10, v71
    buffer_store_dwordx4 v[68:71], v4, s[48:51], s9 offen sc1
    s_waitcnt lgkmcnt(1)
    v_dot2c_f32_bf16 v7, s10, v88
    v_dot2c_f32_bf16 v7, s10, v89
    s_waitcnt lgkmcnt(0)
    v_dot2c_f32_bf16 v7, s10, v90
    v_dot2c_f32_bf16 v7, s10, v91
    buffer_store_dwordx4 v[88:91], v5, s[48:51], s9 offen sc1
    s_waitcnt vmcnt(9)
    s_barrier
    ds_read_b64_tr_b16 v[72:73], v2 offset:8192
    ds_read_b64_tr_b16 v[74:75], v2 offset:9216
    ds_read_b64_tr_b16 v[92:93], v3 offset:8192
    ds_read_b64_tr_b16 v[94:95], v3 offset:9216
    s_lshr_b32 s9, s8, 1
    s_mul_i32 s9, s9, 2048
    s_lshl_b32 s11, s8, 9
    s_add_u32 s9, s9, s11
    s_add_u32 s9, s9, 1048576
    s_add_u32 s8, s8, 1
    s_waitcnt lgkmcnt(3)
    v_dot2c_f32_bf16 v6, s10, v72
    v_dot2c_f32_bf16 v6, s10, v73
    s_waitcnt lgkmcnt(2)
    v_dot2c_f32_bf16 v6, s10, v74
    v_dot2c_f32_bf16 v6, s10, v75
    buffer_store_dwordx4 v[72:75], v4, s[48:51], s9 offen sc1
    s_waitcnt lgkmcnt(1)
    v_dot2c_f32_bf16 v7, s10, v92
    v_dot2c_f32_bf16 v7, s10, v93
    s_waitcnt lgkmcnt(0)
    v_dot2c_f32_bf16 v7, s10, v94
    v_dot2c_f32_bf16 v7, s10, v95
    buffer_store_dwordx4 v[92:95], v5, s[48:51], s9 offen sc1
    s_waitcnt vmcnt(9)
    s_barrier
    ds_read_b64_tr_b16 v[76:77], v2 offset:12288
    ds_read_b64_tr_b16 v[78:79], v2 offset:13312
    ds_read_b64_tr_b16 v[96:97], v3 offset:12288
    ds_read_b64_tr_b16 v[98:99], v3 offset:13312
    s_lshr_b32 s9, s8, 1
    s_mul_i32 s9, s9, 2048
    s_lshl_b32 s11, s8, 9
    s_add_u32 s9, s9, s11
    s_add_u32 s9, s9, 1048576
    s_add_u32 s8, s8, 1
    s_waitcnt lgkmcnt(3)
    v_dot2c_f32_bf16 v6, s10, v76
    v_dot2c_f32_bf16 v6, s10, v77
    s_waitcnt lgkmcnt(2)
    v_dot2c_f32_bf16 v6, s10, v78
    v_dot2c_f32_bf16 v6, s10, v79
    buffer_store_dwordx4 v[76:79], v4, s[48:51], s9 offen sc1
    s_waitcnt lgkmcnt(1)
    v_dot2c_f32_bf16 v7, s10, v96
    v_dot2c_f32_bf16 v7, s10, v97
    s_waitcnt lgkmcnt(0)
    v_dot2c_f32_bf16 v7, s10, v98
    v_dot2c_f32_bf16 v7, s10, v99
    buffer_store_dwordx4 v[96:99], v5, s[48:51], s9 offen sc1
    s_waitcnt vmcnt(9)
    s_barrier
    ds_read_b64_tr_b16 v[80:81], v2 offset:16384
    ds_read_b64_tr_b16 v[82:83], v2 offset:17408
    ds_read_b64_tr_b16 v[100:101], v3 offset:16384
    ds_read_b64_tr_b16 v[102:103], v3 offset:17408
    s_lshr_b32 s9, s8, 1
    s_mul_i32 s9, s9, 2048
    s_lshl_b32 s11, s8, 9
    s_add_u32 s9, s9, s11
    s_add_u32 s9, s9, 1048576
    s_add_u32 s8, s8, 1
    s_waitcnt lgkmcnt(3)
    v_dot2c_f32_bf16 v6, s10, v80
    v_dot2c_f32_bf16 v6, s10, v81
    s_waitcnt lgkmcnt(2)
    v_dot2c_f32_bf16 v6, s10, v82
    v_dot2c_f32_bf16 v6, s10, v83
    buffer_store_dwordx4 v[80:83], v4, s[48:51], s9 offen sc1
    s_waitcnt lgkmcnt(1)
    v_dot2c_f32_bf16 v7, s10, v100
    v_dot2c_f32_bf16 v7, s10, v101
    s_waitcnt lgkmcnt(0)
    v_dot2c_f32_bf16 v7, s10, v102
    v_dot2c_f32_bf16 v7, s10, v103
    buffer_store_dwordx4 v[100:103], v5, s[48:51], s9 offen sc1
    s_lshl_b32 s8, s7, 4
    s_add_u32 s8, s8, 786432
    v_bfe_u32 v10, v0, 4, 1
    v_lshl_add_u32 v8, v10, 1, v8
    v_permlane16_swap_b32 v6, v7
    v_bfe_u32 v9, v241, 6, 2
    v_lshl_add_u32 v8, v8, 2, v9
    v_bfe_u32 v9, v241, 4, 2
    v_lshl_add_u32 v8, v8, 5, v9
    v_lshlrev_b32 v8, 2, v8
    v_add_f32 v6, v6, v7
    buffer_store_dword v6, v8, s[48:51], s8 offen sc1
    v_lshlrev_b32 v56, 2, v0
    buffer_load_dword v57, v56, s[60:63], 0 offen sc1
    s_bfe_u32 s4, s2, 0x10002
    s_lshl_b32 s4, s4, 3
    s_lshr_b32 s6, s2, 5
    s_bfe_u32 s5, s2, 0x20003
    s_lshl_b32 s7, s5, 1
    s_add_u32 s6, s6, s7
    s_and_b32 s6, s6, 7
    s_add_u32 s64, s4, s6
    s_and_b32 s4, s2, 3
    s_lshl_b32 s4, s4, 2
    s_add_u32 s65, s4, s5
    s_and_b32 s66, s2, 1
    s_and_b32 s4, s2, 2
    s_lshl_b32 s4, s4, 1
    s_add_u32 s67, s4, s5
    s_mul_i32 s72, s64, 163840
    s_mul_i32 s73, s3, 5120
    s_add_u32 s72, s72, s73
    s_add_u32 s72, s72, 6946816
    s_lshl_b32 s6, s65, 2
    s_add_u32 s6, s6, s3
    s_mul_i32 s68, s6, 61440
    s_add_u32 s68, s68, 1048576
    s_lshl_b32 s6, s67, 2
    s_add_u32 s6, s6, s3
    s_mul_i32 s70, s6, 61440
    s_add_u32 s70, s70, 4980736
    s_call_b64 s[74:75], L_warm_f
    s_and_b32 s4, s2, 0
    s_lshl_b32 s4, s4, 2
    s_add_u32 s4, s4, s3
    s_mul_i32 s4, s4, 5120
    s_add_u32 s4, s4, 98304
    v_min_u32 v251, 39, v0
    v_lshl_add_u32 v251, v251, 7, s4
    v_mov_b32 v47, 2147483632
    s_lshr_b32 s4, s65, 2
    s_mul_i32 s4, s4, 20480
    s_and_b32 s5, s65, 3
    s_lshl_b32 s5, s5, 5
    s_add_u32 s4, s4, s5
    s_add_u32 s4, s4, s72
    v_lshrrev_b32 v46, 1, v0
    v_lshl_add_u32 v46, v46, 7, s4
    v_and_or_b32 v228, v240, 16, v46
    v_cmp_gt_u32 s[8:9], 16, v0
    s_nop 1
    v_cndmask_b32 v229, v47, v228, s[8:9]
    v_lshlrev_b32 v242, 3, v0
    v_add_u32 v243, 81920, v242
    s_mul_i32 s5, s64, 393216
    s_lshl_b32 s6, s65, 2
    s_add_u32 s6, s6, s3
    s_mul_i32 s7, s6, 768
    s_add_u32 s5, s5, s7
    s_add_u32 s5, s5, 9568256
    v_add_u32 v46, s5, v240
    v_mov_b32 v47, 2147483632
    v_cmp_gt_u32 s[8:9], 48, v0
    s_nop 1
    v_cndmask_b32 v244, v47, v46, s[8:9]
    s_lshl_b32 s4, s64, 10
    s_add_u32 s4, s4, 16384
    v_and_b32 v46, 15, v0
    v_lshl_add_u32 v245, v46, 4, s4
    s_lshl_b32 s5, s64, 4
    s_add_u32 s5, s5, s65
    s_lshl_b32 s5, s5, 5
    s_add_u32 s5, s5, s3
    s_lshl_b32 s5, s5, 2
    s_add_u32 s5, s5, 131072
    v_mov_b32 v46, s5
    v_cmp_eq_u32 s[8:9], 0, v0
    s_nop 1
    v_cndmask_b32 v246, v47, v46, s[8:9]
    s_lshr_b32 s5, s65, 3
    s_lshl_b32 s5, s5, 8
    s_add_u32 s4, s4, s5
    s_and_b32 s5, s65, 3
    s_lshl_b32 s5, s5, 6
    s_add_u32 s4, s4, s5
    s_and_b32 s5, s65, 4
    s_lshl_b32 s5, s5, 1
    s_add_u32 s4, s4, s5
    v_add_u32 v46, s4, v240
    s_lshl_b32 s4, s79, 2
    v_cmp_gt_u32 s[8:9], s4, v0
    s_nop 1
    v_cndmask_b32 v232, v47, v46, s[8:9]
    v_and_b32 v46, 1, v0
    v_lshrrev_b32 v47, 4, v0
    v_lshl_add_u32 v46, v46, 2, v47
    s_lshl_b32 s4, s3, 2
    s_add_u32 s4, s4, 143360
    v_lshl_add_u32 v230, v46, 4, s4
    v_and_b32 v47, 3, v0
    s_mov_b32 s4, 143360
    v_lshl_add_u32 v231, v47, 5, s4
    s_lshl_b32 s4, s64, 2
    s_add_u32 s4, s4, s3
    s_lshl_b32 s4, s4, 9
    s_add_u32 s4, s4, 131072
    v_bfe_u32 v46, v0, 2, 2
    v_lshl_add_u32 v46, v46, 5, v47
    v_lshl_add_u32 v247, v46, 2, s4
    s_lshl_b32 s4, s64, 3
    s_add_u32 s4, s4, s66
    s_mul_i32 s76, s4, 49152
    s_mul_i32 s5, s3, 12288
    s_add_u32 s76, s76, s5
    s_add_u32 s76, s76, 9568256
    s_mul_i32 s91, s3, 3072
    s_add_u32 s4, s73, 20480
    v_add_u32 v248, s4, v240
    v_add_u32 v249, 61440, v248
    s_add_u32 s4, s91, 143872
    v_add_u32 v250, s4, v240
    s_mov_b32 s82, s70
    v_mov_b32 v252, 2147483632
    s_mul_i32 s4, s67, 5
    s_lshr_b32 s4, s4, 3
    s_min_u32 s4, s4, 3
    s_mul_i32 s5, s3, 20
    s_add_u32 s4, s4, s5
    s_lshl_b32 s4, s4, 5
    s_sub_u32 s4, 203744, s4
    v_bfe_u32 v234, v0, 1, 2
    v_mul_u32_u24 v234, 5, v234
    v_and_b32 v235, 1, v0
    v_add_lshl_u32 v234, v234, v235, 5
    v_sub_u32 v234, s4, v234
    s_mul_i32 s4, s65, 3
    s_lshr_b32 s4, s4, 2
    s_min_u32 s4, s4, 10
    s_lshl_b32 s4, s4, 10
    s_add_u32 s4, s4, 118784
    v_and_b32 v54, 15, v0
    v_lshl_add_u32 v54, v54, 7, s4
    v_and_b32 v48, 4294966527, v54
    s_waitcnt vmcnt(0)
    v_cmp_eq_u32 vcc, 0, v57
    s_nop 1
    s_cbranch_vccnz L_chk13_slow
L_chk13:
    s_barrier
    s_lshl_b32 s4, s88, 7
    s_add_u32 s4, s4, 118784
    s_mul_i32 s5, s79, 1
    v_mul_u32_u24 v56, 20480, v0
    v_add_u32 v56, s4, v56
    v_mov_b32 v57, 2147483632
    v_cmp_gt_u32 s[8:9], s5, v0
    s_nop 1
    v_cndmask_b32 v56, v57, v56, s[8:9]
    v_mov_b32 v57, 1
    buffer_store_dword v57, v56, s[48:51], 0 offen sc1
    buffer_load_dword v49, v48, s[48:51], 0 offen sc1
    s_mov_b32 s84, s40
    s_mov_b32 s85, s41
    s_mov_b32 s86, 1966080
    s_mov_b32 s87, 0x20000
    s_mul_i32 s12, s14, 205
    s_lshr_b32 s12, s12, 10
    s_mul_i32 s13, s12, 5
    s_sub_u32 s13, s14, s13
    s_mul_i32 s4, s12, 96
    s_mul_i32 s5, s3, 24
    s_add_u32 s4, s4, s5
    s_mul_i32 s4, s4, 1280
    s_lshl_b32 s5, s13, 8
    s_add_u32 s4, s4, s5
    v_lshrrev_b32 v52, 4, v0
    v_mul_u32_u24 v52, 1280, v52
    v_and_b32 v53, 15, v0
    v_lshl_add_u32 v52, v53, 4, v52
    v_add_u32 v52, s4, v52
    s_mul_i32 s5, s3, 6144
    s_add_u32 m0, s5, 40960
    s_nop 0
    buffer_load_dwordx4 v52, s[84:87], 0 offen nt lds
    v_add_u32 v52, 5120, v52
    s_add_u32 m0, s5, 41984
    s_nop 0
    buffer_load_dwordx4 v52, s[84:87], 0 offen nt lds
    v_add_u32 v52, 5120, v52
    s_add_u32 m0, s5, 43008
    s_nop 0
    buffer_load_dwordx4 v52, s[84:87], 0 offen nt lds
    v_add_u32 v52, 5120, v52
    s_add_u32 m0, s5, 44032
    s_nop 0
    buffer_load_dwordx4 v52, s[84:87], 0 offen nt lds
    v_add_u32 v52, 5120, v52
    s_add_u32 m0, s5, 45056
    s_nop 0
    buffer_load_dwordx4 v52, s[84:87], 0 offen nt lds
    v_add_u32 v52, 5120, v52
    s_add_u32 m0, s5, 46080
    s_nop 0
    buffer_load_dwordx4 v52, s[84:87], 0 offen nt lds
    v_add_u32 v52, 5120, v52
    s_waitcnt vmcnt(6)
    v_cmp_gt_u32 vcc, 1, v49
    s_nop 1
    s_cbranch_vccnz L_chk15_slow
L_chk15:
    s_add_u32 s69, s68, 0
    buffer_load_dwordx4 a[0:3], v241, s[48:51], s69 offen offset:0 sc1
    buffer_load_dwordx4 a[4:7], v241, s[48:51], s69 offen offset:1024 sc1
    buffer_load_dwordx4 a[8:11], v241, s[48:51], s69 offen offset:2048 sc1
    buffer_load_dwordx4 a[12:15], v241, s[48:51], s69 offen offset:3072 sc1
    s_add_u32 s69, s68, 4096
    buffer_load_dwordx4 a[16:19], v241, s[48:51], s69 offen offset:0 sc1
    buffer_load_dwordx4 a[20:23], v241, s[48:51], s69 offen offset:1024 sc1
    buffer_load_dwordx4 a[24:27], v241, s[48:51], s69 offen offset:2048 sc1
    buffer_load_dwordx4 a[28:31], v241, s[48:51], s69 offen offset:3072 sc1
    s_add_u32 s69, s68, 8192
    buffer_load_dwordx4 a[32:35], v241, s[48:51], s69 offen offset:0 sc1
    buffer_load_dwordx4 a[36:39], v241, s[48:51], s69 offen offset:1024 sc1
    buffer_load_dwordx4 a[40:43], v241, s[48:51], s69 offen offset:2048 sc1
    buffer_load_dwordx4 a[44:47], v241, s[48:51], s69 offen offset:3072 sc1
    s_add_u32 s69, s68, 12288
    buffer_load_dwordx4 a[48:51], v241, s[48:51], s69 offen offset:0 sc1
    buffer_load_dwordx4 a[52:55], v241, s[48:51], s69 offen offset:1024 sc1
    buffer_load_dwordx4 a[56:59], v241, s[48:51], s69 offen offset:2048 sc1
    buffer_load_dword v55, v54, s[48:51], 0 offen sc1
    s_waitcnt vmcnt(16)
    s_cmp_ge_u32 s14, 80
    s_cbranch_scc1 L_h_done
    v_lshrrev_b32 v2, 4, v0
    v_lshlrev_b32 v2, 3, v2
    v_bfe_u32 v3, v0, 2, 1
    v_lshlrev_b32 v3, 8, v3
    v_and_b32 v10, 3, v0
    v_lshl_add_u32 v3, v10, 3, v3
    s_lshl_b32 s4, s3, 6
    s_add_u32 s4, s4, 40960
    v_add_u32 v3, s4, v3
    v_lshlrev_b32 v10, 4, v0
    v_and_b32 v11, 8, v0
    v_cmp_eq_u32 vcc, 0, v11
    v_mov_b32 v12, 0x18040200
    v_mov_b32 v13, 0x200c0a08
    v_cndmask_b32 v12, v13, v12, vcc
    v_bfe_u32 v14, v12, v2, 8
    v_lshl_add_u32 v14, v14, 8, v3
    v_mov_b32 v12, 0x28141210
    v_mov_b32 v13, 0x1e160e06
    v_cndmask_b32 v12, v13, v12, vcc
    v_bfe_u32 v15, v12, v2, 8
    v_lshl_add_u32 v15, v15, 8, v3
    v_mov_b32 v12, 0x32301c1a
    v_mov_b32 v13, 0x3a382422
    v_cndmask_b32 v12, v13, v12, vcc
    v_bfe_u32 v16, v12, v2, 8
    v_lshl_add_u32 v16, v16, 8, v3
    v_mov_b32 v12, 0x42402c2a
    v_mov_b32 v13, 0x3e362e26
    v_cndmask_b32 v12, v13, v12, vcc
    v_bfe_u32 v17, v12, v2, 8
    v_lshl_add_u32 v17, v17, 8, v3
    v_mov_b32 v12, 0x4c4a4834
    v_mov_b32 v13, 0x5452503c
    v_cndmask_b32 v12, v13, v12, vcc
    v_bfe_u32 v18, v12, v2, 8
    v_lshl_add_u32 v18, v18, 8, v3
    v_mov_b32 v12, 0x5c5a5844
    v_mov_b32 v13, 0x5e564e46
    v_cndmask_b32 v12, v13, v12, vcc
    v_bfe_u32 v19, v12, v2, 8
    v_lshl_add_u32 v19, v19, 8, v3
    s_barrier
    ds_read_b64_tr_b16 v[104:105], v14 offset:0
    ds_read_b64_tr_b16 v[106:107], v15 offset:0
    ds_read_b64_tr_b16 v[108:109], v16 offset:0
    ds_read_b64_tr_b16 v[110:111], v17 offset:0
    ds_read_b64_tr_b16 v[112:113], v18 offset:0
    ds_read_b64_tr_b16 v[114:115], v19 offset:0
    ds_read_b64_tr_b16 v[116:117], v14 offset:32
    ds_read_b64_tr_b16 v[118:119], v15 offset:32
    ds_read_b64_tr_b16 v[120:121], v16 offset:32
    ds_read_b64_tr_b16 v[122:123], v17 offset:32
    ds_read_b64_tr_b16 v[124:125], v18 offset:32
    ds_read_b64_tr_b16 v[126:127], v19 offset:32
    s_lshl_b32 s4, s13, 3
    s_lshl_b32 s5, s3, 1
    s_add_u32 s4, s4, s5
    s_add_u32 s4, s4, 0
    s_mul_i32 s5, s4, 205
    s_lshr_b32 s5, s5, 10
    s_mul_i32 s6, s5, 5
    s_sub_u32 s4, s4, s6
    s_mul_i32 s4, s4, 3
    s_lshl_b32 s5, s5, 2
    s_lshr_b32 s6, s12, 2
    s_add_u32 s5, s5, s6
    s_mul_i32 s5, s5, 60
    s_and_b32 s6, s12, 3
    s_mul_i32 s6, s6, 15
    s_add_u32 s5, s5, s6
    s_add_u32 s5, s5, s4
    s_lshl_b32 s5, s5, 10
    s_add_u32 s5, s5, 4980736
    s_waitcnt lgkmcnt(10)
    buffer_store_dwordx4 v[104:107], v10, s[48:51], s5 offen offset:0 sc1
    s_waitcnt lgkmcnt(8)
    buffer_store_dwordx4 v[108:111], v10, s[48:51], s5 offen offset:1024 sc1
    s_waitcnt lgkmcnt(6)
    buffer_store_dwordx4 v[112:115], v10, s[48:51], s5 offen offset:2048 sc1
    s_lshl_b32 s4, s13, 3
    s_lshl_b32 s5, s3, 1
    s_add_u32 s4, s4, s5
    s_add_u32 s4, s4, 1
    s_mul_i32 s5, s4, 205
    s_lshr_b32 s5, s5, 10
    s_mul_i32 s6, s5, 5
    s_sub_u32 s4, s4, s6
    s_mul_i32 s4, s4, 3
    s_lshl_b32 s5, s5, 2
    s_lshr_b32 s6, s12, 2
    s_add_u32 s5, s5, s6
    s_mul_i32 s5, s5, 60
    s_and_b32 s6, s12, 3
    s_mul_i32 s6, s6, 15
    s_add_u32 s5, s5, s6
    s_add_u32 s5, s5, s4
    s_lshl_b32 s5, s5, 10
    s_add_u32 s5, s5, 4980736
    s_waitcnt lgkmcnt(4)
    buffer_store_dwordx4 v[116:119], v10, s[48:51], s5 offen offset:0 sc1
    s_waitcnt lgkmcnt(2)
    buffer_store_dwordx4 v[120:123], v10, s[48:51], s5 offen offset:1024 sc1
    s_waitcnt lgkmcnt(0)
    buffer_store_dwordx4 v[124:127], v10, s[48:51], s5 offen offset:2048 sc1
L_h_done:
    s_waitcnt vmcnt(6)
    s_cmp_lt_u32 s14, 80
    s_cbranch_scc1 L_h_w
    s_waitcnt vmcnt(0)
L_h_w:
    v_cmp_gt_u32 vcc, 1, v55
    s_nop 1
    s_cbranch_vccnz L_chk17_slow
L_chk17:
    s_lshr_b32 s10, s15, 5
    s_mov_b32 s11, 0
L_rw_go:
    s_cmp_eq_u32 s10, 1
    s_cbranch_scc1 L_rw1
    s_cmp_eq_u32 s10, 2
    s_cbranch_scc1 L_rw2
L_rw0:
    s_add_u32 s69, s68, 28672
    buffer_load_dwordx4 a[120:123], v241, s[48:51], s69 offen offset:2048 sc1
    buffer_load_dwordx4 a[124:127], v241, s[48:51], s69 offen offset:3072 sc1
    s_add_u32 s69, s68, 32768
    buffer_load_dwordx4 a[128:131], v241, s[48:51], s69 offen offset:0 sc1
    buffer_load_dwordx4 a[132:135], v241, s[48:51], s69 offen offset:1024 sc1
    buffer_load_dwordx4 a[136:139], v241, s[48:51], s69 offen offset:2048 sc1
    buffer_load_dwordx4 a[140:143], v241, s[48:51], s69 offen offset:3072 sc1
    s_add_u32 s69, s68, 36864
    buffer_load_dwordx4 a[144:147], v241, s[48:51], s69 offen offset:0 sc1
    buffer_load_dwordx4 a[148:151], v241, s[48:51], s69 offen offset:1024 sc1
    buffer_load_dwordx4 a[152:155], v241, s[48:51], s69 offen offset:2048 sc1
    buffer_load_dwordx4 a[156:159], v241, s[48:51], s69 offen offset:3072 sc1
    s_add_u32 s69, s68, 40960
    buffer_load_dwordx4 a[160:163], v241, s[48:51], s69 offen offset:0 sc1
    buffer_load_dwordx4 a[164:167], v241, s[48:51], s69 offen offset:1024 sc1
    buffer_load_dwordx4 a[168:171], v241, s[48:51], s69 offen offset:2048 sc1
    buffer_load_dwordx4 a[172:175], v241, s[48:51], s69 offen offset:3072 sc1
    s_add_u32 s69, s68, 45056
    buffer_load_dwordx4 a[176:179], v241, s[48:51], s69 offen offset:0 sc1
    s_mov_b32 s10, 1
    s_branch L_rw_next
L_rw1:
    s_add_u32 s69, s68, 45056
    buffer_load_dwordx4 a[180:183], v241, s[48:51], s69 offen offset:1024 sc1
    buffer_load_dwordx4 a[184:187], v241, s[48:51], s69 offen offset:2048 sc1
    buffer_load_dwordx4 a[188:191], v241, s[48:51], s69 offen offset:3072 sc1
    s_add_u32 s69, s68, 49152
    buffer_load_dwordx4 a[192:195], v241, s[48:51], s69 offen offset:0 sc1
    buffer_load_dwordx4 a[196:199], v241, s[48:51], s69 offen offset:1024 sc1
    buffer_load_dwordx4 a[200:203], v241, s[48:51], s69 offen offset:2048 sc1
    buffer_load_dwordx4 a[204:207], v241, s[48:51], s69 offen offset:3072 sc1
    s_add_u32 s69, s68, 53248
    buffer_load_dwordx4 a[208:211], v241, s[48:51], s69 offen offset:0 sc1
    buffer_load_dwordx4 a[212:215], v241, s[48:51], s69 offen offset:1024 sc1
    buffer_load_dwordx4 a[216:219], v241, s[48:51], s69 offen offset:2048 sc1
    buffer_load_dwordx4 a[220:223], v241, s[48:51], s69 offen offset:3072 sc1
    s_add_u32 s69, s68, 57344
    buffer_load_dwordx4 a[224:227], v241, s[48:51], s69 offen offset:0 sc1
    buffer_load_dwordx4 a[228:231], v241, s[48:51], s69 offen offset:1024 sc1
    buffer_load_dwordx4 a[232:235], v241, s[48:51], s69 offen offset:2048 sc1
    buffer_load_dwordx4 a[236:239], v241, s[48:51], s69 offen offset:3072 sc1
    s_mov_b32 s10, 2
    s_branch L_rw_next
L_rw2:
    s_add_u32 s69, s68, 12288
    buffer_load_dwordx4 a[60:63], v241, s[48:51], s69 offen offset:3072 sc1
    s_add_u32 s69, s68, 16384
    buffer_load_dwordx4 a[64:67], v241, s[48:51], s69 offen offset:0 sc1
    buffer_load_dwordx4 a[68:71], v241, s[48:51], s69 offen offset:1024 sc1
    buffer_load_dwordx4 a[72:75], v241, s[48:51], s69 offen offset:2048 sc1
    buffer_load_dwordx4 a[76:79], v241, s[48:51], s69 offen offset:3072 sc1
    s_add_u32 s69, s68, 20480
    buffer_load_dwordx4 a[80:83], v241, s[48:51], s69 offen offset:0 sc1
    buffer_load_dwordx4 a[84:87], v241, s[48:51], s69 offen offset:1024 sc1
    buffer_load_dwordx4 a[88:91], v241, s[48:51], s69 offen offset:2048 sc1
    buffer_load_dwordx4 a[92:95], v241, s[48:51], s69 offen offset:3072 sc1
    s_add_u32 s69, s68, 24576
    buffer_load_dwordx4 a[96:99], v241, s[48:51], s69 offen offset:0 sc1
    buffer_load_dwordx4 a[100:103], v241, s[48:51], s69 offen offset:1024 sc1
    buffer_load_dwordx4 a[104:107], v241, s[48:51], s69 offen offset:2048 sc1
    buffer_load_dwordx4 a[108:111], v241, s[48:51], s69 offen offset:3072 sc1
    s_add_u32 s69, s68, 28672
    buffer_load_dwordx4 a[112:115], v241, s[48:51], s69 offen offset:0 sc1
    buffer_load_dwordx4 a[116:119], v241, s[48:51], s69 offen offset:1024 sc1
    s_mov_b32 s10, 0
L_rw_next:
    s_add_u32 s11, s11, 1
    s_cmp_eq_u32 s11, 3
    s_cbranch_scc1 L_rw_done
    s_cmp_eq_u32 s11, 2
    s_cbranch_scc1 L_rw_go
    s_waitcnt vmcnt(15)
    s_barrier
    s_lshl_b32 s4, s15, 5
    s_add_u32 s4, s4, 200704
    s_mul_i32 s5, s79, 1
    v_mul_u32_u24 v56, 20480, v0
    v_add_u32 v56, s4, v56
    v_mov_b32 v57, 2147483632
    v_cmp_gt_u32 s[8:9], s5, v0
    s_nop 1
    v_cndmask_b32 v56, v57, v56, s[8:9]
    v_mov_b32 v57, 2
    buffer_store_dword v57, v56, s[48:51], 0 offen sc1
    s_branch L_rw_go
L_rw_done:
    s_lshl_b32 s4, s65, 2
    s_add_u32 s4, s4, s3
    s_mul_i32 s4, s4, 1536
    s_add_u32 s4, s4, 786432
    v_lshrrev_b32 v56, 1, v0
    v_bfi_b32 v56, 7, v0, v56
    v_lshl_add_u32 v56, v56, 4, s4
    buffer_load_dwordx4 v[60:63], v56, s[48:51], 0 offen offset:0 sc1
    buffer_load_dwordx4 v[64:67], v56, s[48:51], 0 offen offset:512 sc1
    buffer_load_dwordx4 v[68:71], v56, s[48:51], 0 offen offset:1024 sc1
    s_and_b32 s4, s15, 31
    v_readlane_b32 s4, v251, s4
    s_nop 1
    v_mov_b32 v44, s4
    buffer_load_dword v235, v234, s[48:51], 0 offen sc1
    buffer_load_dword v45, v44, s[48:51], 0 offen sc1
    s_waitcnt vmcnt(1)
    v_cmp_gt_u32 vcc, 2, v235
    s_nop 1
    s_cbranch_vccnz L_chk19_slow
L_chk19:
    s_add_u32 s71, s70, 16384
    buffer_load_dwordx4 v[200:203], v240, s[48:51], s71 offen offset:2048 sc1
    buffer_load_dwordx4 v[204:207], v240, s[48:51], s71 offen offset:3072 sc1
    s_add_u32 s71, s70, 20480
    buffer_load_dwordx4 v[208:211], v240, s[48:51], s71 offen offset:0 sc1
    buffer_load_dwordx4 v[212:215], v240, s[48:51], s71 offen offset:1024 sc1
    s_add_u32 s71, s70, 28672
    buffer_load_dwordx4 a[240:243], v240, s[48:51], s71 offen offset:0 sc1
    buffer_load_dwordx4 a[244:247], v240, s[48:51], s71 offen offset:1024 sc1
    buffer_load_dwordx4 a[248:251], v240, s[48:51], s71 offen offset:2048 sc1
    buffer_load_dwordx4 a[252:255], v240, s[48:51], s71 offen offset:3072 sc1
    s_waitcnt vmcnt(8)
    v_cmp_gt_u32 vcc, 1, v45
    s_nop 1
    s_cbranch_vccnz L_chk21_slow
L_chk21:
    buffer_load_dword v59, v251, s[48:51], 0 offen sc1
    s_waitcnt vmcnt(0)
    v_cmp_gt_u32 vcc, 1, v59
    s_nop 1
    s_cbranch_vccnz L_chk23_slow
L_chk23:
    s_waitcnt lgkmcnt(0)
    s_barrier
    s_mov_b32 s12, 0
    buffer_load_dwordx4 v[216:219], v228, s[48:51], s12 offen sc1
    s_mov_b32 s12, 4096
    buffer_load_dwordx4 v[220:223], v229, s[48:51], s12 offen sc1
    s_add_u32 m0, s73, 0
    s_add_u32 s74, s72, 0
    buffer_load_dwordx4 v240, s[48:51], s74 offen offset:0 sc1 lds
    buffer_load_dwordx4 v240, s[48:51], s74 offen offset:1024 sc1 lds
    buffer_load_dwordx4 v240, s[48:51], s74 offen offset:2048 sc1 lds
    buffer_load_dwordx4 v240, s[48:51], s74 offen offset:3072 sc1 lds
    s_add_u32 m0, s73, 4096
    s_add_u32 s74, s72, 4096
    buffer_load_dwordx4 v240, s[48:51], s74 offen offset:0 sc1 lds
    buffer_store_dword v252, v252, s[48:51], 0 offen
    buffer_store_dword v252, v252, s[48:51], 0 offen
    s_branch L_ffn
.p2align 12
L_ffn:
    s_cbranch_execz L_rt_ffn
    s_add_u32 m0, s73, 20480
    s_add_u32 s74, s72, 20480
    buffer_load_dwordx4 v240, s[48:51], s74 offen offset:0 sc1 lds
    buffer_load_dwordx4 v240, s[48:51], s74 offen offset:1024 sc1 lds
    buffer_load_dwordx4 v240, s[48:51], s74 offen offset:2048 sc1 lds
    buffer_load_dwordx4 v240, s[48:51], s74 offen offset:3072 sc1 lds
    s_add_u32 m0, s73, 24576
    s_add_u32 s74, s72, 24576
    buffer_load_dwordx4 v240, s[48:51], s74 offen offset:0 sc1 lds
    s_mov_b32 s10, 32768
    v_lshrrev_b32 v251, 3, v251
    v_add_u32 v251, 184320, v251
    s_mul_i32 s4, s2, 112
    s_sub_u32 s4, 98304, s4
    v_add_u32 v252, s4, v252
    s_mov_b32 s12, 0x3f803f80
    s_waitcnt vmcnt(13)
    v_dot2_f32_bf16 v224, v216, s12, 0
    v_dot2_f32_bf16 v225, v216, v216, 0
    v_dot2_f32_bf16 v226, v218, s12, 0
    v_dot2_f32_bf16 v227, v218, v218, 0
    v_dot2_f32_bf16 v224, v217, s12, v224
    v_dot2_f32_bf16 v225, v217, v217, v225
    v_dot2_f32_bf16 v226, v219, s12, v226
    v_dot2_f32_bf16 v227, v219, v219, v227
    s_waitcnt vmcnt(12)
    v_dot2_f32_bf16 v224, v220, s12, v224
    v_dot2_f32_bf16 v225, v220, v220, v225
    v_dot2_f32_bf16 v226, v222, s12, v226
    v_dot2_f32_bf16 v227, v222, v222, v227
    v_dot2_f32_bf16 v224, v221, s12, v224
    v_dot2_f32_bf16 v225, v221, v221, v225
    v_dot2_f32_bf16 v226, v223, s12, v226
    v_dot2_f32_bf16 v227, v223, v223, v227
    s_nop 1
    v_permlane32_swap_b32 v224, v226
    v_permlane32_swap_b32 v225, v227
    v_add_f32 v224, v224, v226
    v_add_f32 v225, v225, v227
    s_nop 1
    v_permlane16_swap_b32 v224, v225
    v_add_f32 v224, v224, v225
    s_nop 1
    v_add_f32_dpp v224, v224, v224 row_ror:8 row_mask:0xf bank_mask:0xf
    s_nop 1
    v_add_f32_dpp v224, v224, v224 row_ror:4 row_mask:0xf bank_mask:0xf
    s_nop 1
    v_add_f32_dpp v224, v224, v224 row_ror:2 row_mask:0xf bank_mask:0xf
    ds_write_b32 v230, v224
    s_waitcnt vmcnt(7)
    s_waitcnt lgkmcnt(0)
    s_barrier
    ds_read2st64_b64 v[72:75], v242 offset0:0 offset1:1
    ds_read2st64_b64 v[76:79], v242 offset0:2 offset1:3
    ds_read2st64_b64 v[80:83], v242 offset0:4 offset1:5
    ds_read2st64_b64 v[84:87], v242 offset0:6 offset1:7
    ds_read_b128 v[216:219], v231
    ds_read_b128 v[220:223], v231 offset:16
    s_waitcnt lgkmcnt(5)
    v_mfma_f32_16x16x32_bf16 v[12:15], a[0:3], v[72:75], 0
    ds_read2st64_b64 v[88:91], v242 offset0:8 offset1:9
    v_add_f32_dpp v60, v60, v60 quad_perm:[1,0,3,2] row_mask:0xf bank_mask:0xf
    v_add_f32_dpp v61, v61, v61 quad_perm:[1,0,3,2] row_mask:0xf bank_mask:0xf
    s_waitcnt lgkmcnt(5)
    v_mfma_f32_16x16x32_bf16 v[12:15], a[12:15], v[76:79], v[12:15]
    s_waitcnt lgkmcnt(2)
    v_add_f32 v216, v216, v217
    v_add_f32 v218, v218, v219
    v_mfma_f32_16x16x32_bf16 v[12:15], a[24:27], v[80:83], v[12:15]
    ds_read2st64_b64 v[92:95], v242 offset0:10 offset1:11
    s_waitcnt lgkmcnt(2)
    v_add_f32 v220, v220, v221
    v_add_f32 v222, v222, v223
    v_mfma_f32_16x16x32_bf16 v[12:15], a[36:39], v[84:87], v[12:15]
    v_add_f32 v216, v216, v218
    v_add_f32 v220, v220, v222
    v_mfma_f32_16x16x32_bf16 v[16:19], a[4:7], v[72:75], 0
    ds_read2st64_b64 v[96:99], v242 offset0:12 offset1:13
    v_mul_f32 v216, 0x3acccccd, v216
    v_mul_f32 v220, 0x3acccccd, v220
    v_mfma_f32_16x16x32_bf16 v[16:19], a[16:19], v[76:79], v[16:19]
    v_fma_f32 v220, -v216, v216, v220
    v_max_f32 v220, 0, v220
    v_mfma_f32_16x16x32_bf16 v[16:19], a[28:31], v[80:83], v[16:19]
    ds_read2st64_b64 v[100:103], v242 offset0:14 offset1:15
    v_cvt_pk_bf16_f32 v217, v216, v220
    v_lshlrev_b32 v219, 16, v217
    v_mfma_f32_16x16x32_bf16 v[16:19], a[40:43], v[84:87], v[16:19]
    v_and_b32 v217, 0xffff0000, v217
    v_add_f32 v217, 0x3727c5ac, v217
    v_mfma_f32_16x16x32_bf16 v[20:23], a[8:11], v[72:75], 0
    v_cvt_pk_bf16_f32 v217, v217, v217
    v_and_b32 v217, 0xffff0000, v217
    v_mfma_f32_16x16x32_bf16 v[20:23], a[20:23], v[76:79], v[20:23]
    s_add_u32 m0, s73, 40960
    v_sqrt_f32 v217, v217
    s_nop 0
    v_cvt_pk_bf16_f32 v217, v217, v217
    v_mfma_f32_16x16x32_bf16 v[20:23], a[32:35], v[80:83], v[20:23]
    s_add_u32 s74, s72, 40960
    v_and_b32 v218, 0xffff0000, v217
    v_xor_b32 v219, 0x80000000, v219
    v_mfma_f32_16x16x32_bf16 v[20:23], a[44:47], v[84:87], v[20:23]
    s_waitcnt lgkmcnt(0)
    buffer_store_dwordx2 v[218:219], v232, s[48:51], 0 offen offset:0 sc1
    v_mfma_f32_16x16x32_bf16 v[12:15], a[48:51], v[88:91], v[12:15]
    ds_read2st64_b64 v[72:75], v242 offset0:16 offset1:17
    v_add_f32_dpp v62, v62, v62 quad_perm:[1,0,3,2] row_mask:0xf bank_mask:0xf
    v_add_f32_dpp v63, v63, v63 quad_perm:[1,0,3,2] row_mask:0xf bank_mask:0xf
    v_mfma_f32_16x16x32_bf16 v[12:15], a[60:63], v[92:95], v[12:15]
    buffer_load_dwordx4 v240, s[48:51], s74 offen offset:0 sc1 lds
    v_mfma_f32_16x16x32_bf16 v[12:15], a[72:75], v[96:99], v[12:15]
    ds_read2st64_b64 v[76:79], v242 offset0:18 offset1:19
    v_add_f32_dpp v64, v64, v64 quad_perm:[1,0,3,2] row_mask:0xf bank_mask:0xf
    v_add_f32_dpp v65, v65, v65 quad_perm:[1,0,3,2] row_mask:0xf bank_mask:0xf
    v_mfma_f32_16x16x32_bf16 v[12:15], a[84:87], v[100:103], v[12:15]
    v_add_f32_dpp v66, v66, v66 quad_perm:[1,0,3,2] row_mask:0xf bank_mask:0xf
    v_add_f32_dpp v67, v67, v67 quad_perm:[1,0,3,2] row_mask:0xf bank_mask:0xf
    v_mfma_f32_16x16x32_bf16 v[16:19], a[52:55], v[88:91], v[16:19]
    ds_read2st64_b64 v[80:83], v242 offset0:20 offset1:21
    v_add_f32_dpp v68, v68, v68 quad_perm:[1,0,3,2] row_mask:0xf bank_mask:0xf
    v_add_f32_dpp v69, v69, v69 quad_perm:[1,0,3,2] row_mask:0xf bank_mask:0xf
    v_mfma_f32_16x16x32_bf16 v[16:19], a[64:67], v[92:95], v[16:19]
    buffer_load_dwordx4 v240, s[48:51], s74 offen offset:1024 sc1 lds
    v_mfma_f32_16x16x32_bf16 v[16:19], a[76:79], v[96:99], v[16:19]
    ds_read2st64_b64 v[84:87], v242 offset0:22 offset1:23
    v_add_f32_dpp v70, v70, v70 quad_perm:[1,0,3,2] row_mask:0xf bank_mask:0xf
    v_add_f32_dpp v71, v71, v71 quad_perm:[1,0,3,2] row_mask:0xf bank_mask:0xf
    v_mfma_f32_16x16x32_bf16 v[16:19], a[88:91], v[100:103], v[16:19]
    s_waitcnt vmcnt(8)
    v_mov_b32 v2, 2
    v_add_f32_dpp v60, v60, v60 quad_perm:[2,3,0,1] row_mask:0xf bank_mask:0xf
    v_mfma_f32_16x16x32_bf16 v[20:23], a[56:59], v[88:91], v[20:23]
    s_barrier
    v_add_f32_dpp v61, v61, v61 quad_perm:[2,3,0,1] row_mask:0xf bank_mask:0xf
    v_add_f32_dpp v62, v62, v62 quad_perm:[2,3,0,1] row_mask:0xf bank_mask:0xf
    v_mfma_f32_16x16x32_bf16 v[20:23], a[68:71], v[92:95], v[20:23]
    buffer_store_dword v2, v252, s[48:51], 0 offen sc1
    v_mfma_f32_16x16x32_bf16 v[20:23], a[80:83], v[96:99], v[20:23]
    buffer_load_dwordx4 v240, s[48:51], s74 offen offset:2048 sc1 lds
    v_mfma_f32_16x16x32_bf16 v[20:23], a[92:95], v[100:103], v[20:23]
    s_waitcnt lgkmcnt(0)
    v_add_f32_dpp v63, v63, v63 quad_perm:[2,3,0,1] row_mask:0xf bank_mask:0xf
    v_add_f32_dpp v64, v64, v64 quad_perm:[2,3,0,1] row_mask:0xf bank_mask:0xf
    v_mfma_f32_16x16x32_bf16 v[12:15], a[96:99], v[72:75], v[12:15]
    ds_read2st64_b64 v[88:91], v242 offset0:24 offset1:25
    v_add_f32_dpp v65, v65, v65 quad_perm:[2,3,0,1] row_mask:0xf bank_mask:0xf
    v_add_f32_dpp v66, v66, v66 quad_perm:[2,3,0,1] row_mask:0xf bank_mask:0xf
    v_mfma_f32_16x16x32_bf16 v[12:15], a[108:111], v[76:79], v[12:15]
    buffer_load_dwordx4 v240, s[48:51], s74 offen offset:3072 sc1 lds
    v_mfma_f32_16x16x32_bf16 v[12:15], a[120:123], v[80:83], v[12:15]
    ds_read2st64_b64 v[92:95], v242 offset0:26 offset1:27
    v_add_f32_dpp v67, v67, v67 quad_perm:[2,3,0,1] row_mask:0xf bank_mask:0xf
    v_add_f32_dpp v68, v68, v68 quad_perm:[2,3,0,1] row_mask:0xf bank_mask:0xf
    v_mfma_f32_16x16x32_bf16 v[12:15], a[132:135], v[84:87], v[12:15]
    s_add_u32 s74, s72, 45056
    v_add_f32_dpp v69, v69, v69 quad_perm:[2,3,0,1] row_mask:0xf bank_mask:0xf
    v_add_f32_dpp v70, v70, v70 quad_perm:[2,3,0,1] row_mask:0xf bank_mask:0xf
    v_mfma_f32_16x16x32_bf16 v[16:19], a[100:103], v[72:75], v[16:19]
    ds_read2st64_b64 v[96:99], v242 offset0:28 offset1:29
    v_add_f32_dpp v71, v71, v71 quad_perm:[2,3,0,1] row_mask:0xf bank_mask:0xf
    v_add_f32_dpp v60, v60, v60 row_half_mirror row_mask:0xf bank_mask:0xf
    v_mfma_f32_16x16x32_bf16 v[16:19], a[112:115], v[76:79], v[16:19]
    s_add_u32 m0, s73, 45056
    s_nop 0
    buffer_load_dwordx4 v240, s[48:51], s74 offen offset:0 sc1 lds
    v_mfma_f32_16x16x32_bf16 v[16:19], a[124:127], v[80:83], v[16:19]
    ds_read2st64_b64 v[100:103], v242 offset0:30 offset1:31
    v_add_f32_dpp v61, v61, v61 row_half_mirror row_mask:0xf bank_mask:0xf
    v_add_f32_dpp v62, v62, v62 row_half_mirror row_mask:0xf bank_mask:0xf
    v_mfma_f32_16x16x32_bf16 v[16:19], a[136:139], v[84:87], v[16:19]
    s_add_u32 m0, s73, 61440
    v_add_f32_dpp v63, v63, v63 row_half_mirror row_mask:0xf bank_mask:0xf
    v_add_f32_dpp v64, v64, v64 row_half_mirror row_mask:0xf bank_mask:0xf
    v_mfma_f32_16x16x32_bf16 v[20:23], a[104:107], v[72:75], v[20:23]
    s_add_u32 s74, s72, 61440
    v_add_f32_dpp v65, v65, v65 row_half_mirror row_mask:0xf bank_mask:0xf
    v_add_f32_dpp v66, v66, v66 row_half_mirror row_mask:0xf bank_mask:0xf
    v_mfma_f32_16x16x32_bf16 v[20:23], a[116:119], v[76:79], v[20:23]
    buffer_load_dwordx4 v240, s[48:51], s74 offen offset:0 sc1 lds
    v_mfma_f32_16x16x32_bf16 v[20:23], a[128:131], v[80:83], v[20:23]
    v_add_f32_dpp v67, v67, v67 row_half_mirror row_mask:0xf bank_mask:0xf
    v_add_f32_dpp v68, v68, v68 row_half_mirror row_mask:0xf bank_mask:0xf
    v_mfma_f32_16x16x32_bf16 v[20:23], a[140:143], v[84:87], v[20:23]
    s_waitcnt lgkmcnt(0)
    v_add_f32_dpp v69, v69, v69 row_half_mirror row_mask:0xf bank_mask:0xf
    v_add_f32_dpp v70, v70, v70 row_half_mirror row_mask:0xf bank_mask:0xf
    v_mfma_f32_16x16x32_bf16 v[12:15], a[144:147], v[88:91], v[12:15]
    ds_read2st64_b64 v[72:75], v242 offset0:32 offset1:33
    v_add_f32_dpp v71, v71, v71 row_half_mirror row_mask:0xf bank_mask:0xf
    v_mfma_f32_16x16x32_bf16 v[12:15], a[156:159], v[92:95], v[12:15]
    buffer_load_dwordx4 v240, s[48:51], s74 offen offset:1024 sc1 lds
    v_mfma_f32_16x16x32_bf16 v[12:15], a[168:171], v[96:99], v[12:15]
    ds_read2st64_b64 v[76:79], v242 offset0:34 offset1:35
    v_mfma_f32_16x16x32_bf16 v[12:15], a[180:183], v[100:103], v[12:15]
    v_mfma_f32_16x16x32_bf16 v[16:19], a[148:151], v[88:91], v[16:19]
    ds_read2st64_b64 v[80:83], v242 offset0:36 offset1:37
    v_mfma_f32_16x16x32_bf16 v[16:19], a[160:163], v[92:95], v[16:19]
    buffer_load_dwordx4 v240, s[48:51], s74 offen offset:2048 sc1 lds
    v_mfma_f32_16x16x32_bf16 v[16:19], a[172:175], v[96:99], v[16:19]
    ds_read2st64_b64 v[84:87], v242 offset0:38 offset1:39
    v_mfma_f32_16x16x32_bf16 v[16:19], a[184:187], v[100:103], v[16:19]
    v_mfma_f32_16x16x32_bf16 v[20:23], a[152:155], v[88:91], v[20:23]
    v_mfma_f32_16x16x32_bf16 v[20:23], a[164:167], v[92:95], v[20:23]
    s_waitcnt vmcnt(10)
    buffer_load_dwordx4 v240, s[48:51], s74 offen offset:3072 sc1 lds
    v_mfma_f32_16x16x32_bf16 v[20:23], a[176:179], v[96:99], v[20:23]
    s_barrier
    v_mfma_f32_16x16x32_bf16 v[20:23], a[188:191], v[100:103], v[20:23]
    s_waitcnt lgkmcnt(0)
    v_mfma_f32_16x16x32_bf16 v[12:15], a[192:195], v[72:75], v[12:15]
    ds_read2st64_b64 v[88:91], v242 offset0:40 offset1:41
    v_mfma_f32_16x16x32_bf16 v[12:15], a[204:207], v[76:79], v[12:15]
    s_add_u32 m0, s73, 65536
    s_add_u32 s74, s72, 65536
    buffer_load_dwordx4 v240, s[48:51], s74 offen offset:0 sc1 lds
    v_mfma_f32_16x16x32_bf16 v[12:15], a[216:219], v[80:83], v[12:15]
    ds_read2st64_b64 v[92:95], v242 offset0:42 offset1:43
    v_mfma_f32_16x16x32_bf16 v[12:15], a[228:231], v[84:87], v[12:15]
    v_mfma_f32_16x16x32_bf16 v[16:19], a[196:199], v[72:75], v[16:19]
    ds_read2st64_b64 v[96:99], v242 offset0:44 offset1:45
    v_mfma_f32_16x16x32_bf16 v[16:19], a[208:211], v[76:79], v[16:19]
    v_mfma_f32_16x16x32_bf16 v[16:19], a[220:223], v[80:83], v[16:19]
    ds_read2st64_b64 v[100:103], v242 offset0:46 offset1:47
    v_mfma_f32_16x16x32_bf16 v[16:19], a[232:235], v[84:87], v[16:19]
    v_mfma_f32_16x16x32_bf16 v[20:23], a[200:203], v[72:75], v[20:23]
    v_mfma_f32_16x16x32_bf16 v[20:23], a[212:215], v[76:79], v[20:23]
    v_mfma_f32_16x16x32_bf16 v[20:23], a[224:227], v[80:83], v[20:23]
    s_add_u32 m0, s91, 143872
    v_mfma_f32_16x16x32_bf16 v[20:23], a[236:239], v[84:87], v[20:23]
    s_waitcnt lgkmcnt(0)
    v_mfma_f32_16x16x32_bf16 v[24:27], a[0:3], v[88:91], 0
    ds_read2st64_b64 v[72:75], v242 offset0:48 offset1:49
    v_mfma_f32_16x16x32_bf16 v[24:27], a[12:15], v[92:95], v[24:27]
    s_add_u32 s71, s70, 32768
    v_mfma_f32_16x16x32_bf16 v[24:27], a[24:27], v[96:99], v[24:27]
    ds_read2st64_b64 v[76:79], v242 offset0:50 offset1:51
    v_mfma_f32_16x16x32_bf16 v[24:27], a[36:39], v[100:103], v[24:27]
    buffer_load_dwordx4 v240, s[48:51], s71 offen offset:0 sc1 lds
    v_mfma_f32_16x16x32_bf16 v[28:31], a[4:7], v[88:91], 0
    ds_read2st64_b64 v[80:83], v242 offset0:52 offset1:53
    v_mfma_f32_16x16x32_bf16 v[28:31], a[16:19], v[92:95], v[28:31]
    v_mfma_f32_16x16x32_bf16 v[28:31], a[28:31], v[96:99], v[28:31]
    ds_read2st64_b64 v[84:87], v242 offset0:54 offset1:55
    v_mfma_f32_16x16x32_bf16 v[28:31], a[40:43], v[100:103], v[28:31]
    buffer_load_dwordx4 v240, s[48:51], s71 offen offset:1024 sc1 lds
    v_mfma_f32_16x16x32_bf16 v[32:35], a[8:11], v[88:91], 0
    v_mfma_f32_16x16x32_bf16 v[32:35], a[20:23], v[92:95], v[32:35]
    v_mfma_f32_16x16x32_bf16 v[32:35], a[32:35], v[96:99], v[32:35]
    buffer_load_dwordx4 v240, s[48:51], s71 offen offset:2048 sc1 lds
    v_mfma_f32_16x16x32_bf16 v[32:35], a[44:47], v[100:103], v[32:35]
    s_waitcnt lgkmcnt(0)
    v_mfma_f32_16x16x32_bf16 v[24:27], a[48:51], v[72:75], v[24:27]
    ds_read2st64_b64 v[88:91], v242 offset0:56 offset1:57
    v_mfma_f32_16x16x32_bf16 v[24:27], a[60:63], v[76:79], v[24:27]
    s_add_u32 s83, s82, 0
    v_mfma_f32_16x16x32_bf16 v[24:27], a[72:75], v[80:83], v[24:27]
    ds_read2st64_b64 v[92:95], v242 offset0:58 offset1:59
    v_mfma_f32_16x16x32_bf16 v[24:27], a[84:87], v[84:87], v[24:27]
    buffer_load_dwordx4 v[128:131], v240, s[48:51], s83 offen offset:0 sc1
    v_mfma_f32_16x16x32_bf16 v[28:31], a[52:55], v[72:75], v[28:31]
    ds_read2st64_b64 v[96:99], v242 offset0:60 offset1:61
    v_mfma_f32_16x16x32_bf16 v[28:31], a[64:67], v[76:79], v[28:31]
    v_mfma_f32_16x16x32_bf16 v[28:31], a[76:79], v[80:83], v[28:31]
    ds_read2st64_b64 v[100:103], v242 offset0:62 offset1:63
    v_mfma_f32_16x16x32_bf16 v[28:31], a[88:91], v[84:87], v[28:31]
    buffer_load_dwordx4 v[104:107], v245, s[48:51], 0 offen offset:0 sc1
    v_mfma_f32_16x16x32_bf16 v[32:35], a[56:59], v[72:75], v[32:35]
    buffer_load_dwordx4 v[132:135], v240, s[48:51], s83 offen offset:1024 sc1
    v_mfma_f32_16x16x32_bf16 v[32:35], a[68:71], v[76:79], v[32:35]
    buffer_load_dwordx4 v[108:111], v245, s[48:51], 0 offen offset:256 sc1
    v_mfma_f32_16x16x32_bf16 v[32:35], a[80:83], v[80:83], v[32:35]
    v_mfma_f32_16x16x32_bf16 v[32:35], a[92:95], v[84:87], v[32:35]
    s_waitcnt lgkmcnt(0)
    v_mfma_f32_16x16x32_bf16 v[24:27], a[96:99], v[88:91], v[24:27]
    ds_read2st64_b64 v[72:75], v242 offset0:64 offset1:65
    v_mfma_f32_16x16x32_bf16 v[24:27], a[108:111], v[92:95], v[24:27]
    buffer_load_dwordx4 v[136:139], v240, s[48:51], s83 offen offset:2048 sc1
    v_mfma_f32_16x16x32_bf16 v[24:27], a[120:123], v[96:99], v[24:27]
    ds_read2st64_b64 v[76:79], v242 offset0:66 offset1:67
    v_mfma_f32_16x16x32_bf16 v[24:27], a[132:135], v[100:103], v[24:27]
    v_mfma_f32_16x16x32_bf16 v[28:31], a[100:103], v[88:91], v[28:31]
    ds_read2st64_b64 v[80:83], v242 offset0:68 offset1:69
    v_mfma_f32_16x16x32_bf16 v[28:31], a[112:115], v[92:95], v[28:31]
    buffer_load_dwordx4 v[140:143], v240, s[48:51], s83 offen offset:3072 sc1
    v_mfma_f32_16x16x32_bf16 v[28:31], a[124:127], v[96:99], v[28:31]
    ds_read2st64_b64 v[84:87], v242 offset0:70 offset1:71
    v_mfma_f32_16x16x32_bf16 v[28:31], a[136:139], v[100:103], v[28:31]
    buffer_load_dword v4, v251, s[48:51], 0 offen sc1
    v_mfma_f32_16x16x32_bf16 v[32:35], a[104:107], v[88:91], v[32:35]
    s_add_u32 s83, s82, 4096
    v_mfma_f32_16x16x32_bf16 v[32:35], a[116:119], v[92:95], v[32:35]
    buffer_load_dwordx4 v[144:147], v240, s[48:51], s83 offen offset:0 sc1
    v_mfma_f32_16x16x32_bf16 v[32:35], a[128:131], v[96:99], v[32:35]
    v_mfma_f32_16x16x32_bf16 v[32:35], a[140:143], v[100:103], v[32:35]
    s_waitcnt lgkmcnt(0)
    v_mfma_f32_16x16x32_bf16 v[24:27], a[144:147], v[72:75], v[24:27]
    ds_read2st64_b64 v[88:91], v242 offset0:72 offset1:73
    v_mfma_f32_16x16x32_bf16 v[24:27], a[156:159], v[76:79], v[24:27]
    buffer_load_dwordx4 v[148:151], v240, s[48:51], s83 offen offset:1024 sc1
    v_mfma_f32_16x16x32_bf16 v[24:27], a[168:171], v[80:83], v[24:27]
    ds_read2st64_b64 v[92:95], v242 offset0:74 offset1:75
    v_mfma_f32_16x16x32_bf16 v[24:27], a[180:183], v[84:87], v[24:27]
    v_mfma_f32_16x16x32_bf16 v[28:31], a[148:151], v[72:75], v[28:31]
    ds_read2st64_b64 v[96:99], v242 offset0:76 offset1:77
    v_mfma_f32_16x16x32_bf16 v[28:31], a[160:163], v[76:79], v[28:31]
    v_mfma_f32_16x16x32_bf16 v[28:31], a[172:175], v[80:83], v[28:31]
    ds_read2st64_b64 v[100:103], v242 offset0:78 offset1:79
    v_mfma_f32_16x16x32_bf16 v[28:31], a[184:187], v[84:87], v[28:31]
    buffer_load_dwordx4 v[152:155], v240, s[48:51], s83 offen offset:2048 sc1
    v_mfma_f32_16x16x32_bf16 v[32:35], a[152:155], v[72:75], v[32:35]
    v_mfma_f32_16x16x32_bf16 v[32:35], a[164:167], v[76:79], v[32:35]
    s_waitcnt vmcnt(18)
    v_mfma_f32_16x16x32_bf16 v[32:35], a[176:179], v[80:83], v[32:35]
    s_barrier
    v_mfma_f32_16x16x32_bf16 v[32:35], a[188:191], v[84:87], v[32:35]
    s_waitcnt lgkmcnt(0)
    v_mfma_f32_16x16x32_bf16 v[24:27], a[192:195], v[88:91], v[24:27]
    ds_read2st64_b64 v[72:75], v242 offset0:80 offset1:81
    v_mfma_f32_16x16x32_bf16 v[24:27], a[204:207], v[92:95], v[24:27]
    buffer_load_dwordx4 v[156:159], v240, s[48:51], s83 offen offset:3072 sc1
    v_mfma_f32_16x16x32_bf16 v[24:27], a[216:219], v[96:99], v[24:27]
    ds_read2st64_b64 v[76:79], v242 offset0:82 offset1:83
    v_mfma_f32_16x16x32_bf16 v[24:27], a[228:231], v[100:103], v[24:27]
    s_add_u32 s83, s82, 8192
    v_mfma_f32_16x16x32_bf16 v[28:31], a[196:199], v[88:91], v[28:31]
    ds_read2st64_b64 v[80:83], v242 offset0:84 offset1:85
    v_mfma_f32_16x16x32_bf16 v[28:31], a[208:211], v[92:95], v[28:31]
    buffer_load_dwordx4 v[160:163], v240, s[48:51], s83 offen offset:0 sc1
    v_mfma_f32_16x16x32_bf16 v[28:31], a[220:223], v[96:99], v[28:31]
    ds_read2st64_b64 v[84:87], v242 offset0:86 offset1:87
    v_mfma_f32_16x16x32_bf16 v[28:31], a[232:235], v[100:103], v[28:31]
    s_waitcnt vmcnt(8)
    v_min3_u32 v3, v104, v106, v108
    v_mfma_f32_16x16x32_bf16 v[32:35], a[200:203], v[88:91], v[32:35]
    v_min_u32 v3, v3, v110
    v_mfma_f32_16x16x32_bf16 v[32:35], a[212:215], v[92:95], v[32:35]
    v_cmp_eq_u32 vcc, 0, v3
    buffer_load_dwordx4 v[164:167], v240, s[48:51], s83 offen offset:1024 sc1
    v_mfma_f32_16x16x32_bf16 v[32:35], a[224:227], v[96:99], v[32:35]
    s_cbranch_vccnz L_chk25_slow
L_chk25:
    v_mfma_f32_16x16x32_bf16 v[32:35], a[236:239], v[100:103], v[32:35]
    s_waitcnt lgkmcnt(0)
    v_rcp_f32 v5, v104
    v_mfma_f32_16x16x32_bf16 v[36:39], a[0:3], v[72:75], 0
    ds_read2st64_b64 v[88:91], v242 offset0:88 offset1:89
    v_mul_f32 v7, v104, v104
    v_fma_f32 v12, v105, v60, v12
    v_mfma_f32_16x16x32_bf16 v[36:39], a[12:15], v[76:79], v[36:39]
    buffer_load_dwordx4 v[168:171], v240, s[48:51], s83 offen offset:2048 sc1
    v_mfma_f32_16x16x32_bf16 v[36:39], a[24:27], v[80:83], v[36:39]
    ds_read2st64_b64 v[92:95], v242 offset0:90 offset1:91
    v_fma_f32 v13, v105, v61, v13
    v_fma_f32 v16, v105, v64, v16
    v_mfma_f32_16x16x32_bf16 v[36:39], a[36:39], v[84:87], v[36:39]
    v_fma_f32 v17, v105, v65, v17
    v_fma_f32 v20, v105, v68, v20
    v_mfma_f32_16x16x32_bf16 v[40:43], a[4:7], v[72:75], 0
    ds_read2st64_b64 v[96:99], v242 offset0:92 offset1:93
    v_fma_f32 v21, v105, v69, v21
    v_mul_f32 v6, v5, v5
    v_mfma_f32_16x16x32_bf16 v[40:43], a[16:19], v[76:79], v[40:43]
    v_mul_f32 v5, 0xc0135761, v5
    v_mul_f32 v6, 0x3d372713, v6
    v_mfma_f32_16x16x32_bf16 v[40:43], a[28:31], v[80:83], v[40:43]
    ds_read2st64_b64 v[100:103], v242 offset0:94 offset1:95
    v_mul_f32 v120, v12, v12
    v_mul_f32 v121, v13, v13
    v_mfma_f32_16x16x32_bf16 v[40:43], a[40:43], v[84:87], v[40:43]
    buffer_load_dwordx4 v[172:175], v240, s[48:51], s83 offen offset:3072 sc1
    v_mfma_f32_16x16x32_bf16 v[44:47], a[8:11], v[72:75], 0
    v_mul_f32 v122, v16, v16
    v_mul_f32 v123, v17, v17
    v_mfma_f32_16x16x32_bf16 v[44:47], a[20:23], v[76:79], v[44:47]
    v_mul_f32 v124, v20, v20
    v_mul_f32 v125, v21, v21
    v_mfma_f32_16x16x32_bf16 v[44:47], a[32:35], v[80:83], v[44:47]
    s_add_u32 s83, s82, 12288
    v_mul_f32 v6, v6, v5
    v_fma_f32 v14, v105, v62, v14
    v_mfma_f32_16x16x32_bf16 v[44:47], a[44:47], v[84:87], v[44:47]
    s_waitcnt lgkmcnt(0)
    v_fma_f32 v15, v105, v63, v15
    v_fma_f32 v18, v105, v66, v18
    v_mfma_f32_16x16x32_bf16 v[36:39], a[48:51], v[88:91], v[36:39]
    ds_read2st64_b64 v[72:75], v242 offset0:96 offset1:97
    v_fma_f32 v19, v105, v67, v19
    v_fma_f32 v22, v105, v70, v22
    v_mfma_f32_16x16x32_bf16 v[36:39], a[60:63], v[92:95], v[36:39]
    buffer_load_dwordx4 v[176:179], v240, s[48:51], s83 offen offset:0 sc1
    v_mfma_f32_16x16x32_bf16 v[36:39], a[72:75], v[96:99], v[36:39]
    ds_read2st64_b64 v[76:79], v242 offset0:98 offset1:99
    v_fma_f32 v23, v105, v71, v23
    v_fma_f32 v120, v120, v6, v5
    v_mfma_f32_16x16x32_bf16 v[36:39], a[84:87], v[100:103], v[36:39]
    v_fma_f32 v121, v121, v6, v5
    v_fma_f32 v122, v122, v6, v5
    v_mfma_f32_16x16x32_bf16 v[40:43], a[52:55], v[88:91], v[40:43]
    ds_read2st64_b64 v[80:83], v242 offset0:100 offset1:101
    v_fma_f32 v123, v123, v6, v5
    v_fma_f32 v124, v124, v6, v5
    v_mfma_f32_16x16x32_bf16 v[40:43], a[64:67], v[92:95], v[40:43]
    s_mov_b32 s12, 81920
    s_waitcnt vmcnt(9)
    v_cmp_gt_u32 vcc, 2, v4
    v_fma_f32 v125, v125, v6, v5
    v_mfma_f32_16x16x32_bf16 v[40:43], a[76:79], v[96:99], v[40:43]
    ds_read2st64_b64 v[84:87], v242 offset0:102 offset1:103
    s_cbranch_vccnz L_chk29_slow
L_chk29:
    s_barrier
    v_mfma_f32_16x16x32_bf16 v[40:43], a[88:91], v[100:103], v[40:43]
    buffer_load_dwordx4 v[216:219], v228, s[48:51], s12 offen sc1
    v_mfma_f32_16x16x32_bf16 v[44:47], a[56:59], v[88:91], v[44:47]
    s_mov_b32 s12, 86016
    v_mul_f32 v120, v120, v12
    v_mul_f32 v121, v121, v13
    v_mfma_f32_16x16x32_bf16 v[44:47], a[68:71], v[92:95], v[44:47]
    buffer_load_dwordx4 v[220:223], v229, s[48:51], s12 offen sc1
    v_mfma_f32_16x16x32_bf16 v[44:47], a[80:83], v[96:99], v[44:47]
    s_add_u32 s74, s72, 81920
    v_mul_f32 v122, v122, v16
    v_mul_f32 v123, v123, v17
    v_mfma_f32_16x16x32_bf16 v[44:47], a[92:95], v[100:103], v[44:47]
    s_waitcnt lgkmcnt(0)
    v_mul_f32 v124, v124, v20
    v_mul_f32 v125, v125, v21
    v_mfma_f32_16x16x32_bf16 v[36:39], a[96:99], v[72:75], v[36:39]
    ds_read2st64_b64 v[88:91], v242 offset0:104 offset1:105
    v_exp_f32 v120, v120
    v_mfma_f32_16x16x32_bf16 v[36:39], a[108:111], v[76:79], v[36:39]
    s_add_u32 m0, s73, 81920
    s_nop 0
    buffer_load_dwordx4 v240, s[48:51], s74 offen offset:0 sc1 lds
    v_mfma_f32_16x16x32_bf16 v[36:39], a[120:123], v[80:83], v[36:39]
    ds_read2st64_b64 v[92:95], v242 offset0:106 offset1:107
    v_exp_f32 v121, v121
    v_mfma_f32_16x16x32_bf16 v[36:39], a[132:135], v[84:87], v[36:39]
    buffer_load_dwordx4 v240, s[48:51], s74 offen offset:1024 sc1 lds
    v_mfma_f32_16x16x32_bf16 v[40:43], a[100:103], v[72:75], v[40:43]
    ds_read2st64_b64 v[96:99], v242 offset0:108 offset1:109
    v_exp_f32 v122, v122
    v_mfma_f32_16x16x32_bf16 v[40:43], a[112:115], v[76:79], v[40:43]
    v_exp_f32 v123, v123
    v_mfma_f32_16x16x32_bf16 v[40:43], a[124:127], v[80:83], v[40:43]
    ds_read2st64_b64 v[100:103], v242 offset0:110 offset1:111
    v_exp_f32 v124, v124
    v_mfma_f32_16x16x32_bf16 v[40:43], a[136:139], v[84:87], v[40:43]
    buffer_load_dwordx4 v240, s[48:51], s74 offen offset:2048 sc1 lds
    v_mfma_f32_16x16x32_bf16 v[44:47], a[104:107], v[72:75], v[44:47]
    v_exp_f32 v125, v125
    v_mfma_f32_16x16x32_bf16 v[44:47], a[116:119], v[76:79], v[44:47]
    v_mul_f32 v12, v12, v14
    v_mul_f32 v13, v13, v15
    v_mfma_f32_16x16x32_bf16 v[44:47], a[128:131], v[80:83], v[44:47]
    v_mul_f32 v16, v16, v18
    v_mul_f32 v17, v17, v19
    v_mfma_f32_16x16x32_bf16 v[44:47], a[140:143], v[84:87], v[44:47]
    s_waitcnt lgkmcnt(0)
    v_mul_f32 v20, v20, v22
    v_mul_f32 v21, v21, v23
    v_mfma_f32_16x16x32_bf16 v[36:39], a[144:147], v[88:91], v[36:39]
    ds_read2st64_b64 v[72:75], v242 offset0:112 offset1:113
    v_fma_f32 v120, v120, v7, v7
    v_fma_f32 v121, v121, v7, v7
    v_mfma_f32_16x16x32_bf16 v[36:39], a[156:159], v[92:95], v[36:39]
    buffer_load_dwordx4 v240, s[48:51], s74 offen offset:3072 sc1 lds
    v_mfma_f32_16x16x32_bf16 v[36:39], a[168:171], v[96:99], v[36:39]
    ds_read2st64_b64 v[76:79], v242 offset0:114 offset1:115
    v_fma_f32 v122, v122, v7, v7
    v_fma_f32 v123, v123, v7, v7
    v_mfma_f32_16x16x32_bf16 v[36:39], a[180:183], v[100:103], v[36:39]
    s_add_u32 s74, s72, 86016
    v_fma_f32 v124, v124, v7, v7
    v_fma_f32 v125, v125, v7, v7
    v_mfma_f32_16x16x32_bf16 v[40:43], a[148:151], v[88:91], v[40:43]
    ds_read2st64_b64 v[80:83], v242 offset0:116 offset1:117
    v_rcp_f32 v120, v120
    v_mfma_f32_16x16x32_bf16 v[40:43], a[160:163], v[92:95], v[40:43]
    s_add_u32 m0, s73, 86016
    s_nop 0
    buffer_load_dwordx4 v240, s[48:51], s74 offen offset:0 sc1 lds
    v_mfma_f32_16x16x32_bf16 v[40:43], a[172:175], v[96:99], v[40:43]
    ds_read2st64_b64 v[84:87], v242 offset0:118 offset1:119
    v_rcp_f32 v121, v121
    v_mfma_f32_16x16x32_bf16 v[40:43], a[184:187], v[100:103], v[40:43]
    s_add_u32 m0, s73, 102400
    v_rcp_f32 v122, v122
    v_mfma_f32_16x16x32_bf16 v[44:47], a[152:155], v[88:91], v[44:47]
    s_add_u32 s74, s72, 102400
    v_rcp_f32 v123, v123
    v_mfma_f32_16x16x32_bf16 v[44:47], a[164:167], v[92:95], v[44:47]
    buffer_load_dwordx4 v240, s[48:51], s74 offen offset:0 sc1 lds
    v_mfma_f32_16x16x32_bf16 v[44:47], a[176:179], v[96:99], v[44:47]
    s_barrier
    v_rcp_f32 v124, v124
    v_mfma_f32_16x16x32_bf16 v[44:47], a[188:191], v[100:103], v[44:47]
    s_waitcnt lgkmcnt(0)
    v_rcp_f32 v125, v125
    v_mfma_f32_16x16x32_bf16 v[36:39], a[192:195], v[72:75], v[36:39]
    ds_read2st64_b64 v[88:91], v242 offset0:120 offset1:121
    v_mul_f32 v12, v12, v120
    v_mul_f32 v13, v13, v121
    v_mfma_f32_16x16x32_bf16 v[36:39], a[204:207], v[76:79], v[36:39]
    buffer_load_dwordx4 v240, s[48:51], s74 offen offset:1024 sc1 lds
    v_mfma_f32_16x16x32_bf16 v[36:39], a[216:219], v[80:83], v[36:39]
    ds_read2st64_b64 v[92:95], v242 offset0:122 offset1:123
    v_mul_f32 v16, v16, v122
    v_mul_f32 v17, v17, v123
    v_mfma_f32_16x16x32_bf16 v[36:39], a[228:231], v[84:87], v[36:39]
    s_mov_b32 s75, 0
    v_mul_f32 v20, v20, v124
    v_mul_f32 v21, v21, v125
    v_mfma_f32_16x16x32_bf16 v[40:43], a[196:199], v[72:75], v[40:43]
    ds_read2st64_b64 v[96:99], v242 offset0:124 offset1:125
    v_cvt_pk_bf16_f32 v120, v12, v13
    v_cvt_pk_bf16_f32 v121, v16, v17
    v_mfma_f32_16x16x32_bf16 v[40:43], a[208:211], v[76:79], v[40:43]
    buffer_load_dwordx4 v240, s[48:51], s74 offen offset:2048 sc1 lds
    v_cvt_pk_bf16_f32 v122, v20, v21
    v_mfma_f32_16x16x32_bf16 v[40:43], a[220:223], v[80:83], v[40:43]
    ds_read2st64_b64 v[100:103], v242 offset0:126 offset1:127
    v_cvt_pk_bf16_f32 v8, v12, v13
    v_cvt_pk_bf16_f32 v9, v16, v17
    v_cvt_pk_bf16_f32 v10, v20, v21
    v_mfma_f32_16x16x32_bf16 v[40:43], a[232:235], v[84:87], v[40:43]
    v_permlane16_swap_b32 v120, v121
    v_mul_f32 v7, v106, v106
    v_mfma_f32_16x16x32_bf16 v[44:47], a[200:203], v[72:75], v[44:47]
    v_permlane16_swap_b32 v122, v11
    v_fma_f32 v24, v107, v60, v24
    v_mfma_f32_16x16x32_bf16 v[44:47], a[212:215], v[76:79], v[44:47]
    v_permlane32_swap_b32 v121, v11
    v_fma_f32 v25, v107, v61, v25
    v_mfma_f32_16x16x32_bf16 v[44:47], a[224:227], v[80:83], v[44:47]
    buffer_load_dwordx4 v240, s[48:51], s74 offen offset:3072 sc1 lds
    v_fma_f32 v28, v107, v64, v28
    v_mfma_f32_16x16x32_bf16 v[44:47], a[236:239], v[84:87], v[44:47]
    s_waitcnt lgkmcnt(0)
    buffer_store_dwordx4 v[8:11], v244, s[48:51], s75 offen sc1
    v_mfma_f32_16x16x32_bf16 v[48:51], a[0:3], v[88:91], 0
    ds_read2st64_b64 v[72:75], v242 offset0:128 offset1:129
    v_rcp_f32 v5, v106
    v_mfma_f32_16x16x32_bf16 v[48:51], a[12:15], v[92:95], v[48:51]
    s_add_u32 s74, s72, 106496
    v_fma_f32 v29, v107, v65, v29
    v_fma_f32 v32, v107, v68, v32
    v_mfma_f32_16x16x32_bf16 v[48:51], a[24:27], v[96:99], v[48:51]
    ds_read2st64_b64 v[76:79], v242 offset0:130 offset1:131
    v_fma_f32 v33, v107, v69, v33
    v_mul_f32 v6, v5, v5
    v_mfma_f32_16x16x32_bf16 v[48:51], a[36:39], v[100:103], v[48:51]
    s_add_u32 m0, s73, 106496
    s_nop 0
    buffer_load_dwordx4 v240, s[48:51], s74 offen offset:0 sc1 lds
    v_mfma_f32_16x16x32_bf16 v[52:55], a[4:7], v[88:91], 0
    ds_read2st64_b64 v[80:83], v242 offset0:132 offset1:133
    v_mul_f32 v5, 0xc0135761, v5
    v_mul_f32 v6, 0x3d372713, v6
    v_mfma_f32_16x16x32_bf16 v[52:55], a[16:19], v[92:95], v[52:55]
    s_add_u32 s74, s72, 122880
    v_mul_f32 v120, v24, v24
    v_mul_f32 v121, v25, v25
    v_mfma_f32_16x16x32_bf16 v[52:55], a[28:31], v[96:99], v[52:55]
    ds_read2st64_b64 v[84:87], v242 offset0:134 offset1:135
    v_mul_f32 v122, v28, v28
    v_mul_f32 v123, v29, v29
    v_mfma_f32_16x16x32_bf16 v[52:55], a[40:43], v[100:103], v[52:55]
    s_add_u32 m0, s73, 122880
    s_nop 0
    buffer_load_dwordx4 v240, s[48:51], s74 offen offset:0 sc1 lds
    v_mfma_f32_16x16x32_bf16 v[56:59], a[8:11], v[88:91], 0
    v_mul_f32 v124, v32, v32
L_pg_f0:
    s_cbranch_execz L_rt_f0
    v_mul_f32 v125, v33, v33
    v_mfma_f32_16x16x32_bf16 v[56:59], a[20:23], v[92:95], v[56:59]
    v_mul_f32 v6, v6, v5
    v_fma_f32 v26, v107, v62, v26
    v_mfma_f32_16x16x32_bf16 v[56:59], a[32:35], v[96:99], v[56:59]
    s_mov_b32 s12, 0x3f803f80
    s_waitcnt vmcnt(13)
    v_dot2_f32_bf16 v224, v216, s12, 0
    v_dot2_f32_bf16 v225, v216, v216, 0
    v_dot2_f32_bf16 v226, v218, s12, 0
    v_dot2_f32_bf16 v227, v218, v218, 0
    v_dot2_f32_bf16 v224, v217, s12, v224
    v_dot2_f32_bf16 v225, v217, v217, v225
    v_dot2_f32_bf16 v226, v219, s12, v226
    v_dot2_f32_bf16 v227, v219, v219, v227
    s_waitcnt vmcnt(12)
    v_dot2_f32_bf16 v224, v220, s12, v224
    v_dot2_f32_bf16 v225, v220, v220, v225
    v_dot2_f32_bf16 v226, v222, s12, v226
    v_dot2_f32_bf16 v227, v222, v222, v227
    v_dot2_f32_bf16 v224, v221, s12, v224
    v_dot2_f32_bf16 v225, v221, v221, v225
    v_dot2_f32_bf16 v226, v223, s12, v226
    v_dot2_f32_bf16 v227, v223, v223, v227
    v_mfma_f32_16x16x32_bf16 v[56:59], a[44:47], v[100:103], v[56:59]
    s_waitcnt lgkmcnt(0)
    v_fma_f32 v27, v107, v63, v27
    v_fma_f32 v30, v107, v66, v30
    v_mfma_f32_16x16x32_bf16 v[48:51], a[48:51], v[72:75], v[48:51]
    ds_read2st64_b64 v[88:91], v242 offset0:136 offset1:137
    v_permlane32_swap_b32 v224, v226
    v_mfma_f32_16x16x32_bf16 v[48:51], a[60:63], v[76:79], v[48:51]
    buffer_load_dwordx4 v240, s[48:51], s74 offen offset:1024 sc1 lds
    v_mfma_f32_16x16x32_bf16 v[48:51], a[72:75], v[80:83], v[48:51]
    ds_read2st64_b64 v[92:95], v242 offset0:138 offset1:139
    v_permlane32_swap_b32 v225, v227
    v_mfma_f32_16x16x32_bf16 v[48:51], a[84:87], v[84:87], v[48:51]
    buffer_load_dwordx4 v240, s[48:51], s74 offen offset:2048 sc1 lds
    v_mfma_f32_16x16x32_bf16 v[52:55], a[52:55], v[72:75], v[52:55]
    ds_read2st64_b64 v[96:99], v242 offset0:140 offset1:141
    v_add_f32 v224, v224, v226
    v_fma_f32 v31, v107, v67, v31
    v_mfma_f32_16x16x32_bf16 v[52:55], a[64:67], v[76:79], v[52:55]
    v_fma_f32 v34, v107, v70, v34
    v_fma_f32 v35, v107, v71, v35
    v_mfma_f32_16x16x32_bf16 v[52:55], a[76:79], v[80:83], v[52:55]
    ds_read2st64_b64 v[100:103], v242 offset0:142 offset1:143
    v_add_f32 v225, v225, v227
    v_fma_f32 v120, v120, v6, v5
    v_mfma_f32_16x16x32_bf16 v[52:55], a[88:91], v[84:87], v[52:55]
    v_fma_f32 v121, v121, v6, v5
    v_fma_f32 v122, v122, v6, v5
    v_mfma_f32_16x16x32_bf16 v[56:59], a[56:59], v[72:75], v[56:59]
    buffer_load_dwordx4 v240, s[48:51], s74 offen offset:3072 sc1 lds
    v_mfma_f32_16x16x32_bf16 v[56:59], a[68:71], v[76:79], v[56:59]
    s_add_u32 m0, s73, 126976
    v_permlane16_swap_b32 v224, v225
    v_mfma_f32_16x16x32_bf16 v[56:59], a[80:83], v[80:83], v[56:59]
    s_add_u32 s74, s72, 126976
    v_add_f32 v224, v224, v225
    v_fma_f32 v123, v123, v6, v5
    v_mfma_f32_16x16x32_bf16 v[56:59], a[92:95], v[84:87], v[56:59]
    s_waitcnt lgkmcnt(0)
    v_fma_f32 v124, v124, v6, v5
    v_fma_f32 v125, v125, v6, v5
    v_mfma_f32_16x16x32_bf16 v[48:51], a[96:99], v[88:91], v[48:51]
    ds_read2st64_b64 v[72:75], v242 offset0:144 offset1:145
    v_add_f32_dpp v224, v224, v224 row_ror:8 row_mask:0xf bank_mask:0xf
    v_mul_f32 v120, v120, v24
    v_mfma_f32_16x16x32_bf16 v[48:51], a[108:111], v[92:95], v[48:51]
    buffer_load_dwordx4 v240, s[48:51], s74 offen offset:0 sc1 lds
    v_mfma_f32_16x16x32_bf16 v[48:51], a[120:123], v[96:99], v[48:51]
    ds_read2st64_b64 v[76:79], v242 offset0:146 offset1:147
    v_add_f32_dpp v224, v224, v224 row_ror:4 row_mask:0xf bank_mask:0xf
    v_mul_f32 v121, v121, v25
    v_mfma_f32_16x16x32_bf16 v[48:51], a[132:135], v[100:103], v[48:51]
    s_add_u32 s74, s72, 143360
    v_mul_f32 v122, v122, v28
    v_mul_f32 v123, v123, v29
    v_mfma_f32_16x16x32_bf16 v[52:55], a[100:103], v[88:91], v[52:55]
    ds_read2st64_b64 v[80:83], v242 offset0:148 offset1:149
    v_add_f32_dpp v224, v224, v224 row_ror:2 row_mask:0xf bank_mask:0xf
    v_mul_f32 v124, v124, v32
    v_mfma_f32_16x16x32_bf16 v[52:55], a[112:115], v[92:95], v[52:55]
    s_add_u32 m0, s73, 0
    s_nop 0
    buffer_load_dwordx4 v240, s[48:51], s74 offen offset:0 sc1 lds
    v_mfma_f32_16x16x32_bf16 v[52:55], a[124:127], v[96:99], v[52:55]
    ds_read2st64_b64 v[84:87], v242 offset0:150 offset1:151
    v_mul_f32 v125, v125, v33
    v_mul_f32 v24, v24, v26
    v_mfma_f32_16x16x32_bf16 v[52:55], a[136:139], v[100:103], v[52:55]
    ds_write_b32 v230, v224
    v_mfma_f32_16x16x32_bf16 v[56:59], a[104:107], v[88:91], v[56:59]
    v_exp_f32 v120, v120
    v_mfma_f32_16x16x32_bf16 v[56:59], a[116:119], v[92:95], v[56:59]
    buffer_load_dwordx4 v240, s[48:51], s74 offen offset:1024 sc1 lds
    v_mfma_f32_16x16x32_bf16 v[56:59], a[128:131], v[96:99], v[56:59]
    v_exp_f32 v121, v121
    v_mfma_f32_16x16x32_bf16 v[56:59], a[140:143], v[100:103], v[56:59]
    s_waitcnt lgkmcnt(0)
    v_exp_f32 v122, v122
    v_mfma_f32_16x16x32_bf16 v[48:51], a[144:147], v[72:75], v[48:51]
    ds_read2st64_b64 v[88:91], v242 offset0:152 offset1:153
    v_exp_f32 v123, v123
    v_mfma_f32_16x16x32_bf16 v[48:51], a[156:159], v[76:79], v[48:51]
    buffer_load_dwordx4 v240, s[48:51], s74 offen offset:2048 sc1 lds
    v_mfma_f32_16x16x32_bf16 v[48:51], a[168:171], v[80:83], v[48:51]
    ds_read2st64_b64 v[92:95], v242 offset0:154 offset1:155
    v_exp_f32 v124, v124
    v_mfma_f32_16x16x32_bf16 v[48:51], a[180:183], v[84:87], v[48:51]
    v_exp_f32 v125, v125
    v_mfma_f32_16x16x32_bf16 v[52:55], a[148:151], v[72:75], v[52:55]
    ds_read2st64_b64 v[96:99], v242 offset0:156 offset1:157
    v_mul_f32 v25, v25, v27
    v_mul_f32 v28, v28, v30
    v_mfma_f32_16x16x32_bf16 v[52:55], a[160:163], v[76:79], v[52:55]
    v_mul_f32 v29, v29, v31
    v_mul_f32 v32, v32, v34
    v_mfma_f32_16x16x32_bf16 v[52:55], a[172:175], v[80:83], v[52:55]
    ds_read2st64_b64 v[100:103], v242 offset0:158 offset1:159
    v_mul_f32 v33, v33, v35
    v_fma_f32 v120, v120, v7, v7
    v_mfma_f32_16x16x32_bf16 v[52:55], a[184:187], v[84:87], v[52:55]
    buffer_load_dwordx4 v240, s[48:51], s74 offen offset:3072 sc1 lds
    v_mfma_f32_16x16x32_bf16 v[56:59], a[152:155], v[72:75], v[56:59]
    s_add_u32 s74, s72, 147456
    v_fma_f32 v121, v121, v7, v7
    v_fma_f32 v122, v122, v7, v7
    v_mfma_f32_16x16x32_bf16 v[56:59], a[164:167], v[76:79], v[56:59]
    s_waitcnt vmcnt(15)
    v_fma_f32 v123, v123, v7, v7
    v_fma_f32 v124, v124, v7, v7
    v_mfma_f32_16x16x32_bf16 v[56:59], a[176:179], v[80:83], v[56:59]
    s_barrier
    v_fma_f32 v125, v125, v7, v7
    s_mov_b32 s75, 49152
    v_mfma_f32_16x16x32_bf16 v[56:59], a[188:191], v[84:87], v[56:59]
    s_waitcnt lgkmcnt(0)
    ds_read_b128 v[216:219], v231
    ds_read_b128 v[220:223], v231 offset:16
    v_mfma_f32_16x16x32_bf16 v[48:51], a[192:195], v[88:91], v[48:51]
    ds_read2st64_b64 v[72:75], v243 offset0:0 offset1:1
    v_rcp_f32 v120, v120
    v_mfma_f32_16x16x32_bf16 v[48:51], a[204:207], v[92:95], v[48:51]
    s_add_u32 m0, s73, 4096
    s_nop 0
    buffer_load_dwordx4 v240, s[48:51], s74 offen offset:0 sc1 lds
    v_mfma_f32_16x16x32_bf16 v[48:51], a[216:219], v[96:99], v[48:51]
    ds_read2st64_b64 v[76:79], v243 offset0:2 offset1:3
    v_rcp_f32 v121, v121
    v_mfma_f32_16x16x32_bf16 v[48:51], a[228:231], v[100:103], v[48:51]
    s_add_u32 m0, s73, 20480
    s_add_u32 s71, s70, 35840
    buffer_load_dwordx4 v240, s[48:51], s71 offen offset:0 sc1 lds
    v_mfma_f32_16x16x32_bf16 v[52:55], a[196:199], v[88:91], v[52:55]
    ds_read2st64_b64 v[80:83], v243 offset0:4 offset1:5
    v_rcp_f32 v122, v122
    v_mfma_f32_16x16x32_bf16 v[52:55], a[208:211], v[92:95], v[52:55]
    v_rcp_f32 v123, v123
    v_mul_f32 v24, v24, v120
    v_mfma_f32_16x16x32_bf16 v[52:55], a[220:223], v[96:99], v[52:55]
    ds_read2st64_b64 v[84:87], v243 offset0:6 offset1:7
    v_rcp_f32 v124, v124
    v_mul_f32 v25, v25, v121
    v_mfma_f32_16x16x32_bf16 v[52:55], a[232:235], v[100:103], v[52:55]
    v_rcp_f32 v125, v125
    v_mul_f32 v28, v28, v122
    v_mfma_f32_16x16x32_bf16 v[56:59], a[200:203], v[88:91], v[56:59]
    buffer_load_dwordx4 v240, s[48:51], s71 offen offset:1024 sc1 lds
    v_mul_f32 v29, v29, v123
    v_mfma_f32_16x16x32_bf16 v[56:59], a[212:215], v[92:95], v[56:59]
    v_mul_f32 v32, v32, v124
    v_mul_f32 v33, v33, v125
    v_cvt_pk_bf16_f32 v120, v24, v25
    v_mfma_f32_16x16x32_bf16 v[56:59], a[224:227], v[96:99], v[56:59]
    v_cvt_pk_bf16_f32 v121, v28, v29
    v_cvt_pk_bf16_f32 v122, v32, v33
    v_cvt_pk_bf16_f32 v8, v24, v25
    v_mfma_f32_16x16x32_bf16 v[56:59], a[236:239], v[100:103], v[56:59]
    s_waitcnt lgkmcnt(0)
    v_cvt_pk_bf16_f32 v9, v28, v29
    v_cvt_pk_bf16_f32 v10, v32, v33
    v_mul_f32 v7, v108, v108
    v_mfma_f32_16x16x32_bf16 v[12:15], a[0:3], v[72:75], 0
    ds_read2st64_b64 v[88:91], v243 offset0:8 offset1:9
    v_add_f32 v216, v216, v217
    v_add_f32 v218, v218, v219
    v_add_f32 v220, v220, v221
    v_mfma_f32_16x16x32_bf16 v[12:15], a[12:15], v[76:79], v[12:15]
    v_add_f32 v222, v222, v223
    v_add_f32 v216, v216, v218
    v_fma_f32 v36, v109, v60, v36
    v_mfma_f32_16x16x32_bf16 v[12:15], a[24:27], v[80:83], v[12:15]
    ds_read2st64_b64 v[92:95], v243 offset0:10 offset1:11
    v_add_f32 v220, v220, v222
    v_mul_f32 v216, 0x3acccccd, v216
    v_fma_f32 v37, v109, v61, v37
    v_mfma_f32_16x16x32_bf16 v[12:15], a[36:39], v[84:87], v[12:15]
    buffer_load_dwordx4 v240, s[48:51], s71 offen offset:2048 sc1 lds
    v_mul_f32 v220, 0x3acccccd, v220
    v_mfma_f32_16x16x32_bf16 v[16:19], a[4:7], v[72:75], 0
    ds_read2st64_b64 v[96:99], v243 offset0:12 offset1:13
    v_fma_f32 v220, -v216, v216, v220
    v_permlane16_swap_b32 v120, v121
    v_mfma_f32_16x16x32_bf16 v[16:19], a[16:19], v[76:79], v[16:19]
    v_max_f32 v220, 0, v220
    v_permlane16_swap_b32 v122, v11
    v_mfma_f32_16x16x32_bf16 v[16:19], a[28:31], v[80:83], v[16:19]
    ds_read2st64_b64 v[100:103], v243 offset0:14 offset1:15
    v_cvt_pk_bf16_f32 v217, v216, v220
    v_permlane32_swap_b32 v121, v11
    v_mfma_f32_16x16x32_bf16 v[16:19], a[40:43], v[84:87], v[16:19]
    buffer_load_dwordx4 v240, s[48:51], s71 offen offset:3072 sc1 lds
    v_lshlrev_b32 v219, 16, v217
    v_mfma_f32_16x16x32_bf16 v[20:23], a[8:11], v[72:75], 0
    buffer_store_dwordx4 v[8:11], v244, s[48:51], s75 offen sc1
    v_and_b32 v217, 0xffff0000, v217
    v_mfma_f32_16x16x32_bf16 v[20:23], a[20:23], v[76:79], v[20:23]
    s_add_u32 m0, s73, 24576
    v_add_f32 v217, 0x3727c5ac, v217
    v_xor_b32 v219, 0x80000000, v219
    v_mfma_f32_16x16x32_bf16 v[20:23], a[32:35], v[80:83], v[20:23]
    s_add_u32 s71, s70, 39936
    v_cvt_pk_bf16_f32 v217, v217, v217
    v_fma_f32 v40, v109, v64, v40
    v_mfma_f32_16x16x32_bf16 v[20:23], a[44:47], v[84:87], v[20:23]
    s_waitcnt lgkmcnt(0)
    v_and_b32 v217, 0xffff0000, v217
    v_fma_f32 v41, v109, v65, v41
    v_mfma_f32_16x16x32_bf16 v[12:15], a[48:51], v[88:91], v[12:15]
    ds_read2st64_b64 v[72:75], v243 offset0:16 offset1:17
    v_sqrt_f32 v217, v217
    v_mfma_f32_16x16x32_bf16 v[12:15], a[60:63], v[92:95], v[12:15]
    buffer_load_dwordx4 v240, s[48:51], s71 offen offset:0 sc1 lds
    v_mfma_f32_16x16x32_bf16 v[12:15], a[72:75], v[96:99], v[12:15]
    ds_read2st64_b64 v[76:79], v243 offset0:18 offset1:19
    v_cvt_pk_bf16_f32 v217, v217, v217
    v_fma_f32 v44, v109, v68, v44
    v_mfma_f32_16x16x32_bf16 v[12:15], a[84:87], v[100:103], v[12:15]
    s_add_u32 m0, s73, 40960
    v_and_b32 v218, 0xffff0000, v217
    v_fma_f32 v45, v109, v69, v45
    v_mfma_f32_16x16x32_bf16 v[16:19], a[52:55], v[88:91], v[16:19]
    ds_read2st64_b64 v[80:83], v243 offset0:20 offset1:21
    v_rcp_f32 v5, v108
    v_mfma_f32_16x16x32_bf16 v[16:19], a[64:67], v[92:95], v[16:19]
    s_add_u32 s71, s70, 40960
    v_mul_f32 v6, v5, v5
    v_mul_f32 v5, 0xc0135761, v5
    v_mfma_f32_16x16x32_bf16 v[16:19], a[76:79], v[96:99], v[16:19]
    ds_read2st64_b64 v[84:87], v243 offset0:22 offset1:23
    v_mul_f32 v6, 0x3d372713, v6
    v_mul_f32 v120, v36, v36
    v_mfma_f32_16x16x32_bf16 v[16:19], a[88:91], v[100:103], v[16:19]
    buffer_load_dwordx4 v240, s[48:51], s71 offen offset:0 sc1 lds
    v_mfma_f32_16x16x32_bf16 v[20:23], a[56:59], v[88:91], v[20:23]
    buffer_store_dwordx2 v[218:219], v232, s[48:51], 0 offen offset:512 sc1
    v_mfma_f32_16x16x32_bf16 v[20:23], a[68:71], v[92:95], v[20:23]
    v_mul_f32 v121, v37, v37
    v_mul_f32 v122, v40, v40
    v_mfma_f32_16x16x32_bf16 v[20:23], a[80:83], v[96:99], v[20:23]
    v_mul_f32 v123, v41, v41
    v_mul_f32 v124, v44, v44
    v_mfma_f32_16x16x32_bf16 v[20:23], a[92:95], v[100:103], v[20:23]
    s_waitcnt lgkmcnt(0)
    v_mul_f32 v125, v45, v45
    v_mul_f32 v6, v6, v5
    v_mfma_f32_16x16x32_bf16 v[12:15], a[96:99], v[72:75], v[12:15]
    ds_read2st64_b64 v[88:91], v243 offset0:24 offset1:25
    v_fma_f32 v38, v109, v62, v38
    v_fma_f32 v39, v109, v63, v39
    v_mfma_f32_16x16x32_bf16 v[12:15], a[108:111], v[76:79], v[12:15]
    buffer_load_dwordx4 v240, s[48:51], s71 offen offset:1024 sc1 lds
    v_mfma_f32_16x16x32_bf16 v[12:15], a[120:123], v[80:83], v[12:15]
    ds_read2st64_b64 v[92:95], v243 offset0:26 offset1:27
    v_fma_f32 v42, v109, v66, v42
    v_fma_f32 v43, v109, v67, v43
    v_mfma_f32_16x16x32_bf16 v[12:15], a[132:135], v[84:87], v[12:15]
    v_fma_f32 v46, v109, v70, v46
    v_fma_f32 v47, v109, v71, v47
    v_mfma_f32_16x16x32_bf16 v[16:19], a[100:103], v[72:75], v[16:19]
    ds_read2st64_b64 v[96:99], v243 offset0:28 offset1:29
    v_fma_f32 v120, v120, v6, v5
    v_fma_f32 v121, v121, v6, v5
    v_mfma_f32_16x16x32_bf16 v[16:19], a[112:115], v[76:79], v[16:19]
    v_fma_f32 v122, v122, v6, v5
    v_fma_f32 v123, v123, v6, v5
    v_mfma_f32_16x16x32_bf16 v[16:19], a[124:127], v[80:83], v[16:19]
    ds_read2st64_b64 v[100:103], v243 offset0:30 offset1:31
    v_fma_f32 v124, v124, v6, v5
    v_fma_f32 v125, v125, v6, v5
    v_mfma_f32_16x16x32_bf16 v[16:19], a[136:139], v[84:87], v[16:19]
    buffer_load_dwordx4 v240, s[48:51], s71 offen offset:2048 sc1 lds
    v_mfma_f32_16x16x32_bf16 v[20:23], a[104:107], v[72:75], v[20:23]
    v_mul_f32 v120, v120, v36
    v_mul_f32 v121, v121, v37
    v_mfma_f32_16x16x32_bf16 v[20:23], a[116:119], v[76:79], v[20:23]
    v_mul_f32 v122, v122, v40
    v_mul_f32 v123, v123, v41
    v_mfma_f32_16x16x32_bf16 v[20:23], a[128:131], v[80:83], v[20:23]
    v_mul_f32 v124, v124, v44
    v_mul_f32 v125, v125, v45
    v_mfma_f32_16x16x32_bf16 v[20:23], a[140:143], v[84:87], v[20:23]
    s_waitcnt lgkmcnt(0)
    v_exp_f32 v120, v120
    v_mfma_f32_16x16x32_bf16 v[12:15], a[144:147], v[88:91], v[12:15]
    ds_read2st64_b64 v[72:75], v243 offset0:32 offset1:33
    v_exp_f32 v121, v121
    v_mfma_f32_16x16x32_bf16 v[12:15], a[156:159], v[92:95], v[12:15]
    buffer_load_dwordx4 v240, s[48:51], s71 offen offset:3072 sc1 lds
    v_mfma_f32_16x16x32_bf16 v[12:15], a[168:171], v[96:99], v[12:15]
    ds_read2st64_b64 v[76:79], v243 offset0:34 offset1:35
    v_exp_f32 v122, v122
    v_mfma_f32_16x16x32_bf16 v[12:15], a[180:183], v[100:103], v[12:15]
    s_add_u32 s71, s70, 45056
    v_exp_f32 v123, v123
    v_mfma_f32_16x16x32_bf16 v[16:19], a[148:151], v[88:91], v[16:19]
    ds_read2st64_b64 v[80:83], v243 offset0:36 offset1:37
    v_exp_f32 v124, v124
    v_mfma_f32_16x16x32_bf16 v[16:19], a[160:163], v[92:95], v[16:19]
    s_add_u32 m0, s73, 45056
    s_nop 0
    buffer_load_dwordx4 v240, s[48:51], s71 offen offset:0 sc1 lds
    v_mfma_f32_16x16x32_bf16 v[16:19], a[172:175], v[96:99], v[16:19]
    ds_read2st64_b64 v[84:87], v243 offset0:38 offset1:39
    v_exp_f32 v125, v125
    v_mfma_f32_16x16x32_bf16 v[16:19], a[184:187], v[100:103], v[16:19]
    v_mul_f32 v36, v36, v38
    v_mul_f32 v37, v37, v39
    v_mfma_f32_16x16x32_bf16 v[20:23], a[152:155], v[88:91], v[20:23]
    v_mul_f32 v40, v40, v42
    v_mul_f32 v41, v41, v43
    v_mfma_f32_16x16x32_bf16 v[20:23], a[164:167], v[92:95], v[20:23]
    s_waitcnt vmcnt(22)
    v_mul_f32 v44, v44, v46
    v_mul_f32 v45, v45, v47
    v_mfma_f32_16x16x32_bf16 v[20:23], a[176:179], v[96:99], v[20:23]
    s_barrier
    v_fma_f32 v120, v120, v7, v7
    v_fma_f32 v121, v121, v7, v7
    v_mfma_f32_16x16x32_bf16 v[20:23], a[188:191], v[100:103], v[20:23]
    s_waitcnt lgkmcnt(0)
    v_fma_f32 v122, v122, v7, v7
    v_fma_f32 v123, v123, v7, v7
    v_mfma_f32_16x16x32_bf16 v[12:15], a[192:195], v[72:75], v[12:15]
    ds_read2st64_b64 v[88:91], v243 offset0:40 offset1:41
    v_fma_f32 v124, v124, v7, v7
    v_fma_f32 v125, v125, v7, v7
    v_mfma_f32_16x16x32_bf16 v[12:15], a[204:207], v[76:79], v[12:15]
    buffer_load_dwordx4 v[180:183], v240, s[48:51], s83 offen offset:1024 sc1
    v_mfma_f32_16x16x32_bf16 v[12:15], a[216:219], v[80:83], v[12:15]
    ds_read2st64_b64 v[92:95], v243 offset0:42 offset1:43
    v_rcp_f32 v120, v120
    v_mfma_f32_16x16x32_bf16 v[12:15], a[228:231], v[84:87], v[12:15]
    s_add_u32 s71, s70, 46080
    v_rcp_f32 v121, v121
    v_mfma_f32_16x16x32_bf16 v[16:19], a[196:199], v[72:75], v[16:19]
    ds_read2st64_b64 v[96:99], v243 offset0:44 offset1:45
    v_rcp_f32 v122, v122
    v_mfma_f32_16x16x32_bf16 v[16:19], a[208:211], v[76:79], v[16:19]
    s_add_u32 m0, s73, 61440
    s_nop 0
    buffer_load_dwordx4 v240, s[48:51], s71 offen offset:0 sc1 lds
    v_mfma_f32_16x16x32_bf16 v[16:19], a[220:223], v[80:83], v[16:19]
    ds_read2st64_b64 v[100:103], v243 offset0:46 offset1:47
    v_rcp_f32 v123, v123
    v_mul_f32 v36, v36, v120
    v_mfma_f32_16x16x32_bf16 v[16:19], a[232:235], v[84:87], v[16:19]
    s_mov_b32 s75, 98304
    v_rcp_f32 v124, v124
    v_mul_f32 v37, v37, v121
    v_mfma_f32_16x16x32_bf16 v[20:23], a[200:203], v[72:75], v[20:23]
    v_rcp_f32 v125, v125
    v_mul_f32 v40, v40, v122
    v_mfma_f32_16x16x32_bf16 v[20:23], a[212:215], v[76:79], v[20:23]
    v_mul_f32 v41, v41, v123
    v_mul_f32 v44, v44, v124
    v_mul_f32 v45, v45, v125
    v_mfma_f32_16x16x32_bf16 v[20:23], a[224:227], v[80:83], v[20:23]
    buffer_load_dwordx4 v240, s[48:51], s71 offen offset:1024 sc1 lds
    v_cvt_pk_bf16_f32 v120, v36, v37
    v_mfma_f32_16x16x32_bf16 v[20:23], a[236:239], v[84:87], v[20:23]
    s_waitcnt lgkmcnt(0)
    v_cvt_pk_bf16_f32 v121, v40, v41
    v_cvt_pk_bf16_f32 v122, v44, v45
    v_cvt_pk_bf16_f32 v8, v36, v37
    v_mfma_f32_16x16x32_bf16 v[24:27], a[0:3], v[88:91], 0
    ds_read2st64_b64 v[72:75], v243 offset0:48 offset1:49
    v_cvt_pk_bf16_f32 v9, v40, v41
    v_cvt_pk_bf16_f32 v10, v44, v45
    v_mov_b32 v2, 1
    v_mfma_f32_16x16x32_bf16 v[24:27], a[12:15], v[92:95], v[24:27]
    v_permlane16_swap_b32 v120, v121
    v_mul_f32 v7, v110, v110
    v_mfma_f32_16x16x32_bf16 v[24:27], a[24:27], v[96:99], v[24:27]
    ds_read2st64_b64 v[76:79], v243 offset0:50 offset1:51
    v_permlane16_swap_b32 v122, v11
    v_fma_f32 v48, v111, v60, v48
    v_mfma_f32_16x16x32_bf16 v[24:27], a[36:39], v[100:103], v[24:27]
    v_permlane32_swap_b32 v121, v11
    s_waitcnt vmcnt(10)
    v_mfma_f32_16x16x32_bf16 v[28:31], a[4:7], v[88:91], 0
    ds_read2st64_b64 v[80:83], v243 offset0:52 offset1:53
    buffer_store_dword v2, v246, s[48:51], 0 offen sc1
    v_mfma_f32_16x16x32_bf16 v[28:31], a[16:19], v[92:95], v[28:31]
    buffer_load_dwordx4 v240, s[48:51], s71 offen offset:2048 sc1 lds
    v_fma_f32 v49, v111, v61, v49
    v_mfma_f32_16x16x32_bf16 v[28:31], a[28:31], v[96:99], v[28:31]
    ds_read2st64_b64 v[84:87], v243 offset0:54 offset1:55
    buffer_store_dwordx4 v[8:11], v244, s[48:51], s75 offen sc1
    v_mfma_f32_16x16x32_bf16 v[28:31], a[40:43], v[100:103], v[28:31]
    v_rcp_f32 v5, v110
    v_mfma_f32_16x16x32_bf16 v[32:35], a[8:11], v[88:91], 0
    v_fma_f32 v52, v111, v64, v52
    v_fma_f32 v53, v111, v65, v53
    v_mfma_f32_16x16x32_bf16 v[32:35], a[20:23], v[92:95], v[32:35]
    v_fma_f32 v56, v111, v68, v56
    v_fma_f32 v57, v111, v69, v57
    v_mfma_f32_16x16x32_bf16 v[32:35], a[32:35], v[96:99], v[32:35]
    buffer_load_dwordx4 v[112:115], v245, s[48:51], 0 offen offset:512 sc1
    v_mfma_f32_16x16x32_bf16 v[32:35], a[44:47], v[100:103], v[32:35]
    s_waitcnt lgkmcnt(0)
    v_mul_f32 v6, v5, v5
    v_mul_f32 v5, 0xc0135761, v5
    v_mfma_f32_16x16x32_bf16 v[24:27], a[48:51], v[72:75], v[24:27]
    ds_read2st64_b64 v[88:91], v243 offset0:56 offset1:57
    v_mul_f32 v6, 0x3d372713, v6
    v_mul_f32 v120, v48, v48
    v_mfma_f32_16x16x32_bf16 v[24:27], a[60:63], v[76:79], v[24:27]
    buffer_load_dwordx4 v240, s[48:51], s71 offen offset:3072 sc1 lds
    v_mfma_f32_16x16x32_bf16 v[24:27], a[72:75], v[80:83], v[24:27]
    ds_read2st64_b64 v[92:95], v243 offset0:58 offset1:59
    v_mul_f32 v121, v49, v49
    v_mul_f32 v122, v52, v52
    v_mfma_f32_16x16x32_bf16 v[24:27], a[84:87], v[84:87], v[24:27]
    buffer_load_dwordx4 v[116:119], v245, s[48:51], 0 offen offset:768 sc1
    v_mfma_f32_16x16x32_bf16 v[28:31], a[52:55], v[72:75], v[28:31]
    ds_read2st64_b64 v[96:99], v243 offset0:60 offset1:61
    v_mul_f32 v123, v53, v53
    v_mul_f32 v124, v56, v56
    v_mfma_f32_16x16x32_bf16 v[28:31], a[64:67], v[76:79], v[28:31]
    s_add_u32 m0, s73, 65536
    s_add_u32 s71, s70, 50176
    buffer_load_dwordx4 v240, s[48:51], s71 offen offset:0 sc1 lds
    v_mfma_f32_16x16x32_bf16 v[28:31], a[76:79], v[80:83], v[28:31]
    ds_read2st64_b64 v[100:103], v243 offset0:62 offset1:63
    v_mul_f32 v125, v57, v57
    v_mul_f32 v6, v6, v5
    v_mfma_f32_16x16x32_bf16 v[28:31], a[88:91], v[84:87], v[28:31]
    v_fma_f32 v50, v111, v62, v50
    v_fma_f32 v51, v111, v63, v51
    v_mfma_f32_16x16x32_bf16 v[32:35], a[56:59], v[72:75], v[32:35]
    v_fma_f32 v54, v111, v66, v54
    v_fma_f32 v55, v111, v67, v55
    v_mfma_f32_16x16x32_bf16 v[32:35], a[68:71], v[76:79], v[32:35]
    buffer_load_dwordx4 v[184:187], v240, s[48:51], s83 offen offset:2048 sc1
    v_mfma_f32_16x16x32_bf16 v[32:35], a[80:83], v[80:83], v[32:35]
    v_fma_f32 v58, v111, v70, v58
    v_fma_f32 v59, v111, v71, v59
    v_mfma_f32_16x16x32_bf16 v[32:35], a[92:95], v[84:87], v[32:35]
    s_waitcnt lgkmcnt(0)
    v_fma_f32 v120, v120, v6, v5
    v_fma_f32 v121, v121, v6, v5
    v_mfma_f32_16x16x32_bf16 v[24:27], a[96:99], v[88:91], v[24:27]
    ds_read2st64_b64 v[72:75], v243 offset0:64 offset1:65
    v_fma_f32 v122, v122, v6, v5
    v_fma_f32 v123, v123, v6, v5
    v_mfma_f32_16x16x32_bf16 v[24:27], a[108:111], v[92:95], v[24:27]
    v_fma_f32 v124, v124, v6, v5
    v_fma_f32 v125, v125, v6, v5
    v_mfma_f32_16x16x32_bf16 v[24:27], a[120:123], v[96:99], v[24:27]
    ds_read2st64_b64 v[76:79], v243 offset0:66 offset1:67
    v_mul_f32 v120, v120, v48
    v_mul_f32 v121, v121, v49
    v_mfma_f32_16x16x32_bf16 v[24:27], a[132:135], v[100:103], v[24:27]
    buffer_load_dwordx4 v[188:191], v240, s[48:51], s83 offen offset:3072 sc1
    v_mfma_f32_16x16x32_bf16 v[28:31], a[100:103], v[88:91], v[28:31]
    ds_read2st64_b64 v[80:83], v243 offset0:68 offset1:69
    v_mul_f32 v122, v122, v52
    v_mul_f32 v123, v123, v53
    v_mfma_f32_16x16x32_bf16 v[28:31], a[112:115], v[92:95], v[28:31]
    v_mul_f32 v124, v124, v56
    v_mul_f32 v125, v125, v57
    v_mfma_f32_16x16x32_bf16 v[28:31], a[124:127], v[96:99], v[28:31]
    ds_read2st64_b64 v[84:87], v243 offset0:70 offset1:71
    v_exp_f32 v120, v120
    v_mfma_f32_16x16x32_bf16 v[28:31], a[136:139], v[100:103], v[28:31]
    s_add_u32 s83, s82, 16384
    v_exp_f32 v121, v121
    v_mfma_f32_16x16x32_bf16 v[32:35], a[104:107], v[88:91], v[32:35]
    buffer_load_dwordx4 v[192:195], v240, s[48:51], s83 offen offset:0 sc1
    v_mfma_f32_16x16x32_bf16 v[32:35], a[116:119], v[92:95], v[32:35]
    v_exp_f32 v122, v122
    v_mfma_f32_16x16x32_bf16 v[32:35], a[128:131], v[96:99], v[32:35]
    v_exp_f32 v123, v123
    v_mfma_f32_16x16x32_bf16 v[32:35], a[140:143], v[100:103], v[32:35]
    s_waitcnt lgkmcnt(0)
    v_exp_f32 v124, v124
    v_mfma_f32_16x16x32_bf16 v[24:27], a[144:147], v[72:75], v[24:27]
    ds_read2st64_b64 v[88:91], v243 offset0:72 offset1:73
    v_exp_f32 v125, v125
    v_mfma_f32_16x16x32_bf16 v[24:27], a[156:159], v[76:79], v[24:27]
    v_mul_f32 v48, v48, v50
    v_mul_f32 v49, v49, v51
    v_mfma_f32_16x16x32_bf16 v[24:27], a[168:171], v[80:83], v[24:27]
    ds_read2st64_b64 v[92:95], v243 offset0:74 offset1:75
    v_mul_f32 v52, v52, v54
    v_mul_f32 v53, v53, v55
    v_mfma_f32_16x16x32_bf16 v[24:27], a[180:183], v[84:87], v[24:27]
    buffer_load_dwordx4 v[196:199], v240, s[48:51], s83 offen offset:1024 sc1
    v_mfma_f32_16x16x32_bf16 v[28:31], a[148:151], v[72:75], v[28:31]
    ds_read2st64_b64 v[96:99], v243 offset0:76 offset1:77
    v_mul_f32 v56, v56, v58
    v_mul_f32 v57, v57, v59
    v_mfma_f32_16x16x32_bf16 v[28:31], a[160:163], v[76:79], v[28:31]
    s_add_u32 s83, s82, 20480
    v_fma_f32 v120, v120, v7, v7
    v_fma_f32 v121, v121, v7, v7
    v_mfma_f32_16x16x32_bf16 v[28:31], a[172:175], v[80:83], v[28:31]
    ds_read2st64_b64 v[100:103], v243 offset0:78 offset1:79
    v_fma_f32 v122, v122, v7, v7
    v_fma_f32 v123, v123, v7, v7
    v_mfma_f32_16x16x32_bf16 v[28:31], a[184:187], v[84:87], v[28:31]
    buffer_load_dwordx4 v[216:219], v240, s[48:51], s83 offen offset:2048 sc1
    v_mfma_f32_16x16x32_bf16 v[32:35], a[152:155], v[72:75], v[32:35]
    s_add_u32 s71, s70, 51200
    v_fma_f32 v124, v124, v7, v7
    v_fma_f32 v125, v125, v7, v7
    v_mfma_f32_16x16x32_bf16 v[32:35], a[164:167], v[76:79], v[32:35]
    v_rcp_f32 v120, v120
    v_mfma_f32_16x16x32_bf16 v[32:35], a[176:179], v[80:83], v[32:35]
    s_barrier
    v_rcp_f32 v121, v121
    v_mfma_f32_16x16x32_bf16 v[32:35], a[188:191], v[84:87], v[32:35]
    s_waitcnt lgkmcnt(0)
    v_rcp_f32 v122, v122
    v_mfma_f32_16x16x32_bf16 v[24:27], a[192:195], v[88:91], v[24:27]
    ds_read2st64_b64 v[72:75], v243 offset0:80 offset1:81
    v_rcp_f32 v123, v123
    v_mfma_f32_16x16x32_bf16 v[24:27], a[204:207], v[92:95], v[24:27]
    s_add_u32 m0, s73, 81920
    s_nop 0
    buffer_load_dwordx4 v240, s[48:51], s71 offen offset:0 sc1 lds
    v_mfma_f32_16x16x32_bf16 v[24:27], a[216:219], v[96:99], v[24:27]
    ds_read2st64_b64 v[76:79], v243 offset0:82 offset1:83
    v_rcp_f32 v124, v124
    v_mfma_f32_16x16x32_bf16 v[24:27], a[228:231], v[100:103], v[24:27]
    s_mov_b32 s75, 147456
    v_rcp_f32 v125, v125
    v_mfma_f32_16x16x32_bf16 v[28:31], a[196:199], v[88:91], v[28:31]
    ds_read2st64_b64 v[80:83], v243 offset0:84 offset1:85
    v_mul_f32 v48, v48, v120
    v_mul_f32 v49, v49, v121
    v_mfma_f32_16x16x32_bf16 v[28:31], a[208:211], v[92:95], v[28:31]
    v_mul_f32 v52, v52, v122
    v_mul_f32 v53, v53, v123
    v_mul_f32 v56, v56, v124
    v_mfma_f32_16x16x32_bf16 v[28:31], a[220:223], v[96:99], v[28:31]
    ds_read2st64_b64 v[84:87], v243 offset0:86 offset1:87
    v_mul_f32 v57, v57, v125
    v_cvt_pk_bf16_f32 v120, v48, v49
    v_cvt_pk_bf16_f32 v121, v52, v53
    v_mfma_f32_16x16x32_bf16 v[28:31], a[232:235], v[100:103], v[28:31]
    buffer_load_dwordx4 v240, s[48:51], s71 offen offset:1024 sc1 lds
    v_cvt_pk_bf16_f32 v122, v56, v57
    v_mfma_f32_16x16x32_bf16 v[32:35], a[200:203], v[88:91], v[32:35]
    v_cvt_pk_bf16_f32 v8, v48, v49
    v_cvt_pk_bf16_f32 v9, v52, v53
    v_cvt_pk_bf16_f32 v10, v56, v57
    v_mfma_f32_16x16x32_bf16 v[32:35], a[212:215], v[92:95], v[32:35]
    v_permlane16_swap_b32 v120, v121
    v_mfma_f32_16x16x32_bf16 v[32:35], a[224:227], v[96:99], v[32:35]
    v_permlane16_swap_b32 v122, v11
    v_mfma_f32_16x16x32_bf16 v[32:35], a[236:239], v[100:103], v[32:35]
    s_waitcnt lgkmcnt(0)
    s_waitcnt vmcnt(8)
    v_min3_u32 v3, v112, v114, v116
    v_permlane32_swap_b32 v121, v11
    v_mfma_f32_16x16x32_bf16 v[36:39], a[0:3], v[72:75], 0
    ds_read2st64_b64 v[88:91], v243 offset0:88 offset1:89
    v_min_u32 v3, v3, v118
    v_mfma_f32_16x16x32_bf16 v[36:39], a[12:15], v[76:79], v[36:39]
    v_cmp_eq_u32 vcc, 0, v3
    v_mfma_f32_16x16x32_bf16 v[36:39], a[24:27], v[80:83], v[36:39]
    ds_read2st64_b64 v[92:95], v243 offset0:90 offset1:91
    s_cbranch_vccnz L_chk27_slow
L_chk27:
    v_mfma_f32_16x16x32_bf16 v[36:39], a[36:39], v[84:87], v[36:39]
    buffer_load_dwordx4 v240, s[48:51], s71 offen offset:2048 sc1 lds
    v_mul_f32 v7, v112, v112
    v_mfma_f32_16x16x32_bf16 v[40:43], a[4:7], v[72:75], 0
    ds_read2st64_b64 v[96:99], v243 offset0:92 offset1:93
    buffer_store_dwordx4 v[8:11], v244, s[48:51], s75 offen sc1
    v_mfma_f32_16x16x32_bf16 v[40:43], a[16:19], v[76:79], v[40:43]
    v_rcp_f32 v5, v112
    v_mfma_f32_16x16x32_bf16 v[40:43], a[28:31], v[80:83], v[40:43]
    ds_read2st64_b64 v[100:103], v243 offset0:94 offset1:95
    v_fma_f32 v12, v113, v60, v12
L_pg_f1:
    s_cbranch_execz L_rt_f1
    v_fma_f32 v13, v113, v61, v13
    v_mfma_f32_16x16x32_bf16 v[40:43], a[40:43], v[84:87], v[40:43]
    buffer_load_dwordx4 v240, s[48:51], s71 offen offset:3072 sc1 lds
    v_mfma_f32_16x16x32_bf16 v[44:47], a[8:11], v[72:75], 0
    v_fma_f32 v16, v113, v64, v16
    v_fma_f32 v17, v113, v65, v17
    v_mfma_f32_16x16x32_bf16 v[44:47], a[20:23], v[76:79], v[44:47]
    s_add_u32 m0, s73, 86016
    v_fma_f32 v20, v113, v68, v20
    v_fma_f32 v21, v113, v69, v21
    v_mfma_f32_16x16x32_bf16 v[44:47], a[32:35], v[80:83], v[44:47]
    s_add_u32 s71, s70, 55296
    v_mul_f32 v6, v5, v5
    v_mul_f32 v5, 0xc0135761, v5
    v_mfma_f32_16x16x32_bf16 v[44:47], a[44:47], v[84:87], v[44:47]
    s_waitcnt lgkmcnt(0)
    v_mul_f32 v6, 0x3d372713, v6
    v_mul_f32 v120, v12, v12
    v_mfma_f32_16x16x32_bf16 v[36:39], a[48:51], v[88:91], v[36:39]
    ds_read2st64_b64 v[72:75], v243 offset0:96 offset1:97
    v_mul_f32 v121, v13, v13
    v_mul_f32 v122, v16, v16
    v_mfma_f32_16x16x32_bf16 v[36:39], a[60:63], v[92:95], v[36:39]
    buffer_load_dwordx4 v240, s[48:51], s71 offen offset:0 sc1 lds
    v_mfma_f32_16x16x32_bf16 v[36:39], a[72:75], v[96:99], v[36:39]
    ds_read2st64_b64 v[76:79], v243 offset0:98 offset1:99
    v_mul_f32 v123, v17, v17
    v_mul_f32 v124, v20, v20
    v_mfma_f32_16x16x32_bf16 v[36:39], a[84:87], v[100:103], v[36:39]
    v_mul_f32 v125, v21, v21
    v_mul_f32 v6, v6, v5
    v_mfma_f32_16x16x32_bf16 v[40:43], a[52:55], v[88:91], v[40:43]
    ds_read2st64_b64 v[80:83], v243 offset0:100 offset1:101
    v_fma_f32 v14, v113, v62, v14
    v_fma_f32 v15, v113, v63, v15
    v_mfma_f32_16x16x32_bf16 v[40:43], a[64:67], v[92:95], v[40:43]
    buffer_load_dwordx4 v[220:223], v240, s[48:51], s83 offen offset:3072 sc1
    v_mfma_f32_16x16x32_bf16 v[40:43], a[76:79], v[96:99], v[40:43]
    ds_read2st64_b64 v[84:87], v243 offset0:102 offset1:103
    v_fma_f32 v18, v113, v66, v18
    v_fma_f32 v19, v113, v67, v19
    v_mfma_f32_16x16x32_bf16 v[40:43], a[88:91], v[100:103], v[40:43]
    v_fma_f32 v22, v113, v70, v22
    v_fma_f32 v23, v113, v71, v23
    v_mfma_f32_16x16x32_bf16 v[44:47], a[56:59], v[88:91], v[44:47]
    v_fma_f32 v120, v120, v6, v5
    v_fma_f32 v121, v121, v6, v5
    v_mfma_f32_16x16x32_bf16 v[44:47], a[68:71], v[92:95], v[44:47]
    v_fma_f32 v122, v122, v6, v5
    v_fma_f32 v123, v123, v6, v5
    v_mfma_f32_16x16x32_bf16 v[44:47], a[80:83], v[96:99], v[44:47]
    s_add_u32 s83, s82, 24576
    v_fma_f32 v124, v124, v6, v5
    v_fma_f32 v125, v125, v6, v5
    v_mfma_f32_16x16x32_bf16 v[44:47], a[92:95], v[100:103], v[44:47]
    s_waitcnt lgkmcnt(0)
    v_mul_f32 v120, v120, v12
    v_mul_f32 v121, v121, v13
    v_mfma_f32_16x16x32_bf16 v[36:39], a[96:99], v[72:75], v[36:39]
    ds_read2st64_b64 v[88:91], v243 offset0:104 offset1:105
    v_mul_f32 v122, v122, v16
    v_mul_f32 v123, v123, v17
    v_mfma_f32_16x16x32_bf16 v[36:39], a[108:111], v[76:79], v[36:39]
    buffer_load_dwordx4 v[224:227], v240, s[48:51], s83 offen offset:0 sc1
    v_mfma_f32_16x16x32_bf16 v[36:39], a[120:123], v[80:83], v[36:39]
    ds_read2st64_b64 v[92:95], v243 offset0:106 offset1:107
    v_mul_f32 v124, v124, v20
    v_mul_f32 v125, v125, v21
    v_mfma_f32_16x16x32_bf16 v[36:39], a[132:135], v[84:87], v[36:39]
    buffer_load_dword v4, v247, s[48:51], 0 offen sc1
    v_mfma_f32_16x16x32_bf16 v[40:43], a[100:103], v[72:75], v[40:43]
    ds_read2st64_b64 v[96:99], v243 offset0:108 offset1:109
    v_exp_f32 v120, v120
    v_mfma_f32_16x16x32_bf16 v[40:43], a[112:115], v[76:79], v[40:43]
    buffer_load_dwordx4 v[228:231], v240, s[48:51], s83 offen offset:1024 sc1
    v_mfma_f32_16x16x32_bf16 v[40:43], a[124:127], v[80:83], v[40:43]
    ds_read2st64_b64 v[100:103], v243 offset0:110 offset1:111
    v_exp_f32 v121, v121
    v_mfma_f32_16x16x32_bf16 v[40:43], a[136:139], v[84:87], v[40:43]
    v_exp_f32 v122, v122
    v_mfma_f32_16x16x32_bf16 v[44:47], a[104:107], v[72:75], v[44:47]
    v_exp_f32 v123, v123
    v_mfma_f32_16x16x32_bf16 v[44:47], a[116:119], v[76:79], v[44:47]
    v_exp_f32 v124, v124
    v_mfma_f32_16x16x32_bf16 v[44:47], a[128:131], v[80:83], v[44:47]
    buffer_load_dwordx4 v[232:235], v240, s[48:51], s83 offen offset:2048 sc1
    v_mfma_f32_16x16x32_bf16 v[44:47], a[140:143], v[84:87], v[44:47]
    s_waitcnt lgkmcnt(0)
    v_exp_f32 v125, v125
    v_mfma_f32_16x16x32_bf16 v[36:39], a[144:147], v[88:91], v[36:39]
    ds_read2st64_b64 v[72:75], v243 offset0:112 offset1:113
    v_mul_f32 v12, v12, v14
    v_mul_f32 v13, v13, v15
    v_mfma_f32_16x16x32_bf16 v[36:39], a[156:159], v[92:95], v[36:39]
    v_mul_f32 v16, v16, v18
    v_mul_f32 v17, v17, v19
    v_mfma_f32_16x16x32_bf16 v[36:39], a[168:171], v[96:99], v[36:39]
    ds_read2st64_b64 v[76:79], v243 offset0:114 offset1:115
    v_mul_f32 v20, v20, v22
    v_mul_f32 v21, v21, v23
    v_mfma_f32_16x16x32_bf16 v[36:39], a[180:183], v[100:103], v[36:39]
    v_fma_f32 v120, v120, v7, v7
    v_fma_f32 v121, v121, v7, v7
    v_mfma_f32_16x16x32_bf16 v[40:43], a[148:151], v[88:91], v[40:43]
    ds_read2st64_b64 v[80:83], v243 offset0:116 offset1:117
    v_fma_f32 v122, v122, v7, v7
    v_fma_f32 v123, v123, v7, v7
    v_mfma_f32_16x16x32_bf16 v[40:43], a[160:163], v[92:95], v[40:43]
    buffer_load_dwordx4 v[236:239], v240, s[48:51], s83 offen offset:3072 sc1
    v_mfma_f32_16x16x32_bf16 v[40:43], a[172:175], v[96:99], v[40:43]
    ds_read2st64_b64 v[84:87], v243 offset0:118 offset1:119
    v_fma_f32 v124, v124, v7, v7
    v_fma_f32 v125, v125, v7, v7
    v_mfma_f32_16x16x32_bf16 v[40:43], a[184:187], v[100:103], v[40:43]
    s_add_u32 m0, s73, 102400
    v_rcp_f32 v120, v120
    v_mfma_f32_16x16x32_bf16 v[44:47], a[152:155], v[88:91], v[44:47]
    s_add_u32 s71, s70, 56320
    v_rcp_f32 v121, v121
    v_mfma_f32_16x16x32_bf16 v[44:47], a[164:167], v[92:95], v[44:47]
    v_rcp_f32 v122, v122
    v_mfma_f32_16x16x32_bf16 v[44:47], a[176:179], v[96:99], v[44:47]
    s_barrier
    v_rcp_f32 v123, v123
    v_mfma_f32_16x16x32_bf16 v[44:47], a[188:191], v[100:103], v[44:47]
    s_waitcnt lgkmcnt(0)
    v_rcp_f32 v124, v124
    v_mfma_f32_16x16x32_bf16 v[36:39], a[192:195], v[72:75], v[36:39]
    ds_read2st64_b64 v[88:91], v242 offset0:0 offset1:1
    v_rcp_f32 v125, v125
    v_mfma_f32_16x16x32_bf16 v[36:39], a[204:207], v[76:79], v[36:39]
    buffer_load_dwordx4 v240, s[48:51], s71 offen offset:0 sc1 lds
    v_mfma_f32_16x16x32_bf16 v[36:39], a[216:219], v[80:83], v[36:39]
    ds_read2st64_b64 v[92:95], v242 offset0:2 offset1:3
    v_mul_f32 v12, v12, v120
    v_mul_f32 v13, v13, v121
    v_mfma_f32_16x16x32_bf16 v[36:39], a[228:231], v[84:87], v[36:39]
    s_mov_b32 s75, 196608
    v_mul_f32 v16, v16, v122
    v_mul_f32 v17, v17, v123
    v_mfma_f32_16x16x32_bf16 v[40:43], a[196:199], v[72:75], v[40:43]
    ds_read2st64_b64 v[96:99], v242 offset0:4 offset1:5
    v_mul_f32 v20, v20, v124
    v_mul_f32 v21, v21, v125
    v_mfma_f32_16x16x32_bf16 v[40:43], a[208:211], v[76:79], v[40:43]
    buffer_load_dwordx4 v240, s[48:51], s71 offen offset:1024 sc1 lds
    v_cvt_pk_bf16_f32 v120, v12, v13
    v_mfma_f32_16x16x32_bf16 v[40:43], a[220:223], v[80:83], v[40:43]
    ds_read2st64_b64 v[100:103], v242 offset0:6 offset1:7
    v_cvt_pk_bf16_f32 v121, v16, v17
    v_cvt_pk_bf16_f32 v122, v20, v21
    v_cvt_pk_bf16_f32 v8, v12, v13
    v_mfma_f32_16x16x32_bf16 v[40:43], a[232:235], v[84:87], v[40:43]
    v_cvt_pk_bf16_f32 v9, v16, v17
    v_cvt_pk_bf16_f32 v10, v20, v21
    v_mov_b32 v2, 2
    v_mfma_f32_16x16x32_bf16 v[44:47], a[200:203], v[72:75], v[44:47]
    buffer_load_dwordx4 v240, s[48:51], s71 offen offset:2048 sc1 lds
    v_mul_f32 v7, v114, v114
    v_mfma_f32_16x16x32_bf16 v[44:47], a[212:215], v[76:79], v[44:47]
    v_permlane16_swap_b32 v120, v121
    v_fma_f32 v24, v115, v60, v24
    v_mfma_f32_16x16x32_bf16 v[44:47], a[224:227], v[80:83], v[44:47]
    v_permlane16_swap_b32 v122, v11
    v_fma_f32 v25, v115, v61, v25
    v_mfma_f32_16x16x32_bf16 v[44:47], a[236:239], v[84:87], v[44:47]
    s_waitcnt lgkmcnt(0)
    v_permlane32_swap_b32 v121, v11
    s_waitcnt vmcnt(11)
    v_mfma_f32_16x16x32_bf16 v[48:51], a[0:3], v[88:91], 0
    ds_read2st64_b64 v[72:75], v242 offset0:8 offset1:9
    buffer_store_dword v2, v246, s[48:51], 0 offen sc1
    v_mfma_f32_16x16x32_bf16 v[48:51], a[12:15], v[92:95], v[48:51]
    buffer_load_dwordx4 v240, s[48:51], s71 offen offset:3072 sc1 lds
    v_fma_f32 v28, v115, v64, v28
    v_mfma_f32_16x16x32_bf16 v[48:51], a[24:27], v[96:99], v[48:51]
    ds_read2st64_b64 v[76:79], v242 offset0:10 offset1:11
    buffer_store_dwordx4 v[8:11], v244, s[48:51], s75 offen sc1
    v_mfma_f32_16x16x32_bf16 v[48:51], a[36:39], v[100:103], v[48:51]
    s_add_u32 s71, s70, 60416
    v_rcp_f32 v5, v114
    v_mfma_f32_16x16x32_bf16 v[52:55], a[4:7], v[88:91], 0
    ds_read2st64_b64 v[80:83], v242 offset0:12 offset1:13
    v_fma_f32 v29, v115, v65, v29
    v_fma_f32 v32, v115, v68, v32
    v_mfma_f32_16x16x32_bf16 v[52:55], a[16:19], v[92:95], v[52:55]
    s_add_u32 m0, s73, 106496
    s_nop 0
    buffer_load_dwordx4 v240, s[48:51], s71 offen offset:0 sc1 lds
    v_mfma_f32_16x16x32_bf16 v[52:55], a[28:31], v[96:99], v[52:55]
    ds_read2st64_b64 v[84:87], v242 offset0:14 offset1:15
    v_fma_f32 v33, v115, v69, v33
    v_mul_f32 v6, v5, v5
    v_mfma_f32_16x16x32_bf16 v[52:55], a[40:43], v[100:103], v[52:55]
    s_waitcnt vmcnt(10)
    v_cmp_gt_u32 vcc, 1, v4
    v_mul_f32 v5, 0xc0135761, v5
    v_mfma_f32_16x16x32_bf16 v[56:59], a[8:11], v[88:91], 0
    s_cbranch_vccnz L_chk31_slow
L_chk31:
    v_mul_f32 v6, 0x3d372713, v6
    v_mul_f32 v120, v24, v24
    v_mfma_f32_16x16x32_bf16 v[56:59], a[20:23], v[92:95], v[56:59]
    v_mul_f32 v121, v25, v25
    v_mul_f32 v122, v28, v28
    v_mfma_f32_16x16x32_bf16 v[56:59], a[32:35], v[96:99], v[56:59]
    s_add_u32 s77, s76, 0
    v_mul_f32 v123, v29, v29
    v_mul_f32 v124, v32, v32
    v_mfma_f32_16x16x32_bf16 v[56:59], a[44:47], v[100:103], v[56:59]
    s_waitcnt lgkmcnt(0)
    v_mul_f32 v125, v33, v33
    v_mul_f32 v6, v6, v5
    v_mfma_f32_16x16x32_bf16 v[48:51], a[48:51], v[72:75], v[48:51]
    ds_read2st64_b64 v[88:91], v242 offset0:16 offset1:17
    v_fma_f32 v26, v115, v62, v26
    v_fma_f32 v27, v115, v63, v27
    v_mfma_f32_16x16x32_bf16 v[48:51], a[60:63], v[76:79], v[48:51]
    buffer_load_dwordx4 a[0:3], v240, s[48:51], s77 offen offset:0 sc1
    v_mfma_f32_16x16x32_bf16 v[48:51], a[72:75], v[80:83], v[48:51]
    ds_read2st64_b64 v[92:95], v242 offset0:18 offset1:19
    v_fma_f32 v30, v115, v66, v30
    v_fma_f32 v31, v115, v67, v31
    v_mfma_f32_16x16x32_bf16 v[48:51], a[84:87], v[84:87], v[48:51]
    v_fma_f32 v34, v115, v70, v34
    v_fma_f32 v35, v115, v71, v35
    v_mfma_f32_16x16x32_bf16 v[52:55], a[52:55], v[72:75], v[52:55]
    ds_read2st64_b64 v[96:99], v242 offset0:20 offset1:21
    v_fma_f32 v120, v120, v6, v5
    v_fma_f32 v121, v121, v6, v5
    v_mfma_f32_16x16x32_bf16 v[52:55], a[64:67], v[76:79], v[52:55]
    buffer_load_dwordx4 a[4:7], v240, s[48:51], s77 offen offset:1024 sc1
    v_mfma_f32_16x16x32_bf16 v[52:55], a[76:79], v[80:83], v[52:55]
    ds_read2st64_b64 v[100:103], v242 offset0:22 offset1:23
    v_fma_f32 v122, v122, v6, v5
    v_fma_f32 v123, v123, v6, v5
    v_mfma_f32_16x16x32_bf16 v[52:55], a[88:91], v[84:87], v[52:55]
    v_fma_f32 v124, v124, v6, v5
    v_fma_f32 v125, v125, v6, v5
    v_mfma_f32_16x16x32_bf16 v[56:59], a[56:59], v[72:75], v[56:59]
    buffer_load_dwordx4 a[8:11], v240, s[48:51], s77 offen offset:2048 sc1
    v_mfma_f32_16x16x32_bf16 v[56:59], a[68:71], v[76:79], v[56:59]
    v_mul_f32 v120, v120, v24
    v_mul_f32 v121, v121, v25
    v_mfma_f32_16x16x32_bf16 v[56:59], a[80:83], v[80:83], v[56:59]
    v_mul_f32 v122, v122, v28
    v_mul_f32 v123, v123, v29
    v_mfma_f32_16x16x32_bf16 v[56:59], a[92:95], v[84:87], v[56:59]
    s_waitcnt lgkmcnt(0)
    v_mul_f32 v124, v124, v32
    v_mul_f32 v125, v125, v33
    v_mfma_f32_16x16x32_bf16 v[48:51], a[96:99], v[88:91], v[48:51]
    ds_read2st64_b64 v[72:75], v242 offset0:24 offset1:25
    v_exp_f32 v120, v120
    v_mfma_f32_16x16x32_bf16 v[48:51], a[108:111], v[92:95], v[48:51]
    buffer_load_dwordx4 a[12:15], v240, s[48:51], s77 offen offset:3072 sc1
    v_mfma_f32_16x16x32_bf16 v[48:51], a[120:123], v[96:99], v[48:51]
    ds_read2st64_b64 v[76:79], v242 offset0:26 offset1:27
    v_exp_f32 v121, v121
    v_mfma_f32_16x16x32_bf16 v[48:51], a[132:135], v[100:103], v[48:51]
    s_add_u32 s77, s76, 4096
    v_exp_f32 v122, v122
    v_mfma_f32_16x16x32_bf16 v[52:55], a[100:103], v[88:91], v[52:55]
    ds_read2st64_b64 v[80:83], v242 offset0:28 offset1:29
    v_exp_f32 v123, v123
    v_mfma_f32_16x16x32_bf16 v[52:55], a[112:115], v[92:95], v[52:55]
    buffer_load_dwordx4 a[16:19], v240, s[48:51], s77 offen offset:0 sc1
    v_mfma_f32_16x16x32_bf16 v[52:55], a[124:127], v[96:99], v[52:55]
    ds_read2st64_b64 v[84:87], v242 offset0:30 offset1:31
    v_exp_f32 v124, v124
    v_mfma_f32_16x16x32_bf16 v[52:55], a[136:139], v[100:103], v[52:55]
    v_exp_f32 v125, v125
    v_mfma_f32_16x16x32_bf16 v[56:59], a[104:107], v[88:91], v[56:59]
    buffer_load_dwordx4 a[20:23], v240, s[48:51], s77 offen offset:1024 sc1
    v_mfma_f32_16x16x32_bf16 v[56:59], a[116:119], v[92:95], v[56:59]
    v_mul_f32 v24, v24, v26
    v_mul_f32 v25, v25, v27
    v_mfma_f32_16x16x32_bf16 v[56:59], a[128:131], v[96:99], v[56:59]
    v_mul_f32 v28, v28, v30
    v_mul_f32 v29, v29, v31
    v_mfma_f32_16x16x32_bf16 v[56:59], a[140:143], v[100:103], v[56:59]
    s_waitcnt lgkmcnt(0)
    v_mul_f32 v32, v32, v34
    v_mul_f32 v33, v33, v35
    v_mfma_f32_16x16x32_bf16 v[48:51], a[144:147], v[72:75], v[48:51]
    ds_read2st64_b64 v[88:91], v242 offset0:32 offset1:33
    v_fma_f32 v120, v120, v7, v7
    v_fma_f32 v121, v121, v7, v7
    v_mfma_f32_16x16x32_bf16 v[48:51], a[156:159], v[76:79], v[48:51]
    buffer_load_dwordx4 a[24:27], v240, s[48:51], s77 offen offset:2048 sc1
    v_mfma_f32_16x16x32_bf16 v[48:51], a[168:171], v[80:83], v[48:51]
    ds_read2st64_b64 v[92:95], v242 offset0:34 offset1:35
    v_fma_f32 v122, v122, v7, v7
    v_fma_f32 v123, v123, v7, v7
    v_mfma_f32_16x16x32_bf16 v[48:51], a[180:183], v[84:87], v[48:51]
    s_mov_b32 s75, 245760
    v_fma_f32 v124, v124, v7, v7
    v_fma_f32 v125, v125, v7, v7
    v_mfma_f32_16x16x32_bf16 v[52:55], a[148:151], v[72:75], v[52:55]
    ds_read2st64_b64 v[96:99], v242 offset0:36 offset1:37
    v_rcp_f32 v120, v120
    v_mfma_f32_16x16x32_bf16 v[52:55], a[160:163], v[76:79], v[52:55]
    buffer_load_dwordx4 a[28:31], v240, s[48:51], s77 offen offset:3072 sc1
    v_mfma_f32_16x16x32_bf16 v[52:55], a[172:175], v[80:83], v[52:55]
    ds_read2st64_b64 v[100:103], v242 offset0:38 offset1:39
    v_rcp_f32 v121, v121
    v_mfma_f32_16x16x32_bf16 v[52:55], a[184:187], v[84:87], v[52:55]
    s_add_u32 s77, s76, 8192
    v_rcp_f32 v122, v122
    v_mfma_f32_16x16x32_bf16 v[56:59], a[152:155], v[72:75], v[56:59]
    buffer_load_dwordx4 a[32:35], v240, s[48:51], s77 offen offset:0 sc1
    v_mfma_f32_16x16x32_bf16 v[56:59], a[164:167], v[76:79], v[56:59]
    v_rcp_f32 v123, v123
    v_mfma_f32_16x16x32_bf16 v[56:59], a[176:179], v[80:83], v[56:59]
    v_rcp_f32 v124, v124
    v_mfma_f32_16x16x32_bf16 v[56:59], a[188:191], v[84:87], v[56:59]
    s_waitcnt lgkmcnt(0)
    v_rcp_f32 v125, v125
    v_mfma_f32_16x16x32_bf16 v[48:51], a[192:195], v[88:91], v[48:51]
    buffer_load_dwordx4 a[36:39], v240, s[48:51], s77 offen offset:1024 sc1
    v_mfma_f32_16x16x32_bf16 v[48:51], a[204:207], v[92:95], v[48:51]
    v_mul_f32 v24, v24, v120
    v_mul_f32 v25, v25, v121
    v_mfma_f32_16x16x32_bf16 v[48:51], a[216:219], v[96:99], v[48:51]
    buffer_load_dword v4, v247, s[48:51], 0 offen sc1
    v_mfma_f32_16x16x32_bf16 v[48:51], a[228:231], v[100:103], v[48:51]
    v_mul_f32 v28, v28, v122
    v_mul_f32 v29, v29, v123
    v_mfma_f32_16x16x32_bf16 v[52:55], a[196:199], v[88:91], v[52:55]
    buffer_load_dwordx4 a[40:43], v240, s[48:51], s77 offen offset:2048 sc1
    v_mfma_f32_16x16x32_bf16 v[52:55], a[208:211], v[92:95], v[52:55]
    v_mul_f32 v32, v32, v124
    v_mul_f32 v33, v33, v125
    v_cvt_pk_bf16_f32 v120, v24, v25
    v_mfma_f32_16x16x32_bf16 v[52:55], a[220:223], v[96:99], v[52:55]
    v_cvt_pk_bf16_f32 v121, v28, v29
    v_cvt_pk_bf16_f32 v122, v32, v33
    v_cvt_pk_bf16_f32 v8, v24, v25
    v_mfma_f32_16x16x32_bf16 v[52:55], a[232:235], v[100:103], v[52:55]
    v_cvt_pk_bf16_f32 v9, v28, v29
    v_cvt_pk_bf16_f32 v10, v32, v33
    v_mfma_f32_16x16x32_bf16 v[56:59], a[200:203], v[88:91], v[56:59]
    buffer_load_dwordx4 a[44:47], v240, s[48:51], s77 offen offset:3072 sc1
    v_mfma_f32_16x16x32_bf16 v[56:59], a[212:215], v[92:95], v[56:59]
    v_permlane16_swap_b32 v120, v121
    v_mfma_f32_16x16x32_bf16 v[56:59], a[224:227], v[96:99], v[56:59]
    v_permlane16_swap_b32 v122, v11
    v_mfma_f32_16x16x32_bf16 v[56:59], a[236:239], v[100:103], v[56:59]
    s_nop 0
    v_permlane32_swap_b32 v121, v11
    buffer_store_dwordx4 v[8:11], v244, s[48:51], s75 offen sc1
    v_rcp_f32 v72, v116
    v_mul_f32 v74, v116, v116
    v_rcp_f32 v88, v118
    v_mul_f32 v90, v118, v118
    v_pk_fma_f32 v[36:37], v[116:117], v[60:61], v[36:37] op_sel:[1,0,0] op_sel_hi:[1,1,1]
    v_pk_fma_f32 v[48:49], v[118:119], v[60:61], v[48:49] op_sel:[1,0,0] op_sel_hi:[1,1,1]
    v_pk_fma_f32 v[40:41], v[116:117], v[64:65], v[40:41] op_sel:[1,0,0] op_sel_hi:[1,1,1]
    v_pk_fma_f32 v[52:53], v[118:119], v[64:65], v[52:53] op_sel:[1,0,0] op_sel_hi:[1,1,1]
    v_pk_fma_f32 v[44:45], v[116:117], v[68:69], v[44:45] op_sel:[1,0,0] op_sel_hi:[1,1,1]
    v_pk_fma_f32 v[56:57], v[118:119], v[68:69], v[56:57] op_sel:[1,0,0] op_sel_hi:[1,1,1]
    v_mul_f32 v73, v72, v72
    v_mul_f32 v72, 0xc0135761, v72
    v_mul_f32 v89, v88, v88
    v_mul_f32 v88, 0xc0135761, v88
    v_mul_f32 v73, 0x3d372713, v73
    v_mul_f32 v89, 0x3d372713, v89
    v_pk_mul_f32 v[76:77], v[36:37], v[36:37]
    v_pk_mul_f32 v[92:93], v[48:49], v[48:49]
    v_pk_mul_f32 v[78:79], v[40:41], v[40:41]
    v_pk_mul_f32 v[94:95], v[52:53], v[52:53]
    v_pk_mul_f32 v[80:81], v[44:45], v[44:45]
    v_pk_mul_f32 v[96:97], v[56:57], v[56:57]
    v_mul_f32 v73, v73, v72
    v_mul_f32 v89, v89, v88
    v_pk_fma_f32 v[76:77], v[76:77], v[72:73], v[72:73] op_sel:[0,1,0] op_sel_hi:[1,1,0]
    v_pk_fma_f32 v[92:93], v[92:93], v[88:89], v[88:89] op_sel:[0,1,0] op_sel_hi:[1,1,0]
    v_pk_fma_f32 v[78:79], v[78:79], v[72:73], v[72:73] op_sel:[0,1,0] op_sel_hi:[1,1,0]
    v_pk_fma_f32 v[94:95], v[94:95], v[88:89], v[88:89] op_sel:[0,1,0] op_sel_hi:[1,1,0]
    v_pk_fma_f32 v[80:81], v[80:81], v[72:73], v[72:73] op_sel:[0,1,0] op_sel_hi:[1,1,0]
    v_pk_fma_f32 v[96:97], v[96:97], v[88:89], v[88:89] op_sel:[0,1,0] op_sel_hi:[1,1,0]
    v_pk_mul_f32 v[76:77], v[76:77], v[36:37]
    v_pk_mul_f32 v[92:93], v[92:93], v[48:49]
    v_pk_mul_f32 v[78:79], v[78:79], v[40:41]
    v_pk_mul_f32 v[94:95], v[94:95], v[52:53]
    v_pk_mul_f32 v[80:81], v[80:81], v[44:45]
    v_pk_mul_f32 v[96:97], v[96:97], v[56:57]
    v_exp_f32 v76, v76
    v_exp_f32 v92, v92
    v_exp_f32 v77, v77
    v_exp_f32 v93, v93
    v_exp_f32 v78, v78
    v_exp_f32 v94, v94
    v_exp_f32 v79, v79
    v_exp_f32 v95, v95
    v_exp_f32 v80, v80
    v_exp_f32 v96, v96
    v_exp_f32 v81, v81
    v_exp_f32 v97, v97
    v_pk_fma_f32 v[38:39], v[116:117], v[62:63], v[38:39] op_sel:[1,0,0] op_sel_hi:[1,1,1]
    v_pk_fma_f32 v[50:51], v[118:119], v[62:63], v[50:51] op_sel:[1,0,0] op_sel_hi:[1,1,1]
    v_pk_fma_f32 v[42:43], v[116:117], v[66:67], v[42:43] op_sel:[1,0,0] op_sel_hi:[1,1,1]
    v_pk_fma_f32 v[54:55], v[118:119], v[66:67], v[54:55] op_sel:[1,0,0] op_sel_hi:[1,1,1]
    v_pk_fma_f32 v[46:47], v[116:117], v[70:71], v[46:47] op_sel:[1,0,0] op_sel_hi:[1,1,1]
    v_pk_fma_f32 v[58:59], v[118:119], v[70:71], v[58:59] op_sel:[1,0,0] op_sel_hi:[1,1,1]
    v_pk_fma_f32 v[76:77], v[76:77], v[74:75], v[74:75] op_sel:[0,0,0] op_sel_hi:[1,0,0]
    v_pk_fma_f32 v[92:93], v[92:93], v[90:91], v[90:91] op_sel:[0,0,0] op_sel_hi:[1,0,0]
    v_pk_fma_f32 v[78:79], v[78:79], v[74:75], v[74:75] op_sel:[0,0,0] op_sel_hi:[1,0,0]
    v_pk_fma_f32 v[94:95], v[94:95], v[90:91], v[90:91] op_sel:[0,0,0] op_sel_hi:[1,0,0]
    v_pk_fma_f32 v[80:81], v[80:81], v[74:75], v[74:75] op_sel:[0,0,0] op_sel_hi:[1,0,0]
    v_pk_fma_f32 v[96:97], v[96:97], v[90:91], v[90:91] op_sel:[0,0,0] op_sel_hi:[1,0,0]
    v_rcp_f32 v76, v76
    v_rcp_f32 v92, v92
    v_rcp_f32 v77, v77
    v_rcp_f32 v93, v93
    v_rcp_f32 v78, v78
    v_rcp_f32 v94, v94
    v_rcp_f32 v79, v79
    v_rcp_f32 v95, v95
    v_rcp_f32 v80, v80
    v_rcp_f32 v96, v96
    v_rcp_f32 v81, v81
    v_rcp_f32 v97, v97
    v_pk_mul_f32 v[36:37], v[36:37], v[38:39]
    v_pk_mul_f32 v[48:49], v[48:49], v[50:51]
    v_pk_mul_f32 v[40:41], v[40:41], v[42:43]
    v_pk_mul_f32 v[52:53], v[52:53], v[54:55]
    v_pk_mul_f32 v[44:45], v[44:45], v[46:47]
    v_pk_mul_f32 v[56:57], v[56:57], v[58:59]
    v_pk_mul_f32 v[36:37], v[36:37], v[76:77]
    v_pk_mul_f32 v[48:49], v[48:49], v[92:93]
    v_pk_mul_f32 v[40:41], v[40:41], v[78:79]
    v_pk_mul_f32 v[52:53], v[52:53], v[94:95]
    v_pk_mul_f32 v[44:45], v[44:45], v[80:81]
    v_pk_mul_f32 v[56:57], v[56:57], v[96:97]
    v_cvt_pk_bf16_f32 v76, v36, v37
    v_cvt_pk_bf16_f32 v92, v48, v49
    v_cvt_pk_bf16_f32 v77, v40, v41
    v_cvt_pk_bf16_f32 v93, v52, v53
    v_cvt_pk_bf16_f32 v78, v44, v45
    v_cvt_pk_bf16_f32 v94, v56, v57
    v_cvt_pk_bf16_f32 v84, v36, v37
    v_cvt_pk_bf16_f32 v100, v48, v49
    v_cvt_pk_bf16_f32 v85, v40, v41
    v_cvt_pk_bf16_f32 v101, v52, v53
    v_cvt_pk_bf16_f32 v86, v44, v45
    v_cvt_pk_bf16_f32 v102, v56, v57
    v_permlane16_swap_b32 v76, v77
    v_permlane16_swap_b32 v78, v87
    v_permlane16_swap_b32 v92, v93
    v_permlane16_swap_b32 v94, v103
    v_permlane32_swap_b32 v77, v87
    s_nop 0
    v_permlane32_swap_b32 v93, v103
    s_mov_b32 s75, 294912
    buffer_store_dwordx4 v[84:87], v244, s[48:51], s75 offen sc1
    s_mov_b32 s75, 344064
    buffer_store_dwordx4 v[100:103], v244, s[48:51], s75 offen sc1
    s_waitcnt vmcnt(5)
    v_cmp_gt_u32 vcc, 2, v4
    s_nop 1
    s_cbranch_vccnz L_chk33_slow
L_chk33:
    v_mfma_f32_16x16x32_bf16 v[12:15], v[128:131], a[0:3], 0
    s_add_u32 s77, s76, 98304
    buffer_load_dwordx4 a[160:163], v240, s[48:51], s77 offen offset:0 sc1
    v_mfma_f32_16x16x32_bf16 v[12:15], v[132:135], a[4:7], v[12:15]
    ds_read_b128 a[48:51], v250 offset:0
    ds_read_b128 a[52:55], v250 offset:1024
    s_mul_i32 s4, s3, 5760
    v_mfma_f32_16x16x32_bf16 v[12:15], v[136:139], a[8:11], v[12:15]
    ds_read_b128 a[56:59], v250 offset:2048
    s_add_u32 s4, s4, 20480
    v_lshrrev_b32 v104, 4, v0
    v_mfma_f32_16x16x32_bf16 v[16:19], v[140:143], a[0:3], 0
    ds_read_b128 a[60:63], v248 offset:0
    v_mul_u32_u24 v104, 288, v104
    v_and_b32 v105, 15, v0
    v_mfma_f32_16x16x32_bf16 v[16:19], v[144:147], a[4:7], v[16:19]
    s_waitcnt vmcnt(3)
    v_mov_b32 v2, 3
    buffer_store_dword v2, v246, s[48:51], 0 offen sc1
    buffer_load_dwordx4 a[164:167], v240, s[48:51], s77 offen offset:1024 sc1
    v_mfma_f32_16x16x32_bf16 v[16:19], v[148:151], a[8:11], v[16:19]
    ds_read_b128 a[64:67], v248 offset:1024
    v_lshl_add_u32 v104, v105, 4, v104
    v_and_b32 v105, 3, v0
    v_mfma_f32_16x16x32_bf16 v[20:23], v[152:155], a[0:3], 0
    ds_read_b128 a[68:71], v248 offset:2048
    v_add_u32 v124, s4, v104
    v_lshrrev_b32 v104, 2, v0
    v_mfma_f32_16x16x32_bf16 v[20:23], v[156:159], a[4:7], v[20:23]
    ds_read_b128 a[72:75], v248 offset:3072
    v_min_u32 v104, 9, v104
    s_lshl_b32 s4, s3, 2
    v_mfma_f32_16x16x32_bf16 v[20:23], v[160:163], a[8:11], v[20:23]
    buffer_load_dwordx4 a[168:171], v240, s[48:51], s77 offen offset:2048 sc1
    v_mfma_f32_16x16x32_bf16 v[24:27], v[164:167], a[0:3], 0
    ds_read_b128 a[76:79], v248 offset:4096
    v_add_u32 v105, s4, v105
    v_mul_u32_u24 v106, 576, v104
    v_mfma_f32_16x16x32_bf16 v[24:27], v[168:171], a[4:7], v[24:27]
    ds_read_b128 a[80:83], v248 offset:20480
    v_lshl_add_u32 v106, v105, 4, v106
    s_lshl_b32 s4, s64, 3
    v_mfma_f32_16x16x32_bf16 v[24:27], v[172:175], a[8:11], v[24:27]
    ds_read_b128 a[84:87], v248 offset:21504
    v_add_u32 v125, 20480, v106
    s_add_u32 s4, s4, s66
    v_mfma_f32_16x16x32_bf16 v[28:31], v[176:179], a[0:3], 0
    buffer_load_dwordx4 a[172:175], v240, s[48:51], s77 offen offset:3072 sc1
    v_mfma_f32_16x16x32_bf16 v[28:31], v[180:183], a[4:7], v[28:31]
    ds_read_b128 a[88:91], v248 offset:22528
    ds_read_b128 a[92:95], v248 offset:23552
    s_mul_i32 s6, s4, 20480
    v_mfma_f32_16x16x32_bf16 v[28:31], v[184:187], a[8:11], v[28:31]
    ds_read_b128 a[96:99], v248 offset:24576
    s_mul_i32 s5, s67, 10
    v_add_u32 v106, s5, v104
    v_mfma_f32_16x16x32_bf16 v[12:15], v[188:191], a[12:15], v[12:15]
    ds_read_b128 a[100:103], v248 offset:40960
    v_and_b32 v107, -4, v106
    s_add_u32 s5, s6, 6946816
    v_mfma_f32_16x16x32_bf16 v[12:15], v[192:195], a[16:19], v[12:15]
    s_add_u32 s77, s76, 102400
    buffer_load_dwordx4 a[176:179], v240, s[48:51], s77 offen offset:0 sc1
    v_mfma_f32_16x16x32_bf16 v[12:15], v[196:199], a[20:23], v[12:15]
    ds_read_b128 a[104:107], v248 offset:41984
    v_add_lshl_u32 v106, v106, v107, 7
    v_mov_b32 v107, 2147483632
    v_mfma_f32_16x16x32_bf16 v[16:19], v[200:203], a[12:15], v[16:19]
    ds_read_b128 a[108:111], v248 offset:43008
    v_lshl_add_u32 v106, v105, 3, v106
    v_cmp_gt_u32 s[8:9], 40, v0
    v_mfma_f32_16x16x32_bf16 v[16:19], v[204:207], a[16:19], v[16:19]
    ds_read_b128 a[112:115], v248 offset:44032
    v_add_u32 v126, s5, v106
    s_mul_i32 s5, s67, 160
    v_mfma_f32_16x16x32_bf16 v[16:19], v[208:211], a[20:23], v[16:19]
    buffer_load_dwordx4 a[180:183], v240, s[48:51], s77 offen offset:1024 sc1
    v_mfma_f32_16x16x32_bf16 v[20:23], v[212:215], a[12:15], v[20:23]
    ds_read_b128 a[116:119], v248 offset:45056
    s_add_u32 s5, s5, s6
    v_and_b32 v106, 1, v105
    v_mfma_f32_16x16x32_bf16 v[20:23], v[216:219], a[16:19], v[20:23]
    ds_read_b128 a[120:123], v249 offset:0
    v_mad_u32_u24 v105, v106, 31, v105
    v_mfma_f32_16x16x32_bf16 v[20:23], v[220:223], a[20:23], v[20:23]
    ds_read_b128 a[124:127], v249 offset:1024
    v_mul_u32_u24 v106, 1280, v105
    v_mfma_f32_16x16x32_bf16 v[24:27], v[224:227], a[12:15], v[24:27]
    buffer_load_dwordx4 a[184:187], v240, s[48:51], s77 offen offset:2048 sc1
    v_mfma_f32_16x16x32_bf16 v[24:27], v[228:231], a[16:19], v[24:27]
    ds_read_b128 a[128:131], v249 offset:2048
    ds_read_b128 a[132:135], v249 offset:3072
    v_lshl_add_u32 v106, v104, 4, v106
    v_mfma_f32_16x16x32_bf16 v[24:27], v[232:235], a[20:23], v[24:27]
    ds_read_b128 a[136:139], v249 offset:4096
    v_add_u32 v106, s5, v106
    v_mfma_f32_16x16x32_bf16 v[28:31], v[236:239], a[12:15], v[28:31]
    ds_read_b128 a[140:143], v249 offset:20480
    v_cndmask_b32 v127, v107, v106, s[8:9]
    v_mfma_f32_16x16x32_bf16 v[28:31], a[240:243], a[16:19], v[28:31]
    buffer_load_dwordx4 a[188:191], v240, s[48:51], s77 offen offset:3072 sc1
    v_mfma_f32_16x16x32_bf16 v[28:31], a[244:247], a[20:23], v[28:31]
    ds_read_b128 a[144:147], v249 offset:21504
    v_mfma_f32_16x16x32_bf16 v[12:15], a[248:251], a[24:27], v[12:15]
    ds_read_b128 a[148:151], v249 offset:22528
    v_mfma_f32_16x16x32_bf16 v[12:15], a[252:255], a[28:31], v[12:15]
    ds_read_b128 a[152:155], v249 offset:23552
    s_waitcnt lgkmcnt(15)
    v_mfma_f32_16x16x32_bf16 v[12:15], a[48:51], a[32:35], v[12:15]
    s_add_u32 s77, s76, 106496
    buffer_load_dwordx4 a[192:195], v240, s[48:51], s77 offen offset:0 sc1
    v_mfma_f32_16x16x32_bf16 v[16:19], a[52:55], a[24:27], v[16:19]
    ds_read_b128 a[156:159], v249 offset:24576
    v_mfma_f32_16x16x32_bf16 v[16:19], a[56:59], a[28:31], v[16:19]
    v_mfma_f32_16x16x32_bf16 v[16:19], a[60:63], a[32:35], v[16:19]
    v_mfma_f32_16x16x32_bf16 v[20:23], a[64:67], a[24:27], v[20:23]
    buffer_load_dwordx4 a[196:199], v240, s[48:51], s77 offen offset:1024 sc1
    v_mfma_f32_16x16x32_bf16 v[20:23], a[68:71], a[28:31], v[20:23]
    s_waitcnt lgkmcnt(0)
    v_mfma_f32_16x16x32_bf16 v[20:23], a[72:75], a[32:35], v[20:23]
    s_waitcnt vmcnt(11)
    v_mov_b32 v2, 4
    buffer_store_dword v2, v246, s[48:51], s10 offen sc1
    v_mfma_f32_16x16x32_bf16 v[24:27], a[76:79], a[24:27], v[24:27]
    s_barrier
    v_mfma_f32_16x16x32_bf16 v[24:27], a[80:83], a[28:31], v[24:27]
    buffer_load_dwordx4 a[200:203], v240, s[48:51], s77 offen offset:2048 sc1
    v_mfma_f32_16x16x32_bf16 v[24:27], a[84:87], a[32:35], v[24:27]
    v_mfma_f32_16x16x32_bf16 v[28:31], a[88:91], a[24:27], v[28:31]
    v_mfma_f32_16x16x32_bf16 v[28:31], a[92:95], a[28:31], v[28:31]
    v_mfma_f32_16x16x32_bf16 v[28:31], a[96:99], a[32:35], v[28:31]
    buffer_load_dwordx4 a[204:207], v240, s[48:51], s77 offen offset:3072 sc1
    v_mfma_f32_16x16x32_bf16 v[12:15], a[100:103], a[36:39], v[12:15]
    v_mfma_f32_16x16x32_bf16 v[12:15], a[104:107], a[40:43], v[12:15]
    buffer_load_dword v4, v247, s[48:51], 0 offen sc1
L_pg_f2:
    s_cbranch_execz L_rt_f2
    v_mfma_f32_16x16x32_bf16 v[12:15], a[108:111], a[44:47], v[12:15]
    v_mfma_f32_16x16x32_bf16 v[16:19], a[112:115], a[36:39], v[16:19]
    v_mfma_f32_16x16x32_bf16 v[16:19], a[116:119], a[40:43], v[16:19]
    v_mfma_f32_16x16x32_bf16 v[16:19], a[120:123], a[44:47], v[16:19]
    v_mfma_f32_16x16x32_bf16 v[20:23], a[124:127], a[36:39], v[20:23]
    s_mov_b32 s88, 0
    v_mfma_f32_16x16x32_bf16 v[20:23], a[128:131], a[40:43], v[20:23]
    buffer_load_dwordx2 v[84:85], v126, s[48:51], s88 offen offset:0 sc1
    v_mfma_f32_16x16x32_bf16 v[20:23], a[132:135], a[44:47], v[20:23]
    v_mfma_f32_16x16x32_bf16 v[24:27], a[136:139], a[36:39], v[24:27]
    v_mfma_f32_16x16x32_bf16 v[24:27], a[140:143], a[40:43], v[24:27]
    v_mfma_f32_16x16x32_bf16 v[24:27], a[144:147], a[44:47], v[24:27]
    v_mfma_f32_16x16x32_bf16 v[28:31], a[148:151], a[36:39], v[28:31]
    buffer_load_dwordx2 v[86:87], v126, s[48:51], s88 offen offset:512 sc1
    v_mfma_f32_16x16x32_bf16 v[28:31], a[152:155], a[40:43], v[28:31]
    v_mfma_f32_16x16x32_bf16 v[28:31], a[156:159], a[44:47], v[28:31]
    s_waitcnt vmcnt(16)
    v_mfma_f32_16x16x32_bf16 v[32:35], v[128:131], a[160:163], 0
    s_waitcnt vmcnt(14)
    v_mfma_f32_16x16x32_bf16 v[32:35], v[132:135], a[164:167], v[32:35]
    ds_write_b128 v124, v[12:15] offset:0
    s_waitcnt vmcnt(13)
    v_mfma_f32_16x16x32_bf16 v[32:35], v[136:139], a[168:171], v[32:35]
    s_mov_b32 s88, 40960
    v_mfma_f32_16x16x32_bf16 v[36:39], v[140:143], a[160:163], 0
    buffer_load_dwordx2 v[88:89], v126, s[48:51], s88 offen offset:0 sc1
    v_mfma_f32_16x16x32_bf16 v[36:39], v[144:147], a[164:167], v[36:39]
    v_mfma_f32_16x16x32_bf16 v[36:39], v[148:151], a[168:171], v[36:39]
    ds_write_b128 v124, v[16:19] offset:1152
    v_mfma_f32_16x16x32_bf16 v[40:43], v[152:155], a[160:163], 0
    v_mfma_f32_16x16x32_bf16 v[40:43], v[156:159], a[164:167], v[40:43]
    v_mfma_f32_16x16x32_bf16 v[40:43], v[160:163], a[168:171], v[40:43]
    buffer_load_dwordx2 v[90:91], v126, s[48:51], s88 offen offset:512 sc1
    v_mfma_f32_16x16x32_bf16 v[44:47], v[164:167], a[160:163], 0
    ds_write_b128 v124, v[20:23] offset:2304
    v_mfma_f32_16x16x32_bf16 v[44:47], v[168:171], a[164:167], v[44:47]
    v_mfma_f32_16x16x32_bf16 v[44:47], v[172:175], a[168:171], v[44:47]
    v_mfma_f32_16x16x32_bf16 v[48:51], v[176:179], a[160:163], 0
    s_add_u32 s77, s76, 196608
    v_mfma_f32_16x16x32_bf16 v[48:51], v[180:183], a[164:167], v[48:51]
    ds_write_b128 v124, v[24:27] offset:3456
    s_waitcnt vmcnt(4)
    v_cmp_gt_u32 vcc, 3, v4
    v_mfma_f32_16x16x32_bf16 v[48:51], v[184:187], a[168:171], v[48:51]
    s_cbranch_vccnz L_chk35_slow
L_chk35:
    v_mfma_f32_16x16x32_bf16 v[32:35], v[188:191], a[172:175], v[32:35]
    buffer_load_dwordx4 a[208:211], v240, s[48:51], s77 offen offset:0 sc1
    v_mfma_f32_16x16x32_bf16 v[32:35], v[192:195], a[176:179], v[32:35]
    v_mfma_f32_16x16x32_bf16 v[32:35], v[196:199], a[180:183], v[32:35]
    ds_write_b128 v124, v[28:31] offset:4608
    v_mfma_f32_16x16x32_bf16 v[36:39], v[200:203], a[172:175], v[36:39]
    v_mfma_f32_16x16x32_bf16 v[36:39], v[204:207], a[176:179], v[36:39]
    buffer_load_dwordx4 a[212:215], v240, s[48:51], s77 offen offset:1024 sc1
    v_mfma_f32_16x16x32_bf16 v[36:39], v[208:211], a[180:183], v[36:39]
    v_mfma_f32_16x16x32_bf16 v[40:43], v[212:215], a[172:175], v[40:43]
    s_waitcnt lgkmcnt(0)
    v_mfma_f32_16x16x32_bf16 v[40:43], v[216:219], a[176:179], v[40:43]
    s_barrier
    v_mfma_f32_16x16x32_bf16 v[40:43], v[220:223], a[180:183], v[40:43]
    buffer_load_dwordx4 a[216:219], v240, s[48:51], s77 offen offset:2048 sc1
    v_mfma_f32_16x16x32_bf16 v[44:47], v[224:227], a[172:175], v[44:47]
    ds_read_b128 v[52:55], v125 offset:0
    ds_read_b128 v[56:59], v125 offset:288
    v_mfma_f32_16x16x32_bf16 v[44:47], v[228:231], a[176:179], v[44:47]
    ds_read_b128 v[60:63], v125 offset:5760
    v_mfma_f32_16x16x32_bf16 v[44:47], v[232:235], a[180:183], v[44:47]
    ds_read_b128 v[64:67], v125 offset:6048
    v_mfma_f32_16x16x32_bf16 v[48:51], v[236:239], a[172:175], v[48:51]
    buffer_load_dwordx4 a[220:223], v240, s[48:51], s77 offen offset:3072 sc1
    v_mfma_f32_16x16x32_bf16 v[48:51], a[240:243], a[176:179], v[48:51]
    ds_read_b128 v[68:71], v125 offset:11520
    ds_read_b128 v[72:75], v125 offset:11808
    v_mfma_f32_16x16x32_bf16 v[48:51], a[244:247], a[180:183], v[48:51]
    ds_read_b128 v[76:79], v125 offset:17280
    v_mfma_f32_16x16x32_bf16 v[32:35], a[248:251], a[184:187], v[32:35]
    s_add_u32 s77, s76, 200704
    ds_read_b128 v[80:83], v125 offset:17568
    v_mfma_f32_16x16x32_bf16 v[32:35], a[252:255], a[188:191], v[32:35]
    buffer_load_dwordx4 a[224:227], v240, s[48:51], s77 offen offset:0 sc1
    v_mfma_f32_16x16x32_bf16 v[32:35], a[48:51], a[192:195], v[32:35]
    v_mfma_f32_16x16x32_bf16 v[36:39], a[52:55], a[184:187], v[36:39]
    buffer_load_dword v4, v247, s[48:51], s10 offen sc1
    v_mfma_f32_16x16x32_bf16 v[36:39], a[56:59], a[188:191], v[36:39]
    s_waitcnt lgkmcnt(5)
    v_add_f32 v52, v52, v60
    v_add_f32 v53, v53, v61
    v_mfma_f32_16x16x32_bf16 v[36:39], a[60:63], a[192:195], v[36:39]
    buffer_load_dwordx4 a[228:231], v240, s[48:51], s77 offen offset:1024 sc1
    v_mfma_f32_16x16x32_bf16 v[40:43], a[64:67], a[184:187], v[40:43]
    v_add_f32 v54, v54, v62
    v_add_f32 v55, v55, v63
    v_mfma_f32_16x16x32_bf16 v[40:43], a[68:71], a[188:191], v[40:43]
    s_waitcnt lgkmcnt(4)
    v_add_f32 v56, v56, v64
    v_add_f32 v57, v57, v65
    v_mfma_f32_16x16x32_bf16 v[40:43], a[72:75], a[192:195], v[40:43]
    v_add_f32 v58, v58, v66
    v_add_f32 v59, v59, v67
    v_mfma_f32_16x16x32_bf16 v[44:47], a[76:79], a[184:187], v[44:47]
    buffer_load_dwordx4 a[232:235], v240, s[48:51], s77 offen offset:2048 sc1
    v_mfma_f32_16x16x32_bf16 v[44:47], a[80:83], a[188:191], v[44:47]
    s_waitcnt vmcnt(11)
    v_lshlrev_b32 v60, 16, v84
    v_and_b32 v61, 0xffff0000, v84
    v_mfma_f32_16x16x32_bf16 v[44:47], a[84:87], a[192:195], v[44:47]
    v_lshlrev_b32 v62, 16, v85
    v_and_b32 v63, 0xffff0000, v85
    v_mfma_f32_16x16x32_bf16 v[48:51], a[88:91], a[184:187], v[48:51]
    s_waitcnt vmcnt(10)
    v_lshlrev_b32 v64, 16, v86
    v_and_b32 v65, 0xffff0000, v86
    v_mfma_f32_16x16x32_bf16 v[48:51], a[92:95], a[188:191], v[48:51]
    buffer_load_dwordx4 a[236:239], v240, s[48:51], s77 offen offset:3072 sc1
    v_mfma_f32_16x16x32_bf16 v[48:51], a[96:99], a[192:195], v[48:51]
    v_lshlrev_b32 v66, 16, v87
    v_and_b32 v67, 0xffff0000, v87
    v_mfma_f32_16x16x32_bf16 v[32:35], a[100:103], a[196:199], v[32:35]
    s_waitcnt lgkmcnt(1)
    v_add_f32 v68, v68, v76
    v_add_f32 v69, v69, v77
    v_mfma_f32_16x16x32_bf16 v[32:35], a[104:107], a[200:203], v[32:35]
    s_add_u32 s77, s76, 204800
    v_add_f32 v70, v70, v78
    v_add_f32 v71, v71, v79
    v_mfma_f32_16x16x32_bf16 v[32:35], a[108:111], a[204:207], v[32:35]
    buffer_load_dwordx4 v[108:111], v240, s[48:51], s77 offen offset:0 sc1
    v_mfma_f32_16x16x32_bf16 v[36:39], a[112:115], a[196:199], v[36:39]
    s_waitcnt lgkmcnt(0)
    v_add_f32 v72, v72, v80
    v_add_f32 v73, v73, v81
    v_mfma_f32_16x16x32_bf16 v[36:39], a[116:119], a[200:203], v[36:39]
    s_mov_b32 s78, 1280
    v_add_f32 v74, v74, v82
    v_add_f32 v75, v75, v83
    v_mfma_f32_16x16x32_bf16 v[36:39], a[120:123], a[204:207], v[36:39]
    v_add_f32 v52, v52, v60
    v_add_f32 v53, v53, v61
    v_mfma_f32_16x16x32_bf16 v[40:43], a[124:127], a[196:199], v[40:43]
    buffer_load_dwordx4 v[112:115], v240, s[48:51], s77 offen offset:1024 sc1
    v_mfma_f32_16x16x32_bf16 v[40:43], a[128:131], a[200:203], v[40:43]
    v_add_f32 v54, v54, v62
    v_add_f32 v55, v55, v63
    v_mfma_f32_16x16x32_bf16 v[40:43], a[132:135], a[204:207], v[40:43]
    v_add_f32 v56, v56, v64
    v_add_f32 v57, v57, v65
    v_mfma_f32_16x16x32_bf16 v[44:47], a[136:139], a[196:199], v[44:47]
    v_add_f32 v58, v58, v66
    v_add_f32 v59, v59, v67
    v_mfma_f32_16x16x32_bf16 v[44:47], a[140:143], a[200:203], v[44:47]
    buffer_load_dwordx4 v[116:119], v240, s[48:51], s77 offen offset:2048 sc1
    v_mfma_f32_16x16x32_bf16 v[44:47], a[144:147], a[204:207], v[44:47]
    v_add_f32 v52, v52, v68
    v_add_f32 v53, v53, v69
    v_mfma_f32_16x16x32_bf16 v[48:51], a[148:151], a[196:199], v[48:51]
    v_add_f32 v54, v54, v70
    v_add_f32 v55, v55, v71
    v_mfma_f32_16x16x32_bf16 v[48:51], a[152:155], a[200:203], v[48:51]
    v_add_f32 v56, v56, v72
    v_add_f32 v57, v57, v73
    v_mfma_f32_16x16x32_bf16 v[48:51], a[156:159], a[204:207], v[48:51]
    buffer_load_dwordx4 v[120:123], v240, s[48:51], s77 offen offset:3072 sc1
    v_add_f32 v58, v58, v74
    v_add_f32 v59, v59, v75
    v_cvt_pk_bf16_f32 v100, v52, v53
    v_cvt_pk_bf16_f32 v101, v54, v55
    v_cvt_pk_bf16_f32 v102, v56, v57
    v_cvt_pk_bf16_f32 v103, v58, v59
    buffer_store_dwordx4 v[100:103], v127, s[52:55], s78 offen nt
    s_waitcnt vmcnt(13)
    v_mfma_f32_16x16x32_bf16 v[12:15], v[128:131], a[208:211], 0
    s_add_u32 s77, s76, 294912
    s_waitcnt vmcnt(8)
    v_cmp_gt_u32 vcc, 4, v4
    v_mfma_f32_16x16x32_bf16 v[12:15], v[132:135], a[212:215], v[12:15]
    ds_write_b128 v124, v[32:35] offset:23040
    s_cbranch_vccnz L_chk37_slow
L_chk37:
    v_mfma_f32_16x16x32_bf16 v[12:15], v[136:139], a[216:219], v[12:15]
    buffer_load_dwordx4 a[0:3], v240, s[48:51], s77 offen offset:0 sc1
    v_mfma_f32_16x16x32_bf16 v[16:19], v[140:143], a[208:211], 0
    v_mfma_f32_16x16x32_bf16 v[16:19], v[144:147], a[212:215], v[16:19]
    v_mfma_f32_16x16x32_bf16 v[16:19], v[148:151], a[216:219], v[16:19]
    ds_write_b128 v124, v[36:39] offset:24192
    v_mfma_f32_16x16x32_bf16 v[20:23], v[152:155], a[208:211], 0
    buffer_load_dwordx4 a[4:7], v240, s[48:51], s77 offen offset:1024 sc1
    v_mfma_f32_16x16x32_bf16 v[20:23], v[156:159], a[212:215], v[20:23]
    v_mfma_f32_16x16x32_bf16 v[20:23], v[160:163], a[216:219], v[20:23]
    v_mfma_f32_16x16x32_bf16 v[24:27], v[164:167], a[208:211], 0
    ds_write_b128 v124, v[40:43] offset:25344
    v_mfma_f32_16x16x32_bf16 v[24:27], v[168:171], a[212:215], v[24:27]
    buffer_load_dwordx4 a[8:11], v240, s[48:51], s77 offen offset:2048 sc1
    v_mfma_f32_16x16x32_bf16 v[24:27], v[172:175], a[216:219], v[24:27]
    v_mfma_f32_16x16x32_bf16 v[28:31], v[176:179], a[208:211], 0
    v_mfma_f32_16x16x32_bf16 v[28:31], v[180:183], a[212:215], v[28:31]
    ds_write_b128 v124, v[44:47] offset:26496
    v_mfma_f32_16x16x32_bf16 v[28:31], v[184:187], a[216:219], v[28:31]
    buffer_load_dwordx4 a[12:15], v240, s[48:51], s77 offen offset:3072 sc1
    v_mfma_f32_16x16x32_bf16 v[12:15], v[188:191], a[220:223], v[12:15]
    v_mfma_f32_16x16x32_bf16 v[12:15], v[192:195], a[224:227], v[12:15]
    s_add_u32 s77, s76, 299008
    s_waitcnt vmcnt(11)
    v_mfma_f32_16x16x32_bf16 v[12:15], v[196:199], a[228:231], v[12:15]
    ds_write_b128 v124, v[48:51] offset:27648
    v_mfma_f32_16x16x32_bf16 v[16:19], v[200:203], a[220:223], v[16:19]
    buffer_load_dwordx4 a[16:19], v240, s[48:51], s77 offen offset:0 sc1
    v_mfma_f32_16x16x32_bf16 v[16:19], v[204:207], a[224:227], v[16:19]
    v_mfma_f32_16x16x32_bf16 v[16:19], v[208:211], a[228:231], v[16:19]
    v_mfma_f32_16x16x32_bf16 v[20:23], v[212:215], a[220:223], v[20:23]
    s_waitcnt lgkmcnt(0)
    v_mfma_f32_16x16x32_bf16 v[20:23], v[216:219], a[224:227], v[20:23]
    s_barrier
    v_mfma_f32_16x16x32_bf16 v[20:23], v[220:223], a[228:231], v[20:23]
    buffer_load_dwordx4 a[20:23], v240, s[48:51], s77 offen offset:1024 sc1
    v_mfma_f32_16x16x32_bf16 v[24:27], v[224:227], a[220:223], v[24:27]
    ds_read_b128 v[52:55], v125 offset:23040
    ds_read_b128 v[56:59], v125 offset:23328
    v_mfma_f32_16x16x32_bf16 v[24:27], v[228:231], a[224:227], v[24:27]
    ds_read_b128 v[60:63], v125 offset:28800
    v_mfma_f32_16x16x32_bf16 v[24:27], v[232:235], a[228:231], v[24:27]
    buffer_load_dwordx4 a[24:27], v240, s[48:51], s77 offen offset:2048 sc1
    v_mfma_f32_16x16x32_bf16 v[28:31], v[236:239], a[220:223], v[28:31]
    ds_read_b128 v[64:67], v125 offset:29088
    ds_read_b128 v[68:71], v125 offset:34560
    v_mfma_f32_16x16x32_bf16 v[28:31], a[240:243], a[224:227], v[28:31]
    ds_read_b128 v[72:75], v125 offset:34848
    v_mfma_f32_16x16x32_bf16 v[28:31], a[244:247], a[228:231], v[28:31]
    ds_read_b128 v[76:79], v125 offset:40320
    s_waitcnt vmcnt(13)
    v_mfma_f32_16x16x32_bf16 v[12:15], a[248:251], a[232:235], v[12:15]
    buffer_load_dwordx4 a[28:31], v240, s[48:51], s77 offen offset:3072 sc1
    s_waitcnt vmcnt(13)
    v_mfma_f32_16x16x32_bf16 v[12:15], a[252:255], a[236:239], v[12:15]
    ds_read_b128 v[80:83], v125 offset:40608
    s_waitcnt vmcnt(12)
    v_mfma_f32_16x16x32_bf16 v[12:15], a[48:51], v[108:111], v[12:15]
    v_mfma_f32_16x16x32_bf16 v[16:19], a[52:55], a[232:235], v[16:19]
    s_add_u32 s77, s76, 303104
    s_waitcnt lgkmcnt(5)
    v_add_f32 v52, v52, v60
    v_add_f32 v53, v53, v61
    v_mfma_f32_16x16x32_bf16 v[16:19], a[56:59], a[236:239], v[16:19]
    buffer_load_dwordx4 a[32:35], v240, s[48:51], s77 offen offset:0 sc1
    v_mfma_f32_16x16x32_bf16 v[16:19], a[60:63], v[108:111], v[16:19]
    v_add_f32 v54, v54, v62
    v_add_f32 v55, v55, v63
    v_mfma_f32_16x16x32_bf16 v[20:23], a[64:67], a[232:235], v[20:23]
    s_waitcnt lgkmcnt(4)
    v_add_f32 v56, v56, v64
    v_add_f32 v57, v57, v65
    v_mfma_f32_16x16x32_bf16 v[20:23], a[68:71], a[236:239], v[20:23]
    v_add_f32 v58, v58, v66
    v_add_f32 v59, v59, v67
    v_mfma_f32_16x16x32_bf16 v[20:23], a[72:75], v[108:111], v[20:23]
    buffer_load_dwordx4 a[36:39], v240, s[48:51], s77 offen offset:1024 sc1
    v_mfma_f32_16x16x32_bf16 v[24:27], a[76:79], a[232:235], v[24:27]
    v_lshlrev_b32 v60, 16, v88
    v_and_b32 v61, 0xffff0000, v88
    v_mfma_f32_16x16x32_bf16 v[24:27], a[80:83], a[236:239], v[24:27]
    v_lshlrev_b32 v62, 16, v89
    v_and_b32 v63, 0xffff0000, v89
    v_mfma_f32_16x16x32_bf16 v[24:27], a[84:87], v[108:111], v[24:27]
    v_lshlrev_b32 v64, 16, v90
    v_and_b32 v65, 0xffff0000, v90
    v_mfma_f32_16x16x32_bf16 v[28:31], a[88:91], a[232:235], v[28:31]
    buffer_load_dwordx4 a[40:43], v240, s[48:51], s77 offen offset:2048 sc1
    v_mfma_f32_16x16x32_bf16 v[28:31], a[92:95], a[236:239], v[28:31]
    v_lshlrev_b32 v66, 16, v91
    v_and_b32 v67, 0xffff0000, v91
    v_mfma_f32_16x16x32_bf16 v[28:31], a[96:99], v[108:111], v[28:31]
    s_waitcnt lgkmcnt(1)
    v_add_f32 v68, v68, v76
    v_add_f32 v69, v69, v77
    s_waitcnt vmcnt(14)
    v_mfma_f32_16x16x32_bf16 v[12:15], a[100:103], v[112:115], v[12:15]
    s_waitcnt vmcnt(13)
    v_add_f32 v70, v70, v78
    v_add_f32 v71, v71, v79
    v_mfma_f32_16x16x32_bf16 v[12:15], a[104:107], v[116:119], v[12:15]
    buffer_load_dwordx4 a[44:47], v240, s[48:51], s77 offen offset:3072 sc1
    s_waitcnt vmcnt(13)
    v_mfma_f32_16x16x32_bf16 v[12:15], a[108:111], v[120:123], v[12:15]
    s_waitcnt lgkmcnt(0)
    v_add_f32 v72, v72, v80
    v_add_f32 v73, v73, v81
    v_mfma_f32_16x16x32_bf16 v[16:19], a[112:115], v[112:115], v[16:19]
    s_mov_b32 s78, 83200
    v_add_f32 v74, v74, v82
    v_add_f32 v75, v75, v83
    v_mfma_f32_16x16x32_bf16 v[16:19], a[116:119], v[116:119], v[16:19]
    v_add_f32 v52, v52, v60
    v_add_f32 v53, v53, v61
    v_mfma_f32_16x16x32_bf16 v[16:19], a[120:123], v[120:123], v[16:19]
    v_add_f32 v54, v54, v62
    v_add_f32 v55, v55, v63
    v_mfma_f32_16x16x32_bf16 v[20:23], a[124:127], v[112:115], v[20:23]
    s_mov_b32 s88, 81920
    v_add_f32 v56, v56, v64
    v_add_f32 v57, v57, v65
    v_mfma_f32_16x16x32_bf16 v[20:23], a[128:131], v[116:119], v[20:23]
    buffer_load_dwordx2 v[92:93], v126, s[48:51], s88 offen offset:0 sc1
    v_mfma_f32_16x16x32_bf16 v[20:23], a[132:135], v[120:123], v[20:23]
    v_add_f32 v58, v58, v66
    v_add_f32 v59, v59, v67
    v_mfma_f32_16x16x32_bf16 v[24:27], a[136:139], v[112:115], v[24:27]
    v_add_f32 v52, v52, v68
    v_add_f32 v53, v53, v69
    v_mfma_f32_16x16x32_bf16 v[24:27], a[140:143], v[116:119], v[24:27]
    v_add_f32 v54, v54, v70
    v_add_f32 v55, v55, v71
    v_mfma_f32_16x16x32_bf16 v[24:27], a[144:147], v[120:123], v[24:27]
    v_add_f32 v56, v56, v72
    v_add_f32 v57, v57, v73
    v_mfma_f32_16x16x32_bf16 v[28:31], a[148:151], v[112:115], v[28:31]
    buffer_load_dwordx2 v[94:95], v126, s[48:51], s88 offen offset:512 sc1
    v_mfma_f32_16x16x32_bf16 v[28:31], a[152:155], v[116:119], v[28:31]
    v_add_f32 v58, v58, v74
    v_add_f32 v59, v59, v75
    v_mfma_f32_16x16x32_bf16 v[28:31], a[156:159], v[120:123], v[28:31]
    v_cvt_pk_bf16_f32 v100, v52, v53
    v_cvt_pk_bf16_f32 v101, v54, v55
    v_cvt_pk_bf16_f32 v102, v56, v57
    v_cvt_pk_bf16_f32 v103, v58, v59
    buffer_store_dwordx4 v[100:103], v127, s[52:55], s78 offen nt
    s_waitcnt vmcnt(14)
    v_mfma_f32_16x16x32_bf16 v[32:35], v[128:131], a[0:3], 0
    s_waitcnt vmcnt(13)
    v_mfma_f32_16x16x32_bf16 v[32:35], v[132:135], a[4:7], v[32:35]
    ds_write_b128 v124, v[12:15] offset:0
    s_waitcnt vmcnt(12)
    v_mfma_f32_16x16x32_bf16 v[32:35], v[136:139], a[8:11], v[32:35]
    s_mov_b32 s88, 122880
    v_mfma_f32_16x16x32_bf16 v[36:39], v[140:143], a[0:3], 0
    buffer_load_dwordx2 v[96:97], v126, s[48:51], s88 offen offset:0 sc1
    v_mfma_f32_16x16x32_bf16 v[36:39], v[144:147], a[4:7], v[36:39]
    v_mfma_f32_16x16x32_bf16 v[36:39], v[148:151], a[8:11], v[36:39]
    ds_write_b128 v124, v[16:19] offset:1152
    v_mfma_f32_16x16x32_bf16 v[40:43], v[152:155], a[0:3], 0
    v_mfma_f32_16x16x32_bf16 v[40:43], v[156:159], a[4:7], v[40:43]
    v_mfma_f32_16x16x32_bf16 v[40:43], v[160:163], a[8:11], v[40:43]
    buffer_load_dwordx2 v[98:99], v126, s[48:51], s88 offen offset:512 sc1
    v_mfma_f32_16x16x32_bf16 v[44:47], v[164:167], a[0:3], 0
    ds_write_b128 v124, v[20:23] offset:2304
    v_mfma_f32_16x16x32_bf16 v[44:47], v[168:171], a[4:7], v[44:47]
    v_mfma_f32_16x16x32_bf16 v[44:47], v[172:175], a[8:11], v[44:47]
    v_mfma_f32_16x16x32_bf16 v[48:51], v[176:179], a[0:3], 0
    v_mfma_f32_16x16x32_bf16 v[48:51], v[180:183], a[4:7], v[48:51]
    ds_write_b128 v124, v[24:27] offset:3456
    v_mfma_f32_16x16x32_bf16 v[48:51], v[184:187], a[8:11], v[48:51]
    s_waitcnt vmcnt(13)
    v_mfma_f32_16x16x32_bf16 v[32:35], v[188:191], a[12:15], v[32:35]
    s_waitcnt vmcnt(12)
    v_mfma_f32_16x16x32_bf16 v[32:35], v[192:195], a[16:19], v[32:35]
    s_waitcnt vmcnt(11)
    v_mfma_f32_16x16x32_bf16 v[32:35], v[196:199], a[20:23], v[32:35]
    ds_write_b128 v124, v[28:31] offset:4608
    v_mfma_f32_16x16x32_bf16 v[36:39], v[200:203], a[12:15], v[36:39]
    v_mfma_f32_16x16x32_bf16 v[36:39], v[204:207], a[16:19], v[36:39]
    v_mfma_f32_16x16x32_bf16 v[36:39], v[208:211], a[20:23], v[36:39]
    v_mfma_f32_16x16x32_bf16 v[40:43], v[212:215], a[12:15], v[40:43]
    s_waitcnt lgkmcnt(0)
    v_mfma_f32_16x16x32_bf16 v[40:43], v[216:219], a[16:19], v[40:43]
    s_barrier
    v_mfma_f32_16x16x32_bf16 v[40:43], v[220:223], a[20:23], v[40:43]
    ds_read_b128 v[52:55], v125 offset:0
    v_mfma_f32_16x16x32_bf16 v[44:47], v[224:227], a[12:15], v[44:47]
    ds_read_b128 v[56:59], v125 offset:288
    v_mfma_f32_16x16x32_bf16 v[44:47], v[228:231], a[16:19], v[44:47]
    ds_read_b128 v[60:63], v125 offset:5760
    v_mfma_f32_16x16x32_bf16 v[44:47], v[232:235], a[20:23], v[44:47]
    ds_read_b128 v[64:67], v125 offset:6048
    v_mfma_f32_16x16x32_bf16 v[48:51], v[236:239], a[12:15], v[48:51]
    ds_read_b128 v[68:71], v125 offset:11520
    v_mfma_f32_16x16x32_bf16 v[48:51], a[240:243], a[16:19], v[48:51]
    ds_read_b128 v[72:75], v125 offset:11808
    v_mfma_f32_16x16x32_bf16 v[48:51], a[244:247], a[20:23], v[48:51]
    ds_read_b128 v[76:79], v125 offset:17280
    s_waitcnt vmcnt(10)
    v_mfma_f32_16x16x32_bf16 v[32:35], a[248:251], a[24:27], v[32:35]
    ds_read_b128 v[80:83], v125 offset:17568
    s_waitcnt vmcnt(9)
    v_mfma_f32_16x16x32_bf16 v[32:35], a[252:255], a[28:31], v[32:35]
    s_waitcnt vmcnt(8)
    v_mfma_f32_16x16x32_bf16 v[32:35], a[48:51], a[32:35], v[32:35]
    v_mfma_f32_16x16x32_bf16 v[36:39], a[52:55], a[24:27], v[36:39]
    s_waitcnt lgkmcnt(5)
    v_add_f32 v52, v52, v60
    v_add_f32 v53, v53, v61
    v_mfma_f32_16x16x32_bf16 v[36:39], a[56:59], a[28:31], v[36:39]
    v_add_f32 v54, v54, v62
    v_add_f32 v55, v55, v63
    v_mfma_f32_16x16x32_bf16 v[36:39], a[60:63], a[32:35], v[36:39]
    s_waitcnt lgkmcnt(4)
    v_add_f32 v56, v56, v64
    v_add_f32 v57, v57, v65
    v_mfma_f32_16x16x32_bf16 v[40:43], a[64:67], a[24:27], v[40:43]
    v_add_f32 v58, v58, v66
    v_add_f32 v59, v59, v67
    v_mfma_f32_16x16x32_bf16 v[40:43], a[68:71], a[28:31], v[40:43]
    s_waitcnt vmcnt(4)
    v_lshlrev_b32 v60, 16, v92
    v_and_b32 v61, 0xffff0000, v92
    v_mfma_f32_16x16x32_bf16 v[40:43], a[72:75], a[32:35], v[40:43]
    v_lshlrev_b32 v62, 16, v93
    v_and_b32 v63, 0xffff0000, v93
    v_mfma_f32_16x16x32_bf16 v[44:47], a[76:79], a[24:27], v[44:47]
    s_waitcnt vmcnt(3)
    v_lshlrev_b32 v64, 16, v94
    v_and_b32 v65, 0xffff0000, v94
    v_mfma_f32_16x16x32_bf16 v[44:47], a[80:83], a[28:31], v[44:47]
    v_lshlrev_b32 v66, 16, v95
    v_and_b32 v67, 0xffff0000, v95
    v_mfma_f32_16x16x32_bf16 v[44:47], a[84:87], a[32:35], v[44:47]
    s_waitcnt lgkmcnt(1)
    v_add_f32 v68, v68, v76
    v_add_f32 v69, v69, v77
    v_mfma_f32_16x16x32_bf16 v[48:51], a[88:91], a[24:27], v[48:51]
    v_add_f32 v70, v70, v78
    v_add_f32 v71, v71, v79
    v_mfma_f32_16x16x32_bf16 v[48:51], a[92:95], a[28:31], v[48:51]
    s_waitcnt lgkmcnt(0)
    v_add_f32 v72, v72, v80
    v_add_f32 v73, v73, v81
    v_mfma_f32_16x16x32_bf16 v[48:51], a[96:99], a[32:35], v[48:51]
    s_mov_b32 s78, 0
    v_add_f32 v74, v74, v82
    v_add_f32 v75, v75, v83
    v_mfma_f32_16x16x32_bf16 v[32:35], a[100:103], a[36:39], v[32:35]
    v_add_f32 v52, v52, v60
    v_add_f32 v53, v53, v61
    v_mfma_f32_16x16x32_bf16 v[32:35], a[104:107], a[40:43], v[32:35]
    v_add_f32 v54, v54, v62
    v_add_f32 v55, v55, v63
    v_mfma_f32_16x16x32_bf16 v[32:35], a[108:111], a[44:47], v[32:35]
    v_add_f32 v56, v56, v64
    v_add_f32 v57, v57, v65
    v_mfma_f32_16x16x32_bf16 v[36:39], a[112:115], a[36:39], v[36:39]
    v_add_f32 v58, v58, v66
    v_add_f32 v59, v59, v67
    v_mfma_f32_16x16x32_bf16 v[36:39], a[116:119], a[40:43], v[36:39]
    v_add_f32 v52, v52, v68
    v_add_f32 v53, v53, v69
    v_mfma_f32_16x16x32_bf16 v[36:39], a[120:123], a[44:47], v[36:39]
    v_add_f32 v54, v54, v70
    v_add_f32 v55, v55, v71
    v_mfma_f32_16x16x32_bf16 v[40:43], a[124:127], a[36:39], v[40:43]
    v_add_f32 v56, v56, v72
    v_add_f32 v57, v57, v73
    v_mfma_f32_16x16x32_bf16 v[40:43], a[128:131], a[40:43], v[40:43]
    ds_write_b128 v124, v[32:35] offset:23040
    v_mfma_f32_16x16x32_bf16 v[40:43], a[132:135], a[44:47], v[40:43]
    v_add_f32 v58, v58, v74
    v_add_f32 v59, v59, v75
    v_mfma_f32_16x16x32_bf16 v[44:47], a[136:139], a[36:39], v[44:47]
    v_cvt_pk_bf16_f32 v100, v52, v53
    v_cvt_pk_bf16_f32 v101, v54, v55
    v_mfma_f32_16x16x32_bf16 v[44:47], a[140:143], a[40:43], v[44:47]
    ds_write_b128 v124, v[36:39] offset:24192
    v_mfma_f32_16x16x32_bf16 v[44:47], a[144:147], a[44:47], v[44:47]
    v_cvt_pk_bf16_f32 v102, v56, v57
    v_cvt_pk_bf16_f32 v103, v58, v59
    v_mfma_f32_16x16x32_bf16 v[48:51], a[148:151], a[36:39], v[48:51]
    buffer_store_dwordx4 v[100:103], v127, s[52:55], s78 offen nt
    v_mfma_f32_16x16x32_bf16 v[48:51], a[152:155], a[40:43], v[48:51]
    ds_write_b128 v124, v[40:43] offset:25344
    v_mfma_f32_16x16x32_bf16 v[48:51], a[156:159], a[44:47], v[48:51]
    s_waitcnt vmcnt(2)
    v_lshlrev_b32 v108, 16, v96
    v_and_b32 v109, 0xffff0000, v96
    v_lshlrev_b32 v110, 16, v97
    v_and_b32 v111, 0xffff0000, v97
    s_waitcnt vmcnt(1)
    v_lshlrev_b32 v112, 16, v98
    v_and_b32 v113, 0xffff0000, v98
    v_lshlrev_b32 v114, 16, v99
    v_and_b32 v115, 0xffff0000, v99
    ds_write_b128 v124, v[44:47] offset:26496
    ds_write_b128 v124, v[48:51] offset:27648
    s_waitcnt lgkmcnt(0)
    s_barrier
    ds_read_b128 v[52:55], v125 offset:23040
    ds_read_b128 v[56:59], v125 offset:23328
    ds_read_b128 v[60:63], v125 offset:28800
    ds_read_b128 v[64:67], v125 offset:29088
    ds_read_b128 v[68:71], v125 offset:34560
    ds_read_b128 v[72:75], v125 offset:34848
    ds_read_b128 v[76:79], v125 offset:40320
    ds_read_b128 v[80:83], v125 offset:40608
    s_mov_b32 s78, 81920
    s_waitcnt lgkmcnt(7)
    v_pk_add_f32 v[52:53], v[52:53], v[108:109]
    v_pk_add_f32 v[54:55], v[54:55], v[110:111]
    s_waitcnt lgkmcnt(6)
    v_pk_add_f32 v[56:57], v[56:57], v[112:113]
    v_pk_add_f32 v[58:59], v[58:59], v[114:115]
    s_waitcnt lgkmcnt(5)
    v_pk_add_f32 v[52:53], v[52:53], v[60:61]
    v_pk_add_f32 v[54:55], v[54:55], v[62:63]
    s_waitcnt lgkmcnt(4)
    v_pk_add_f32 v[56:57], v[56:57], v[64:65]
    v_pk_add_f32 v[58:59], v[58:59], v[66:67]
    s_waitcnt lgkmcnt(3)
    v_pk_add_f32 v[52:53], v[52:53], v[68:69]
    v_pk_add_f32 v[54:55], v[54:55], v[70:71]
    s_waitcnt lgkmcnt(2)
    v_pk_add_f32 v[56:57], v[56:57], v[72:73]
    v_pk_add_f32 v[58:59], v[58:59], v[74:75]
    s_waitcnt lgkmcnt(1)
    v_pk_add_f32 v[52:53], v[52:53], v[76:77]
    v_pk_add_f32 v[54:55], v[54:55], v[78:79]
    s_waitcnt lgkmcnt(0)
    v_pk_add_f32 v[56:57], v[56:57], v[80:81]
    v_pk_add_f32 v[58:59], v[58:59], v[82:83]
    v_cvt_pk_bf16_f32 v100, v52, v53
    v_cvt_pk_bf16_f32 v101, v54, v55
    v_cvt_pk_bf16_f32 v102, v56, v57
    v_cvt_pk_bf16_f32 v103, v58, v59
    buffer_store_dwordx4 v[100:103], v127, s[52:55], s78 offen
L_end:
    s_endpgm
L_chk1_slow:
    s_nop 7
    s_mov_b32 s90, 0
L_spin2:
    buffer_load_dword v57, v56, s[60:63], 0 offen sc1
    s_waitcnt vmcnt(0)
    v_cmp_eq_u32 vcc, 0, v57
    s_nop 4
    s_cbranch_vccz L_spin2_done
    s_mov_b64 exec, vcc
    s_sleep 12
    s_add_u32 s90, s90, 1
    s_cmp_lt_u32 s90, 262144
    s_cbranch_scc1 L_spin2
L_spin2_done:
    s_mov_b64 exec, -1
    s_nop 4
    s_branch L_chk1
L_chk3_slow:
    s_nop 7
    s_mov_b32 s90, 0
L_spin4:
    s_mov_b32 s14, 0
    buffer_load_dwordx4 v[24:27], v52, s[48:51], s14 offen sc1
    s_mov_b32 s14, 4096
    buffer_load_dwordx4 v[28:31], v52, s[48:51], s14 offen sc1
    s_mov_b32 s14, 8192
    buffer_load_dwordx4 v[32:35], v52, s[48:51], s14 offen sc1
    s_mov_b32 s14, 12288
    buffer_load_dwordx4 v[36:39], v52, s[48:51], s14 offen sc1
    s_waitcnt vmcnt(0)
    v_min3_u32 v2, v24, v26, v28
    v_min3_u32 v2, v2, v30, v32
    v_min3_u32 v2, v2, v34, v36
    v_min_u32 v2, v2, v38
    v_cmp_eq_u32 vcc, 0, v2
    s_nop 4
    s_cbranch_vccz L_spin4_done
    s_mov_b64 exec, vcc
    s_sleep 2
    s_add_u32 s90, s90, 1
    s_cmp_lt_u32 s90, 262144
    s_cbranch_scc1 L_spin4
L_spin4_done:
    s_mov_b64 exec, -1
    s_nop 4
    s_branch L_chk3
L_chk5_slow:
    s_nop 7
    s_mov_b32 s90, 0
L_spin6:
    buffer_load_dword v57, v56, s[48:51], 0 offen sc1
    s_waitcnt vmcnt(0)
    v_cmp_gt_u32 vcc, 1, v57
    s_nop 4
    s_cbranch_vccz L_spin6_done
    s_mov_b64 exec, vcc
    s_sleep 4
    s_add_u32 s90, s90, 1
    s_cmp_lt_u32 s90, 262144
    s_cbranch_scc1 L_spin6
L_spin6_done:
    s_mov_b64 exec, -1
    s_nop 4
    s_branch L_chk5
L_chk7_slow:
    s_nop 7
    s_mov_b32 s90, 0
L_spin8:
    buffer_load_dword v59, v58, s[48:51], 0 offen sc1
    s_waitcnt vmcnt(0)
    v_cmp_gt_u32 vcc, 1, v59
    s_nop 4
    s_cbranch_vccz L_spin8_done
    s_mov_b64 exec, vcc
    s_sleep 4
    s_add_u32 s90, s90, 1
    s_cmp_lt_u32 s90, 262144
    s_cbranch_scc1 L_spin8
L_spin8_done:
    s_mov_b64 exec, -1
    s_nop 4
    s_branch L_chk7
L_chk9_slow:
    s_nop 7
    s_mov_b32 s90, 0
L_spin10:
    buffer_load_dword v235, v234, s[48:51], 0 offen sc1
    s_waitcnt vmcnt(0)
    v_cmp_gt_u32 vcc, 2, v235
    s_nop 4
    s_cbranch_vccz L_spin10_done
    s_mov_b64 exec, vcc
    s_sleep 4
    s_add_u32 s90, s90, 1
    s_cmp_lt_u32 s90, 262144
    s_cbranch_scc1 L_spin10
L_spin10_done:
    s_mov_b64 exec, -1
    s_nop 4
    s_branch L_chk9
L_chk11_slow:
    s_nop 7
    s_mov_b32 s90, 0
L_spin12:
    buffer_load_dword v59, v251, s[48:51], 0 offen sc1
    s_waitcnt vmcnt(0)
    v_cmp_gt_u32 vcc, 1, v59
    s_nop 4
    s_cbranch_vccz L_spin12_done
    s_mov_b64 exec, vcc
    s_sleep 2
    s_add_u32 s90, s90, 1
    s_cmp_lt_u32 s90, 262144
    s_cbranch_scc1 L_spin12
L_spin12_done:
    s_mov_b64 exec, -1
    s_nop 4
    s_branch L_chk11
L_chk13_slow:
    s_nop 7
    s_mov_b32 s90, 0
L_spin14:
    buffer_load_dword v57, v56, s[60:63], 0 offen sc1
    s_waitcnt vmcnt(0)
    v_cmp_eq_u32 vcc, 0, v57
    s_nop 4
    s_cbranch_vccz L_spin14_done
    s_mov_b64 exec, vcc
    s_sleep 12
    s_add_u32 s90, s90, 1
    s_cmp_lt_u32 s90, 262144
    s_cbranch_scc1 L_spin14
L_spin14_done:
    s_mov_b64 exec, -1
    s_nop 4
    s_branch L_chk13
L_chk15_slow:
    s_nop 7
    s_mov_b32 s90, 0
L_spin16:
    buffer_load_dword v49, v48, s[48:51], 0 offen sc1
    s_waitcnt vmcnt(0)
    v_cmp_gt_u32 vcc, 1, v49
    s_nop 4
    s_cbranch_vccz L_spin16_done
    s_mov_b64 exec, vcc
    s_sleep 4
    s_add_u32 s90, s90, 1
    s_cmp_lt_u32 s90, 262144
    s_cbranch_scc1 L_spin16
L_spin16_done:
    s_mov_b64 exec, -1
    s_nop 4
    s_branch L_chk15
L_chk17_slow:
    s_nop 7
    s_mov_b32 s90, 0
L_spin18:
    buffer_load_dword v55, v54, s[48:51], 0 offen sc1
    s_waitcnt vmcnt(0)
    v_cmp_gt_u32 vcc, 1, v55
    s_nop 4
    s_cbranch_vccz L_spin18_done
    s_mov_b64 exec, vcc
    s_sleep 4
    s_add_u32 s90, s90, 1
    s_cmp_lt_u32 s90, 262144
    s_cbranch_scc1 L_spin18
L_spin18_done:
    s_mov_b64 exec, -1
    s_nop 4
    s_branch L_chk17
L_chk19_slow:
    s_nop 7
    s_mov_b32 s90, 0
L_spin20:
    buffer_load_dword v235, v234, s[48:51], 0 offen sc1
    s_waitcnt vmcnt(0)
    v_cmp_gt_u32 vcc, 2, v235
    s_nop 4
    s_cbranch_vccz L_spin20_done
    s_mov_b64 exec, vcc
    s_sleep 4
    s_add_u32 s90, s90, 1
    s_cmp_lt_u32 s90, 262144
    s_cbranch_scc1 L_spin20
L_spin20_done:
    s_mov_b64 exec, -1
    s_nop 4
    s_branch L_chk19
L_chk21_slow:
    s_nop 7
    s_mov_b32 s90, 0
L_spin22:
    buffer_load_dword v45, v44, s[48:51], 0 offen sc1
    s_waitcnt vmcnt(0)
    v_cmp_gt_u32 vcc, 1, v45
    s_nop 4
    s_cbranch_vccz L_spin22_done
    s_mov_b64 exec, vcc
    s_sleep 6
    s_add_u32 s90, s90, 1
    s_cmp_lt_u32 s90, 262144
    s_cbranch_scc1 L_spin22
L_spin22_done:
    s_mov_b64 exec, -1
    s_nop 4
    s_branch L_chk21
L_chk23_slow:
    s_nop 7
    s_mov_b32 s90, 0
L_spin24:
    buffer_load_dword v59, v251, s[48:51], 0 offen sc1
    s_waitcnt vmcnt(0)
    v_cmp_gt_u32 vcc, 1, v59
    s_nop 4
    s_cbranch_vccz L_spin24_done
    s_mov_b64 exec, vcc
    s_sleep 2
    s_add_u32 s90, s90, 1
    s_cmp_lt_u32 s90, 262144
    s_cbranch_scc1 L_spin24
L_spin24_done:
    s_mov_b64 exec, -1
    s_nop 4
    s_branch L_chk23
L_chk25_slow:
    s_nop 7
    s_mov_b32 s90, 0
L_spin26:
    buffer_load_dwordx4 v[104:107], v245, s[48:51], 0 offen offset:0 sc1
    buffer_load_dwordx4 v[108:111], v245, s[48:51], 0 offen offset:256 sc1
    s_waitcnt vmcnt(0)
    v_min3_u32 v3, v104, v106, v108
    v_min_u32 v3, v3, v110
    v_cmp_eq_u32 vcc, 0, v3
    s_nop 4
    s_cbranch_vccz L_spin26_done
    s_mov_b64 exec, vcc
    s_sleep 2
    s_add_u32 s90, s90, 1
    s_cmp_lt_u32 s90, 262144
    s_cbranch_scc1 L_spin26
L_spin26_done:
    s_mov_b64 exec, -1
    s_nop 4
    s_branch L_chk25
L_chk27_slow:
    s_nop 7
    s_mov_b32 s90, 0
L_spin28:
    buffer_load_dwordx4 v[112:115], v245, s[48:51], 0 offen offset:512 sc1
    buffer_load_dwordx4 v[116:119], v245, s[48:51], 0 offen offset:768 sc1
    s_waitcnt vmcnt(0)
    v_min3_u32 v3, v112, v114, v116
    v_min_u32 v3, v3, v118
    v_cmp_eq_u32 vcc, 0, v3
    s_nop 4
    s_cbranch_vccz L_spin28_done
    s_mov_b64 exec, vcc
    s_sleep 2
    s_add_u32 s90, s90, 1
    s_cmp_lt_u32 s90, 262144
    s_cbranch_scc1 L_spin28
L_spin28_done:
    s_mov_b64 exec, -1
    s_nop 4
    s_branch L_chk27
L_chk29_slow:
    s_nop 7
    s_mov_b32 s90, 0
L_spin30:
    buffer_load_dword v4, v251, s[48:51], 0 offen sc1
    s_waitcnt vmcnt(0)
    v_cmp_gt_u32 vcc, 2, v4
    s_nop 4
    s_cbranch_vccz L_spin30_done
    s_mov_b64 exec, vcc
    s_sleep 1
    s_add_u32 s90, s90, 1
    s_cmp_lt_u32 s90, 262144
    s_cbranch_scc1 L_spin30
L_spin30_done:
    s_mov_b64 exec, -1
    s_nop 4
    s_branch L_chk29
L_chk31_slow:
    s_nop 7
    s_mov_b32 s90, 0
L_spin32:
    buffer_load_dword v4, v247, s[48:51], 0 offen sc1
    s_waitcnt vmcnt(0)
    v_cmp_gt_u32 vcc, 1, v4
    s_nop 4
    s_cbranch_vccz L_spin32_done
    s_mov_b64 exec, vcc
    s_sleep 1
    s_add_u32 s90, s90, 1
    s_cmp_lt_u32 s90, 262144
    s_cbranch_scc1 L_spin32
L_spin32_done:
    s_mov_b64 exec, -1
    s_nop 4
    s_branch L_chk31
L_chk33_slow:
    s_nop 7
    s_mov_b32 s90, 0
L_spin34:
    buffer_load_dword v4, v247, s[48:51], 0 offen sc1
    s_waitcnt vmcnt(0)
    v_cmp_gt_u32 vcc, 2, v4
    s_nop 4
    s_cbranch_vccz L_spin34_done
    s_mov_b64 exec, vcc
    s_sleep 1
    s_add_u32 s90, s90, 1
    s_cmp_lt_u32 s90, 262144
    s_cbranch_scc1 L_spin34
L_spin34_done:
    s_mov_b64 exec, -1
    s_nop 4
    s_branch L_chk33
L_chk35_slow:
    s_nop 7
    s_mov_b32 s90, 0
L_spin36:
    buffer_load_dword v4, v247, s[48:51], 0 offen sc1
    s_waitcnt vmcnt(0)
    v_cmp_gt_u32 vcc, 3, v4
    s_nop 4
    s_cbranch_vccz L_spin36_done
    s_mov_b64 exec, vcc
    s_sleep 1
    s_add_u32 s90, s90, 1
    s_cmp_lt_u32 s90, 262144
    s_cbranch_scc1 L_spin36
L_spin36_done:
    s_mov_b64 exec, -1
    s_nop 4
    s_branch L_chk35
L_chk37_slow:
    s_nop 7
    s_mov_b32 s90, 0
L_spin38:
    buffer_load_dword v4, v247, s[48:51], s10 offen sc1
    s_waitcnt vmcnt(0)
    v_cmp_gt_u32 vcc, 4, v4
    s_nop 4
    s_cbranch_vccz L_spin38_done
    s_mov_b64 exec, vcc
    s_sleep 1
    s_add_u32 s90, s90, 1
    s_cmp_lt_u32 s90, 262144
    s_cbranch_scc1 L_spin38
L_spin38_done:
    s_mov_b64 exec, -1
    s_nop 4
    s_branch L_chk37
L_code_end:
.section .rodata,"a"
.p2align 6
.amdhsa_kernel sequential_preLN__ssm_conv_s4__geglu_ffn__prompt_kernel
  .amdhsa_next_free_vgpr 512
  .amdhsa_next_free_sgpr 102
  .amdhsa_accum_offset 256
  .amdhsa_group_segment_fixed_size 0
  .amdhsa_kernarg_size 128
  .amdhsa_user_sgpr_count 2
  .amdhsa_user_sgpr_kernarg_segment_ptr 1
  .amdhsa_system_sgpr_workgroup_id_x 1
.end_amdhsa_kernel
```
